```python
import torch

def _softmax(x, axis=-1):
    return torch.softmax(x, dim=axis)
def _gelu(x):
    return torch.nn.functional.gelu(x, approximate="tanh")
def _silu(x):
    return torch.nn.functional.silu(x)
def _sigmoid(x):
    return torch.sigmoid(x)
def _layernorm(x, axis=-1, eps=1e-5):
    m = x.mean(dim=axis, keepdim=True)
    v = x.var(dim=axis, keepdim=True, unbiased=False)
    return (x - m) / torch.sqrt(v + eps)
def _scatter_add(tgt, idx, src, axis=0):
    return tgt.clone().index_add_(axis, idx, src)
def _segment_sum(src, seg, n):
    out = torch.zeros((n,) + src.shape[1:], dtype=src.dtype)
    return out.index_add_(0, seg, src)
def _pad(x, pw):
    flat = tuple(v for pair in reversed(pw) for v in pair)
    return torch.nn.functional.pad(x, flat)

kernel_name = 'interleave_layers__linear_kernel_hedgehog__glu_gated_geglu__prompt'

def setup_inputs():

    _w = (lambda a: (lambda t: t.to(torch.bfloat16) if t.is_floating_point() else t)(torch.as_tensor(a)))
    def _A_setup():
        B, S, D, H = 1, 2048, 640, 32
        Dh = D // H
        return {
            "x": _w((lambda *s: torch.randn(*s, dtype=torch.bfloat16) * 0.05)(B, S, D)),
            "wqkv": _w((lambda *s: torch.randn(*s, dtype=torch.bfloat16) * 0.4)(D, 3 * D)),
            "w_phi": _w((lambda *s: torch.randn(*s, dtype=torch.bfloat16) * 0.4)(H, Dh, Dh) * (Dh ** -0.5)),
            "wo": _w((lambda *s: torch.randn(*s, dtype=torch.bfloat16) * 0.05)(D, D)),
        }
    _A_in = _A_setup()

    def _B_setup():
        B, S, Dm, Df = 1, 2048, 640, 1728
        return {
            "x": _w((lambda *s: torch.randn(*s, dtype=torch.bfloat16) * 0.05)(B, S, Dm)),
            "w_gate": _w((lambda *s: torch.randn(*s, dtype=torch.bfloat16) * 1.6)(Dm, Df) * (Dm ** -0.5)),
            "w_up": _w((lambda *s: torch.randn(*s, dtype=torch.bfloat16) * 1.6)(Dm, Df) * (Dm ** -0.5)),
            "w_down": _w((lambda *s: torch.randn(*s, dtype=torch.bfloat16) * 1.6)(Df, Dm) * (Df ** -0.5)),
        }
    _B_in = _B_setup()

    return {
        "A_x": _A_in["x"],
        "A_wqkv": _A_in["wqkv"],
        "A_w_phi": _A_in["w_phi"],
        "A_wo": _A_in["wo"],
        "B_x": _B_in["x"],
        "B_w_gate": _B_in["w_gate"],
        "B_w_up": _B_in["w_up"],
        "B_w_down": _B_in["w_down"],
    }

def reference(A_x, A_wqkv, A_w_phi, A_wo, B_x, B_w_gate, B_w_up, B_w_down):
    def _A_ref(x, wqkv, w_phi, wo):
        B, S, D = x.shape
        H = 32; Dh = D // H
        qkv = (lambda x, *d: x.permute(*d))((x @ wqkv).reshape(B, S, 3, H, Dh), 2, 0, 3, 1, 4)
        q, k, v = qkv[0], qkv[1], qkv[2]
        pq = torch.einsum("bhsd,hdf->bhsf", q, w_phi)
        pk = torch.einsum("bhsd,hdf->bhsf", k, w_phi)
        phi_q = torch.concatenate([_softmax(pq, axis=-1), _softmax(-pq, axis=-1)], axis=-1)
        phi_k = torch.concatenate([_softmax(pk, axis=-1), _softmax(-pk, axis=-1)], axis=-1)
        kv = torch.einsum("bhsf,bhsd->bhfd", phi_k, v)
        z  = torch.einsum("bhsf->bhf", phi_k)
        num = torch.einsum("bhqf,bhfd->bhqd", phi_q, kv)
        den = torch.einsum("bhqf,bhf->bhq", phi_q, z)[..., None] + 1e-6
        o = num / den
        return (lambda x, *d: x.permute(*d))(o, 0, 2, 1, 3).reshape(B, S, D) @ wo

    def _B_ref(x, w_gate, w_up, w_down):
        g = torch.einsum("bsd,df->bsf", x, w_gate)
        u = torch.einsum("bsd,df->bsf", x, w_up)
        h = _gelu(g) * u
        return torch.einsum("bsf,fd->bsd", h, w_down)

    x = A_x
    x = x + _A_ref(_layernorm(x, axis=-1), A_wqkv, A_w_phi, A_wo)
    x = x + _B_ref(_layernorm(x, axis=-1), B_w_gate, B_w_up, B_w_down)
    x = x + _A_ref(_layernorm(x, axis=-1), A_wqkv, A_w_phi, A_wo)
    x = x + _B_ref(_layernorm(x, axis=-1), B_w_gate, B_w_up, B_w_down)
    return x
```

```asm
; @launch kernel=interleave_layers__linear_kernel_hedgehog__glu_gated_geglu__prompt_kernel grid=(2460,1,1) block=(256,1,1) lds=0
; @launch kernel=k1a_kernel grid=(256,1,1) block=(256,1,1) lds=138240
; @launch kernel=kra_kernel grid=(192,1,1) block=(256,1,1) lds=0
; @launch kernel=k2a_kernel grid=(160,1,1) block=(256,1,1) lds=83008
; @launch kernel=k3a_kernel grid=(448,1,1) block=(256,1,1) lds=83008
; @launch kernel=k4a_kernel grid=(160,1,1) block=(256,1,1) lds=111680
; @launch kernel=k1b_kernel grid=(256,1,1) block=(256,1,1) lds=138240
; @launch kernel=krb_kernel grid=(192,1,1) block=(256,1,1) lds=0
; @launch kernel=k2b_kernel grid=(160,1,1) block=(256,1,1) lds=83008
; @launch kernel=k3b_kernel grid=(448,1,1) block=(256,1,1) lds=83008
; @launch kernel=k4b_kernel grid=(160,1,1) block=(256,1,1) lds=111680
.amdgcn_target "amdgcn-amd-amdhsa--gfx950"
.text
.p2align 8
.globl interleave_layers__linear_kernel_hedgehog__glu_gated_geglu__prompt_kernel
.type interleave_layers__linear_kernel_hedgehog__glu_gated_geglu__prompt_kernel,@function
interleave_layers__linear_kernel_hedgehog__glu_gated_geglu__prompt_kernel:
    s_cmp_ge_u32 s2, 2460
    s_cbranch_scc1 interleave_layers__linear_kernel_hedgehog__glu_gated_geglu__prompt_kernel_end
    s_load_dwordx2 s[4:5], s[0:1], 80
    s_load_dwordx2 s[6:7], s[0:1], 64
    s_load_dwordx2 s[20:21], s[0:1], 0
    s_waitcnt lgkmcnt(0)
    s_mov_b32 s8, s4
    s_and_b32 s9, s5, 0xffff
    s_mov_b32 s10, 268435456
    s_mov_b32 s11, 0x20000
    s_mov_b32 s12, s6
    s_and_b32 s13, s7, 0xffff
    s_mov_b32 s14, 2621440
    s_mov_b32 s15, 0x20000
    s_mov_b32 s16, s20
    s_and_b32 s17, s21, 0xffff
    s_mov_b32 s18, 2621440
    s_mov_b32 s19, 0x20000
    s_load_dwordx2 s[20:21], s[0:1], 8
    s_load_dwordx2 s[22:23], s[0:1], 16
    s_load_dwordx2 s[24:25], s[0:1], 24
    s_load_dwordx2 s[26:27], s[0:1], 40
    s_load_dwordx2 s[28:29], s[0:1], 48
    s_load_dwordx2 s[30:31], s[0:1], 56
    s_waitcnt lgkmcnt(0)
    v_and_b32 v4, 63, v0
    v_and_b32 v2, 31, v0
    v_bfe_u32 v3, v0, 5, 1
    v_lshrrev_b32 v1, 6, v0
    s_nop 0
    v_readfirstlane_b32 s33, v1
    s_cmp_lt_u32 s2, 640
    s_cbranch_scc1 k0_qkv
    s_cmp_lt_u32 s2, 840
    s_cbranch_scc1 k0_wo
    s_cmp_lt_u32 s2, 1920
    s_cbranch_scc1 k0_gu
    s_cmp_lt_u32 s2, 2460
    s_cbranch_scc1 k0_wd
k0_qkv:
    s_sub_u32 s34, s2, 0
    s_lshl_b32 s34, s34, 2
    s_add_u32 s34, s34, s33
    s_mul_hi_u32 s35, s34, 107374183
    s_mul_i32 s36, s35, 40
    s_sub_u32 s36, s34, s36
    s_lshl_b32 s37, s34, 10
    s_add_u32 s37, s37, 0
    v_lshlrev_b32 v5, 4, v4
    s_lshl_b32 s38, s36, 4
    v_lshl_add_u32 v6, v3, 3, s38
    s_mov_b32 s40, s20
    s_and_b32 s41, s21, 0xffff
    s_mov_b32 s42, 2457600
    s_mov_b32 s43, 0x20000
    s_mov_b32 s44, s22
    s_and_b32 s45, s23, 0xffff
    s_mov_b32 s46, 25600
    s_mov_b32 s47, 0x20000
    s_lshr_b32 s39, s35, 1
    s_and_b32 s48, s35, 1
    s_lshl_b32 s48, s48, 4
    v_lshrrev_b32 v7, 3, v2
    v_lshlrev_b32 v7, 2, v7
    v_and_b32 v8, 3, v2
    v_add3_u32 v7, v7, v8, s48
    v_bfe_u32 v8, v2, 2, 1
    s_mul_i32 s49, s39, 20
    v_mul_u32_u24 v9, 640, v8
    v_add_u32 v9, s49, v9
    s_add_u32 s50, s49, 1280
    v_mov_b32 v10, s50
    v_cmp_gt_u32 vcc, 20, v7
    s_nop 1
    v_cndmask_b32 v9, v10, v9, vcc
    s_mov_b64 s[52:53], vcc
    v_mul_u32_u24 v10, 10, v8
    v_add_u32 v10, v10, v7
    v_subrev_u32 v10, 20, v10
    v_cmp_gt_u32 vcc, 30, v7
    s_nop 1
    v_mov_b32 v11, 99
    v_cndmask_b32 v10, v11, v10, vcc
    v_min_u32 v11, 19, v7
    s_mul_i32 s50, s39, 400
    v_add_u32 v11, s50, v11
    v_lshlrev_b32 v11, 1, v11
    v_mul_u32_u24 v6, 1920, v6
    v_add_u32 v6, v6, v9
    v_lshlrev_b32 v6, 1, v6
    v_mov_b32 v24, 0
    v_mov_b32 v25, 0
    v_mov_b32 v26, 0
    v_mov_b32 v27, 0
    v_mov_b32 v28, 0
    v_mov_b32 v29, 0
    v_mov_b32 v30, 0
    v_mov_b32 v31, 0
    buffer_load_ushort v40, v11, s[44:47], 0 offen offset:0
    buffer_load_ushort v41, v11, s[44:47], 0 offen offset:40
    buffer_load_ushort v42, v11, s[44:47], 0 offen offset:80
    buffer_load_ushort v43, v11, s[44:47], 0 offen offset:120
    buffer_load_ushort v44, v11, s[44:47], 0 offen offset:160
    buffer_load_ushort v45, v11, s[44:47], 0 offen offset:200
    buffer_load_ushort v46, v11, s[44:47], 0 offen offset:240
    buffer_load_ushort v47, v11, s[44:47], 0 offen offset:280
    buffer_load_ushort v48, v11, s[44:47], 0 offen offset:320
    buffer_load_ushort v49, v11, s[44:47], 0 offen offset:360
    buffer_load_ushort v50, v11, s[44:47], 0 offen offset:400
    buffer_load_ushort v51, v11, s[44:47], 0 offen offset:440
    buffer_load_ushort v52, v11, s[44:47], 0 offen offset:480
    buffer_load_ushort v53, v11, s[44:47], 0 offen offset:520
    buffer_load_ushort v54, v11, s[44:47], 0 offen offset:560
    buffer_load_ushort v55, v11, s[44:47], 0 offen offset:600
    buffer_load_ushort v56, v11, s[44:47], 0 offen offset:640
    buffer_load_ushort v57, v11, s[44:47], 0 offen offset:680
    buffer_load_ushort v58, v11, s[44:47], 0 offen offset:720
    buffer_load_ushort v59, v11, s[44:47], 0 offen offset:760
    s_mov_b32 s51, 0
    buffer_load_dwordx2 v[64:65], v6, s[40:43], s51 offen offset:0
    buffer_load_dwordx2 v[66:67], v6, s[40:43], s51 offen offset:8
    buffer_load_dwordx2 v[68:69], v6, s[40:43], s51 offen offset:16
    buffer_load_dwordx2 v[70:71], v6, s[40:43], s51 offen offset:24
    buffer_load_dwordx2 v[72:73], v6, s[40:43], s51 offen offset:32
    s_mov_b32 s51, 3840
    buffer_load_dwordx2 v[74:75], v6, s[40:43], s51 offen offset:0
    buffer_load_dwordx2 v[76:77], v6, s[40:43], s51 offen offset:8
    buffer_load_dwordx2 v[78:79], v6, s[40:43], s51 offen offset:16
    buffer_load_dwordx2 v[80:81], v6, s[40:43], s51 offen offset:24
    buffer_load_dwordx2 v[82:83], v6, s[40:43], s51 offen offset:32
    s_mov_b32 s51, 7680
    buffer_load_dwordx2 v[84:85], v6, s[40:43], s51 offen offset:0
    buffer_load_dwordx2 v[86:87], v6, s[40:43], s51 offen offset:8
    buffer_load_dwordx2 v[88:89], v6, s[40:43], s51 offen offset:16
    buffer_load_dwordx2 v[90:91], v6, s[40:43], s51 offen offset:24
    buffer_load_dwordx2 v[92:93], v6, s[40:43], s51 offen offset:32
    s_mov_b32 s51, 11520
    buffer_load_dwordx2 v[94:95], v6, s[40:43], s51 offen offset:0
    buffer_load_dwordx2 v[96:97], v6, s[40:43], s51 offen offset:8
    buffer_load_dwordx2 v[98:99], v6, s[40:43], s51 offen offset:16
    buffer_load_dwordx2 v[100:101], v6, s[40:43], s51 offen offset:24
    buffer_load_dwordx2 v[102:103], v6, s[40:43], s51 offen offset:32
    s_mov_b32 s51, 15360
    buffer_load_dwordx2 v[104:105], v6, s[40:43], s51 offen offset:0
    buffer_load_dwordx2 v[106:107], v6, s[40:43], s51 offen offset:8
    buffer_load_dwordx2 v[108:109], v6, s[40:43], s51 offen offset:16
    buffer_load_dwordx2 v[110:111], v6, s[40:43], s51 offen offset:24
    buffer_load_dwordx2 v[112:113], v6, s[40:43], s51 offen offset:32
    s_mov_b32 s51, 19200
    buffer_load_dwordx2 v[114:115], v6, s[40:43], s51 offen offset:0
    buffer_load_dwordx2 v[116:117], v6, s[40:43], s51 offen offset:8
    buffer_load_dwordx2 v[118:119], v6, s[40:43], s51 offen offset:16
    buffer_load_dwordx2 v[120:121], v6, s[40:43], s51 offen offset:24
    buffer_load_dwordx2 v[122:123], v6, s[40:43], s51 offen offset:32
    s_mov_b32 s51, 23040
    buffer_load_dwordx2 v[124:125], v6, s[40:43], s51 offen offset:0
    buffer_load_dwordx2 v[126:127], v6, s[40:43], s51 offen offset:8
    buffer_load_dwordx2 v[128:129], v6, s[40:43], s51 offen offset:16
    buffer_load_dwordx2 v[130:131], v6, s[40:43], s51 offen offset:24
    buffer_load_dwordx2 v[132:133], v6, s[40:43], s51 offen offset:32
    s_mov_b32 s51, 26880
    buffer_load_dwordx2 v[134:135], v6, s[40:43], s51 offen offset:0
    buffer_load_dwordx2 v[136:137], v6, s[40:43], s51 offen offset:8
    buffer_load_dwordx2 v[138:139], v6, s[40:43], s51 offen offset:16
    buffer_load_dwordx2 v[140:141], v6, s[40:43], s51 offen offset:24
    buffer_load_dwordx2 v[142:143], v6, s[40:43], s51 offen offset:32
    s_waitcnt vmcnt(0)
    v_cmp_eq_u32 vcc, 0, v10
    s_nop 1
    v_cndmask_b32 v33, 0, 1.0, vcc
    v_lshlrev_b32 v32, 16, v40
    v_cndmask_b32 v32, v33, v32, s[52:53]
    v_lshlrev_b32 v34, 16, v64
    v_fmac_f32 v24, v34, v32
    v_lshlrev_b32 v34, 16, v74
    v_fmac_f32 v25, v34, v32
    v_lshlrev_b32 v34, 16, v84
    v_fmac_f32 v26, v34, v32
    v_lshlrev_b32 v34, 16, v94
    v_fmac_f32 v27, v34, v32
    v_lshlrev_b32 v34, 16, v104
    v_fmac_f32 v28, v34, v32
    v_lshlrev_b32 v34, 16, v114
    v_fmac_f32 v29, v34, v32
    v_lshlrev_b32 v34, 16, v124
    v_fmac_f32 v30, v34, v32
    v_lshlrev_b32 v34, 16, v134
    v_fmac_f32 v31, v34, v32
    v_cmp_eq_u32 vcc, 1, v10
    s_nop 1
    v_cndmask_b32 v33, 0, 1.0, vcc
    v_lshlrev_b32 v32, 16, v41
    v_cndmask_b32 v32, v33, v32, s[52:53]
    v_and_b32 v34, 0xffff0000, v64
    v_fmac_f32 v24, v34, v32
    v_and_b32 v34, 0xffff0000, v74
    v_fmac_f32 v25, v34, v32
    v_and_b32 v34, 0xffff0000, v84
    v_fmac_f32 v26, v34, v32
    v_and_b32 v34, 0xffff0000, v94
    v_fmac_f32 v27, v34, v32
    v_and_b32 v34, 0xffff0000, v104
    v_fmac_f32 v28, v34, v32
    v_and_b32 v34, 0xffff0000, v114
    v_fmac_f32 v29, v34, v32
    v_and_b32 v34, 0xffff0000, v124
    v_fmac_f32 v30, v34, v32
    v_and_b32 v34, 0xffff0000, v134
    v_fmac_f32 v31, v34, v32
    v_cmp_eq_u32 vcc, 2, v10
    s_nop 1
    v_cndmask_b32 v33, 0, 1.0, vcc
    v_lshlrev_b32 v32, 16, v42
    v_cndmask_b32 v32, v33, v32, s[52:53]
    v_lshlrev_b32 v34, 16, v65
    v_fmac_f32 v24, v34, v32
    v_lshlrev_b32 v34, 16, v75
    v_fmac_f32 v25, v34, v32
    v_lshlrev_b32 v34, 16, v85
    v_fmac_f32 v26, v34, v32
    v_lshlrev_b32 v34, 16, v95
    v_fmac_f32 v27, v34, v32
    v_lshlrev_b32 v34, 16, v105
    v_fmac_f32 v28, v34, v32
    v_lshlrev_b32 v34, 16, v115
    v_fmac_f32 v29, v34, v32
    v_lshlrev_b32 v34, 16, v125
    v_fmac_f32 v30, v34, v32
    v_lshlrev_b32 v34, 16, v135
    v_fmac_f32 v31, v34, v32
    v_cmp_eq_u32 vcc, 3, v10
    s_nop 1
    v_cndmask_b32 v33, 0, 1.0, vcc
    v_lshlrev_b32 v32, 16, v43
    v_cndmask_b32 v32, v33, v32, s[52:53]
    v_and_b32 v34, 0xffff0000, v65
    v_fmac_f32 v24, v34, v32
    v_and_b32 v34, 0xffff0000, v75
    v_fmac_f32 v25, v34, v32
    v_and_b32 v34, 0xffff0000, v85
    v_fmac_f32 v26, v34, v32
    v_and_b32 v34, 0xffff0000, v95
    v_fmac_f32 v27, v34, v32
    v_and_b32 v34, 0xffff0000, v105
    v_fmac_f32 v28, v34, v32
    v_and_b32 v34, 0xffff0000, v115
    v_fmac_f32 v29, v34, v32
    v_and_b32 v34, 0xffff0000, v125
    v_fmac_f32 v30, v34, v32
    v_and_b32 v34, 0xffff0000, v135
    v_fmac_f32 v31, v34, v32
    v_cmp_eq_u32 vcc, 4, v10
    s_nop 1
    v_cndmask_b32 v33, 0, 1.0, vcc
    v_lshlrev_b32 v32, 16, v44
    v_cndmask_b32 v32, v33, v32, s[52:53]
    v_lshlrev_b32 v34, 16, v66
    v_fmac_f32 v24, v34, v32
    v_lshlrev_b32 v34, 16, v76
    v_fmac_f32 v25, v34, v32
    v_lshlrev_b32 v34, 16, v86
    v_fmac_f32 v26, v34, v32
    v_lshlrev_b32 v34, 16, v96
    v_fmac_f32 v27, v34, v32
    v_lshlrev_b32 v34, 16, v106
    v_fmac_f32 v28, v34, v32
    v_lshlrev_b32 v34, 16, v116
    v_fmac_f32 v29, v34, v32
    v_lshlrev_b32 v34, 16, v126
    v_fmac_f32 v30, v34, v32
    v_lshlrev_b32 v34, 16, v136
    v_fmac_f32 v31, v34, v32
    v_cmp_eq_u32 vcc, 5, v10
    s_nop 1
    v_cndmask_b32 v33, 0, 1.0, vcc
    v_lshlrev_b32 v32, 16, v45
    v_cndmask_b32 v32, v33, v32, s[52:53]
    v_and_b32 v34, 0xffff0000, v66
    v_fmac_f32 v24, v34, v32
    v_and_b32 v34, 0xffff0000, v76
    v_fmac_f32 v25, v34, v32
    v_and_b32 v34, 0xffff0000, v86
    v_fmac_f32 v26, v34, v32
    v_and_b32 v34, 0xffff0000, v96
    v_fmac_f32 v27, v34, v32
    v_and_b32 v34, 0xffff0000, v106
    v_fmac_f32 v28, v34, v32
    v_and_b32 v34, 0xffff0000, v116
    v_fmac_f32 v29, v34, v32
    v_and_b32 v34, 0xffff0000, v126
    v_fmac_f32 v30, v34, v32
    v_and_b32 v34, 0xffff0000, v136
    v_fmac_f32 v31, v34, v32
    v_cmp_eq_u32 vcc, 6, v10
    s_nop 1
    v_cndmask_b32 v33, 0, 1.0, vcc
    v_lshlrev_b32 v32, 16, v46
    v_cndmask_b32 v32, v33, v32, s[52:53]
    v_lshlrev_b32 v34, 16, v67
    v_fmac_f32 v24, v34, v32
    v_lshlrev_b32 v34, 16, v77
    v_fmac_f32 v25, v34, v32
    v_lshlrev_b32 v34, 16, v87
    v_fmac_f32 v26, v34, v32
    v_lshlrev_b32 v34, 16, v97
    v_fmac_f32 v27, v34, v32
    v_lshlrev_b32 v34, 16, v107
    v_fmac_f32 v28, v34, v32
    v_lshlrev_b32 v34, 16, v117
    v_fmac_f32 v29, v34, v32
    v_lshlrev_b32 v34, 16, v127
    v_fmac_f32 v30, v34, v32
    v_lshlrev_b32 v34, 16, v137
    v_fmac_f32 v31, v34, v32
    v_cmp_eq_u32 vcc, 7, v10
    s_nop 1
    v_cndmask_b32 v33, 0, 1.0, vcc
    v_lshlrev_b32 v32, 16, v47
    v_cndmask_b32 v32, v33, v32, s[52:53]
    v_and_b32 v34, 0xffff0000, v67
    v_fmac_f32 v24, v34, v32
    v_and_b32 v34, 0xffff0000, v77
    v_fmac_f32 v25, v34, v32
    v_and_b32 v34, 0xffff0000, v87
    v_fmac_f32 v26, v34, v32
    v_and_b32 v34, 0xffff0000, v97
    v_fmac_f32 v27, v34, v32
    v_and_b32 v34, 0xffff0000, v107
    v_fmac_f32 v28, v34, v32
    v_and_b32 v34, 0xffff0000, v117
    v_fmac_f32 v29, v34, v32
    v_and_b32 v34, 0xffff0000, v127
    v_fmac_f32 v30, v34, v32
    v_and_b32 v34, 0xffff0000, v137
    v_fmac_f32 v31, v34, v32
    v_cmp_eq_u32 vcc, 8, v10
    s_nop 1
    v_cndmask_b32 v33, 0, 1.0, vcc
    v_lshlrev_b32 v32, 16, v48
    v_cndmask_b32 v32, v33, v32, s[52:53]
    v_lshlrev_b32 v34, 16, v68
    v_fmac_f32 v24, v34, v32
    v_lshlrev_b32 v34, 16, v78
    v_fmac_f32 v25, v34, v32
    v_lshlrev_b32 v34, 16, v88
    v_fmac_f32 v26, v34, v32
    v_lshlrev_b32 v34, 16, v98
    v_fmac_f32 v27, v34, v32
    v_lshlrev_b32 v34, 16, v108
    v_fmac_f32 v28, v34, v32
    v_lshlrev_b32 v34, 16, v118
    v_fmac_f32 v29, v34, v32
    v_lshlrev_b32 v34, 16, v128
    v_fmac_f32 v30, v34, v32
    v_lshlrev_b32 v34, 16, v138
    v_fmac_f32 v31, v34, v32
    v_cmp_eq_u32 vcc, 9, v10
    s_nop 1
    v_cndmask_b32 v33, 0, 1.0, vcc
    v_lshlrev_b32 v32, 16, v49
    v_cndmask_b32 v32, v33, v32, s[52:53]
    v_and_b32 v34, 0xffff0000, v68
    v_fmac_f32 v24, v34, v32
    v_and_b32 v34, 0xffff0000, v78
    v_fmac_f32 v25, v34, v32
    v_and_b32 v34, 0xffff0000, v88
    v_fmac_f32 v26, v34, v32
    v_and_b32 v34, 0xffff0000, v98
    v_fmac_f32 v27, v34, v32
    v_and_b32 v34, 0xffff0000, v108
    v_fmac_f32 v28, v34, v32
    v_and_b32 v34, 0xffff0000, v118
    v_fmac_f32 v29, v34, v32
    v_and_b32 v34, 0xffff0000, v128
    v_fmac_f32 v30, v34, v32
    v_and_b32 v34, 0xffff0000, v138
    v_fmac_f32 v31, v34, v32
    v_cmp_eq_u32 vcc, 10, v10
    s_nop 1
    v_cndmask_b32 v33, 0, 1.0, vcc
    v_lshlrev_b32 v32, 16, v50
    v_cndmask_b32 v32, v33, v32, s[52:53]
    v_lshlrev_b32 v34, 16, v69
    v_fmac_f32 v24, v34, v32
    v_lshlrev_b32 v34, 16, v79
    v_fmac_f32 v25, v34, v32
    v_lshlrev_b32 v34, 16, v89
    v_fmac_f32 v26, v34, v32
    v_lshlrev_b32 v34, 16, v99
    v_fmac_f32 v27, v34, v32
    v_lshlrev_b32 v34, 16, v109
    v_fmac_f32 v28, v34, v32
    v_lshlrev_b32 v34, 16, v119
    v_fmac_f32 v29, v34, v32
    v_lshlrev_b32 v34, 16, v129
    v_fmac_f32 v30, v34, v32
    v_lshlrev_b32 v34, 16, v139
    v_fmac_f32 v31, v34, v32
    v_cmp_eq_u32 vcc, 11, v10
    s_nop 1
    v_cndmask_b32 v33, 0, 1.0, vcc
    v_lshlrev_b32 v32, 16, v51
    v_cndmask_b32 v32, v33, v32, s[52:53]
    v_and_b32 v34, 0xffff0000, v69
    v_fmac_f32 v24, v34, v32
    v_and_b32 v34, 0xffff0000, v79
    v_fmac_f32 v25, v34, v32
    v_and_b32 v34, 0xffff0000, v89
    v_fmac_f32 v26, v34, v32
    v_and_b32 v34, 0xffff0000, v99
    v_fmac_f32 v27, v34, v32
    v_and_b32 v34, 0xffff0000, v109
    v_fmac_f32 v28, v34, v32
    v_and_b32 v34, 0xffff0000, v119
    v_fmac_f32 v29, v34, v32
    v_and_b32 v34, 0xffff0000, v129
    v_fmac_f32 v30, v34, v32
    v_and_b32 v34, 0xffff0000, v139
    v_fmac_f32 v31, v34, v32
    v_cmp_eq_u32 vcc, 12, v10
    s_nop 1
    v_cndmask_b32 v33, 0, 1.0, vcc
    v_lshlrev_b32 v32, 16, v52
    v_cndmask_b32 v32, v33, v32, s[52:53]
    v_lshlrev_b32 v34, 16, v70
    v_fmac_f32 v24, v34, v32
    v_lshlrev_b32 v34, 16, v80
    v_fmac_f32 v25, v34, v32
    v_lshlrev_b32 v34, 16, v90
    v_fmac_f32 v26, v34, v32
    v_lshlrev_b32 v34, 16, v100
    v_fmac_f32 v27, v34, v32
    v_lshlrev_b32 v34, 16, v110
    v_fmac_f32 v28, v34, v32
    v_lshlrev_b32 v34, 16, v120
    v_fmac_f32 v29, v34, v32
    v_lshlrev_b32 v34, 16, v130
    v_fmac_f32 v30, v34, v32
    v_lshlrev_b32 v34, 16, v140
    v_fmac_f32 v31, v34, v32
    v_cmp_eq_u32 vcc, 13, v10
    s_nop 1
    v_cndmask_b32 v33, 0, 1.0, vcc
    v_lshlrev_b32 v32, 16, v53
    v_cndmask_b32 v32, v33, v32, s[52:53]
    v_and_b32 v34, 0xffff0000, v70
    v_fmac_f32 v24, v34, v32
    v_and_b32 v34, 0xffff0000, v80
    v_fmac_f32 v25, v34, v32
    v_and_b32 v34, 0xffff0000, v90
    v_fmac_f32 v26, v34, v32
    v_and_b32 v34, 0xffff0000, v100
    v_fmac_f32 v27, v34, v32
    v_and_b32 v34, 0xffff0000, v110
    v_fmac_f32 v28, v34, v32
    v_and_b32 v34, 0xffff0000, v120
    v_fmac_f32 v29, v34, v32
    v_and_b32 v34, 0xffff0000, v130
    v_fmac_f32 v30, v34, v32
    v_and_b32 v34, 0xffff0000, v140
    v_fmac_f32 v31, v34, v32
    v_cmp_eq_u32 vcc, 14, v10
    s_nop 1
    v_cndmask_b32 v33, 0, 1.0, vcc
    v_lshlrev_b32 v32, 16, v54
    v_cndmask_b32 v32, v33, v32, s[52:53]
    v_lshlrev_b32 v34, 16, v71
    v_fmac_f32 v24, v34, v32
    v_lshlrev_b32 v34, 16, v81
    v_fmac_f32 v25, v34, v32
    v_lshlrev_b32 v34, 16, v91
    v_fmac_f32 v26, v34, v32
    v_lshlrev_b32 v34, 16, v101
    v_fmac_f32 v27, v34, v32
    v_lshlrev_b32 v34, 16, v111
    v_fmac_f32 v28, v34, v32
    v_lshlrev_b32 v34, 16, v121
    v_fmac_f32 v29, v34, v32
    v_lshlrev_b32 v34, 16, v131
    v_fmac_f32 v30, v34, v32
    v_lshlrev_b32 v34, 16, v141
    v_fmac_f32 v31, v34, v32
    v_cmp_eq_u32 vcc, 15, v10
    s_nop 1
    v_cndmask_b32 v33, 0, 1.0, vcc
    v_lshlrev_b32 v32, 16, v55
    v_cndmask_b32 v32, v33, v32, s[52:53]
    v_and_b32 v34, 0xffff0000, v71
    v_fmac_f32 v24, v34, v32
    v_and_b32 v34, 0xffff0000, v81
    v_fmac_f32 v25, v34, v32
    v_and_b32 v34, 0xffff0000, v91
    v_fmac_f32 v26, v34, v32
    v_and_b32 v34, 0xffff0000, v101
    v_fmac_f32 v27, v34, v32
    v_and_b32 v34, 0xffff0000, v111
    v_fmac_f32 v28, v34, v32
    v_and_b32 v34, 0xffff0000, v121
    v_fmac_f32 v29, v34, v32
    v_and_b32 v34, 0xffff0000, v131
    v_fmac_f32 v30, v34, v32
    v_and_b32 v34, 0xffff0000, v141
    v_fmac_f32 v31, v34, v32
    v_cmp_eq_u32 vcc, 16, v10
    s_nop 1
    v_cndmask_b32 v33, 0, 1.0, vcc
    v_lshlrev_b32 v32, 16, v56
    v_cndmask_b32 v32, v33, v32, s[52:53]
    v_lshlrev_b32 v34, 16, v72
    v_fmac_f32 v24, v34, v32
    v_lshlrev_b32 v34, 16, v82
    v_fmac_f32 v25, v34, v32
    v_lshlrev_b32 v34, 16, v92
    v_fmac_f32 v26, v34, v32
    v_lshlrev_b32 v34, 16, v102
    v_fmac_f32 v27, v34, v32
    v_lshlrev_b32 v34, 16, v112
    v_fmac_f32 v28, v34, v32
    v_lshlrev_b32 v34, 16, v122
    v_fmac_f32 v29, v34, v32
    v_lshlrev_b32 v34, 16, v132
    v_fmac_f32 v30, v34, v32
    v_lshlrev_b32 v34, 16, v142
    v_fmac_f32 v31, v34, v32
    v_cmp_eq_u32 vcc, 17, v10
    s_nop 1
    v_cndmask_b32 v33, 0, 1.0, vcc
    v_lshlrev_b32 v32, 16, v57
    v_cndmask_b32 v32, v33, v32, s[52:53]
    v_and_b32 v34, 0xffff0000, v72
    v_fmac_f32 v24, v34, v32
    v_and_b32 v34, 0xffff0000, v82
    v_fmac_f32 v25, v34, v32
    v_and_b32 v34, 0xffff0000, v92
    v_fmac_f32 v26, v34, v32
    v_and_b32 v34, 0xffff0000, v102
    v_fmac_f32 v27, v34, v32
    v_and_b32 v34, 0xffff0000, v112
    v_fmac_f32 v28, v34, v32
    v_and_b32 v34, 0xffff0000, v122
    v_fmac_f32 v29, v34, v32
    v_and_b32 v34, 0xffff0000, v132
    v_fmac_f32 v30, v34, v32
    v_and_b32 v34, 0xffff0000, v142
    v_fmac_f32 v31, v34, v32
    v_cmp_eq_u32 vcc, 18, v10
    s_nop 1
    v_cndmask_b32 v33, 0, 1.0, vcc
    v_lshlrev_b32 v32, 16, v58
    v_cndmask_b32 v32, v33, v32, s[52:53]
    v_lshlrev_b32 v34, 16, v73
    v_fmac_f32 v24, v34, v32
    v_lshlrev_b32 v34, 16, v83
    v_fmac_f32 v25, v34, v32
    v_lshlrev_b32 v34, 16, v93
    v_fmac_f32 v26, v34, v32
    v_lshlrev_b32 v34, 16, v103
    v_fmac_f32 v27, v34, v32
    v_lshlrev_b32 v34, 16, v113
    v_fmac_f32 v28, v34, v32
    v_lshlrev_b32 v34, 16, v123
    v_fmac_f32 v29, v34, v32
    v_lshlrev_b32 v34, 16, v133
    v_fmac_f32 v30, v34, v32
    v_lshlrev_b32 v34, 16, v143
    v_fmac_f32 v31, v34, v32
    v_cmp_eq_u32 vcc, 19, v10
    s_nop 1
    v_cndmask_b32 v33, 0, 1.0, vcc
    v_lshlrev_b32 v32, 16, v59
    v_cndmask_b32 v32, v33, v32, s[52:53]
    v_and_b32 v34, 0xffff0000, v73
    v_fmac_f32 v24, v34, v32
    v_and_b32 v34, 0xffff0000, v83
    v_fmac_f32 v25, v34, v32
    v_and_b32 v34, 0xffff0000, v93
    v_fmac_f32 v26, v34, v32
    v_and_b32 v34, 0xffff0000, v103
    v_fmac_f32 v27, v34, v32
    v_and_b32 v34, 0xffff0000, v113
    v_fmac_f32 v28, v34, v32
    v_and_b32 v34, 0xffff0000, v123
    v_fmac_f32 v29, v34, v32
    v_and_b32 v34, 0xffff0000, v133
    v_fmac_f32 v30, v34, v32
    v_and_b32 v34, 0xffff0000, v143
    v_fmac_f32 v31, v34, v32
    v_cvt_pk_bf16_f32 v16, v24, v25
    v_cvt_pk_bf16_f32 v17, v26, v27
    v_cvt_pk_bf16_f32 v18, v28, v29
    v_cvt_pk_bf16_f32 v19, v30, v31
    buffer_store_dwordx4 v[16:19], v5, s[8:11], s37 offen
    s_branch interleave_layers__linear_kernel_hedgehog__glu_gated_geglu__prompt_kernel_end
k0_wo:
    s_sub_u32 s34, s2, 640
    s_lshl_b32 s34, s34, 2
    s_add_u32 s34, s34, s33
    s_mul_hi_u32 s35, s34, 107374183
    s_mul_i32 s36, s35, 40
    s_sub_u32 s36, s34, s36
    s_lshl_b32 s37, s34, 10
    s_add_u32 s37, s37, 2621440
    v_lshlrev_b32 v5, 4, v4
    s_lshl_b32 s38, s36, 4
    v_lshl_add_u32 v6, v3, 3, s38
    s_mov_b32 s39, s35
    s_mov_b32 s40, s24
    s_and_b32 s41, s25, 0xffff
    s_mov_b32 s42, 819200
    s_mov_b32 s43, 0x20000
    s_lshl_b32 s39, s39, 5
    v_mul_u32_u24 v6, 640, v6
    v_add3_u32 v6, v6, v2, s39
    v_lshlrev_b32 v6, 1, v6
    s_mov_b32 s45, 0
    buffer_load_ushort v8, v6, s[40:43], s45 offen
    s_mov_b32 s45, 1280
    buffer_load_ushort v9, v6, s[40:43], s45 offen
    s_mov_b32 s45, 2560
    buffer_load_ushort v10, v6, s[40:43], s45 offen
    s_mov_b32 s45, 3840
    buffer_load_ushort v11, v6, s[40:43], s45 offen
    s_mov_b32 s45, 5120
    buffer_load_ushort v12, v6, s[40:43], s45 offen
    s_mov_b32 s45, 6400
    buffer_load_ushort v13, v6, s[40:43], s45 offen
    s_mov_b32 s45, 7680
    buffer_load_ushort v14, v6, s[40:43], s45 offen
    s_mov_b32 s45, 8960
    buffer_load_ushort v15, v6, s[40:43], s45 offen
    s_waitcnt vmcnt(0)
    v_lshl_or_b32 v16, v9, 16, v8
    v_lshl_or_b32 v17, v11, 16, v10
    v_lshl_or_b32 v18, v13, 16, v12
    v_lshl_or_b32 v19, v15, 16, v14
    buffer_store_dwordx4 v[16:19], v5, s[8:11], s37 offen
    s_branch interleave_layers__linear_kernel_hedgehog__glu_gated_geglu__prompt_kernel_end
k0_gu:
    s_sub_u32 s34, s2, 840
    s_lshl_b32 s34, s34, 2
    s_add_u32 s34, s34, s33
    s_mul_hi_u32 s35, s34, 107374183
    s_mul_i32 s36, s35, 40
    s_sub_u32 s36, s34, s36
    s_lshl_b32 s37, s34, 10
    s_add_u32 s37, s37, 3440640
    v_lshlrev_b32 v5, 4, v4
    s_lshl_b32 s38, s36, 4
    v_lshl_add_u32 v6, v3, 3, s38
    s_lshr_b32 s39, s35, 1
    s_and_b32 s44, s35, 1
    s_cmp_eq_u32 s44, 0
    s_cselect_b32 s46, s26, s28
    s_cselect_b32 s47, s27, s29
    s_mov_b32 s40, s46
    s_and_b32 s41, s47, 0xffff
    s_mov_b32 s42, 2211840
    s_mov_b32 s43, 0x20000
    s_lshl_b32 s39, s39, 5
    v_mul_u32_u24 v6, 1728, v6
    v_add3_u32 v6, v6, v2, s39
    v_lshlrev_b32 v6, 1, v6
    s_mov_b32 s45, 0
    buffer_load_ushort v8, v6, s[40:43], s45 offen
    s_mov_b32 s45, 3456
    buffer_load_ushort v9, v6, s[40:43], s45 offen
    s_mov_b32 s45, 6912
    buffer_load_ushort v10, v6, s[40:43], s45 offen
    s_mov_b32 s45, 10368
    buffer_load_ushort v11, v6, s[40:43], s45 offen
    s_mov_b32 s45, 13824
    buffer_load_ushort v12, v6, s[40:43], s45 offen
    s_mov_b32 s45, 17280
    buffer_load_ushort v13, v6, s[40:43], s45 offen
    s_mov_b32 s45, 20736
    buffer_load_ushort v14, v6, s[40:43], s45 offen
    s_mov_b32 s45, 24192
    buffer_load_ushort v15, v6, s[40:43], s45 offen
    s_waitcnt vmcnt(0)
    v_lshl_or_b32 v16, v9, 16, v8
    v_lshl_or_b32 v17, v11, 16, v10
    v_lshl_or_b32 v18, v13, 16, v12
    v_lshl_or_b32 v19, v15, 16, v14
    buffer_store_dwordx4 v[16:19], v5, s[8:11], s37 offen
    s_branch interleave_layers__linear_kernel_hedgehog__glu_gated_geglu__prompt_kernel_end
k0_wd:
    s_sub_u32 s34, s2, 1920
    s_lshl_b32 s34, s34, 2
    s_add_u32 s34, s34, s33
    s_mul_hi_u32 s35, s34, 39768216
    s_mul_i32 s36, s35, 108
    s_sub_u32 s36, s34, s36
    s_lshl_b32 s37, s34, 10
    s_add_u32 s37, s37, 7864320
    v_lshlrev_b32 v5, 4, v4
    s_lshl_b32 s38, s36, 4
    v_lshl_add_u32 v6, v3, 3, s38
    s_mov_b32 s39, s35
    s_mov_b32 s40, s30
    s_and_b32 s41, s31, 0xffff
    s_mov_b32 s42, 2211840
    s_mov_b32 s43, 0x20000
    s_lshl_b32 s39, s39, 5
    v_mul_u32_u24 v6, 640, v6
    v_add3_u32 v6, v6, v2, s39
    v_lshlrev_b32 v6, 1, v6
    s_mov_b32 s45, 0
    buffer_load_ushort v8, v6, s[40:43], s45 offen
    s_mov_b32 s45, 1280
    buffer_load_ushort v9, v6, s[40:43], s45 offen
    s_mov_b32 s45, 2560
    buffer_load_ushort v10, v6, s[40:43], s45 offen
    s_mov_b32 s45, 3840
    buffer_load_ushort v11, v6, s[40:43], s45 offen
    s_mov_b32 s45, 5120
    buffer_load_ushort v12, v6, s[40:43], s45 offen
    s_mov_b32 s45, 6400
    buffer_load_ushort v13, v6, s[40:43], s45 offen
    s_mov_b32 s45, 7680
    buffer_load_ushort v14, v6, s[40:43], s45 offen
    s_mov_b32 s45, 8960
    buffer_load_ushort v15, v6, s[40:43], s45 offen
    s_waitcnt vmcnt(0)
    v_lshl_or_b32 v16, v9, 16, v8
    v_lshl_or_b32 v17, v11, 16, v10
    v_lshl_or_b32 v18, v13, 16, v12
    v_lshl_or_b32 v19, v15, 16, v14
    buffer_store_dwordx4 v[16:19], v5, s[8:11], s37 offen
    s_branch interleave_layers__linear_kernel_hedgehog__glu_gated_geglu__prompt_kernel_end
interleave_layers__linear_kernel_hedgehog__glu_gated_geglu__prompt_kernel_end:
    s_endpgm
.p2align 8
.globl k1a_kernel
.type k1a_kernel,@function
k1a_kernel:
    s_cmp_ge_u32 s2, 256
    s_cbranch_scc1 k1a_kernel_end
    s_load_dwordx2 s[4:5], s[0:1], 80
    s_load_dwordx2 s[6:7], s[0:1], 64
    s_load_dwordx2 s[20:21], s[0:1], 0
    s_waitcnt lgkmcnt(0)
    s_mov_b32 s8, s4
    s_and_b32 s9, s5, 0xffff
    s_mov_b32 s10, 268435456
    s_mov_b32 s11, 0x20000
    s_mov_b32 s12, s6
    s_and_b32 s13, s7, 0xffff
    s_mov_b32 s14, 2621440
    s_mov_b32 s15, 0x20000
    s_mov_b32 s16, s20
    s_and_b32 s17, s21, 0xffff
    s_mov_b32 s18, 2621440
    s_mov_b32 s19, 0x20000
    v_lshrrev_b32 v1, 6, v0
    s_nop 0
    v_readfirstlane_b32 s32, v1
    v_and_b32 v2, 31, v0
    v_bfe_u32 v3, v0, 5, 1
    v_and_b32 v4, 63, v0
    v_lshlrev_b32 v5, 4, v4
    s_lshr_b32 s33, s2, 3
    s_lshl_b32 s34, s33, 6
    s_and_b32 s35, s2, 7
    s_lshl_b32 s35, s35, 2
    s_add_u32 s35, s35, s32
    v_lshrrev_b32 v6, 2, v0
    v_and_b32 v7, 3, v0
    v_add_u32 v8, s34, v6
    v_mul_u32_u24 v8, 1280, v8
    v_lshl_add_u32 v8, v7, 4, v8
    s_mov_b32 s30, 0
    buffer_load_dwordx4 v[16:19], v8, s[16:19], s30 offen offset:0
    buffer_load_dwordx4 v[20:23], v8, s[16:19], s30 offen offset:64
    buffer_load_dwordx4 v[24:27], v8, s[16:19], s30 offen offset:128
    buffer_load_dwordx4 v[28:31], v8, s[16:19], s30 offen offset:192
    buffer_load_dwordx4 v[32:35], v8, s[16:19], s30 offen offset:256
    buffer_load_dwordx4 v[36:39], v8, s[16:19], s30 offen offset:320
    buffer_load_dwordx4 v[40:43], v8, s[16:19], s30 offen offset:384
    buffer_load_dwordx4 v[44:47], v8, s[16:19], s30 offen offset:448
    buffer_load_dwordx4 v[48:51], v8, s[16:19], s30 offen offset:512
    buffer_load_dwordx4 v[52:55], v8, s[16:19], s30 offen offset:576
    buffer_load_dwordx4 v[56:59], v8, s[16:19], s30 offen offset:640
    buffer_load_dwordx4 v[60:63], v8, s[16:19], s30 offen offset:704
    buffer_load_dwordx4 v[64:67], v8, s[16:19], s30 offen offset:768
    buffer_load_dwordx4 v[68:71], v8, s[16:19], s30 offen offset:832
    buffer_load_dwordx4 v[72:75], v8, s[16:19], s30 offen offset:896
    buffer_load_dwordx4 v[76:79], v8, s[16:19], s30 offen offset:960
    buffer_load_dwordx4 v[80:83], v8, s[16:19], s30 offen offset:1024
    buffer_load_dwordx4 v[84:87], v8, s[16:19], s30 offen offset:1088
    buffer_load_dwordx4 v[88:91], v8, s[16:19], s30 offen offset:1152
    buffer_load_dwordx4 v[92:95], v8, s[16:19], s30 offen offset:1216
    v_mul_u32_u24 v9, 1296, v6
    v_lshl_add_u32 v9, v7, 4, v9
    v_mov_b32 v10, 0
    v_mov_b32 v11, 0
    v_mov_b32 v12, 0x3f803f80
    s_waitcnt vmcnt(0)
    v_dot2c_f32_bf16 v10, v16, v12
    v_dot2c_f32_bf16 v11, v16, v16
    v_dot2c_f32_bf16 v10, v17, v12
    v_dot2c_f32_bf16 v11, v17, v17
    v_dot2c_f32_bf16 v10, v18, v12
    v_dot2c_f32_bf16 v11, v18, v18
    v_dot2c_f32_bf16 v10, v19, v12
    v_dot2c_f32_bf16 v11, v19, v19
    v_dot2c_f32_bf16 v10, v20, v12
    v_dot2c_f32_bf16 v11, v20, v20
    v_dot2c_f32_bf16 v10, v21, v12
    v_dot2c_f32_bf16 v11, v21, v21
    v_dot2c_f32_bf16 v10, v22, v12
    v_dot2c_f32_bf16 v11, v22, v22
    v_dot2c_f32_bf16 v10, v23, v12
    v_dot2c_f32_bf16 v11, v23, v23
    v_dot2c_f32_bf16 v10, v24, v12
    v_dot2c_f32_bf16 v11, v24, v24
    v_dot2c_f32_bf16 v10, v25, v12
    v_dot2c_f32_bf16 v11, v25, v25
    v_dot2c_f32_bf16 v10, v26, v12
    v_dot2c_f32_bf16 v11, v26, v26
    v_dot2c_f32_bf16 v10, v27, v12
    v_dot2c_f32_bf16 v11, v27, v27
    v_dot2c_f32_bf16 v10, v28, v12
    v_dot2c_f32_bf16 v11, v28, v28
    v_dot2c_f32_bf16 v10, v29, v12
    v_dot2c_f32_bf16 v11, v29, v29
    v_dot2c_f32_bf16 v10, v30, v12
    v_dot2c_f32_bf16 v11, v30, v30
    v_dot2c_f32_bf16 v10, v31, v12
    v_dot2c_f32_bf16 v11, v31, v31
    v_dot2c_f32_bf16 v10, v32, v12
    v_dot2c_f32_bf16 v11, v32, v32
    v_dot2c_f32_bf16 v10, v33, v12
    v_dot2c_f32_bf16 v11, v33, v33
    v_dot2c_f32_bf16 v10, v34, v12
    v_dot2c_f32_bf16 v11, v34, v34
    v_dot2c_f32_bf16 v10, v35, v12
    v_dot2c_f32_bf16 v11, v35, v35
    v_dot2c_f32_bf16 v10, v36, v12
    v_dot2c_f32_bf16 v11, v36, v36
    v_dot2c_f32_bf16 v10, v37, v12
    v_dot2c_f32_bf16 v11, v37, v37
    v_dot2c_f32_bf16 v10, v38, v12
    v_dot2c_f32_bf16 v11, v38, v38
    v_dot2c_f32_bf16 v10, v39, v12
    v_dot2c_f32_bf16 v11, v39, v39
    v_dot2c_f32_bf16 v10, v40, v12
    v_dot2c_f32_bf16 v11, v40, v40
    v_dot2c_f32_bf16 v10, v41, v12
    v_dot2c_f32_bf16 v11, v41, v41
    v_dot2c_f32_bf16 v10, v42, v12
    v_dot2c_f32_bf16 v11, v42, v42
    v_dot2c_f32_bf16 v10, v43, v12
    v_dot2c_f32_bf16 v11, v43, v43
    v_dot2c_f32_bf16 v10, v44, v12
    v_dot2c_f32_bf16 v11, v44, v44
    v_dot2c_f32_bf16 v10, v45, v12
    v_dot2c_f32_bf16 v11, v45, v45
    v_dot2c_f32_bf16 v10, v46, v12
    v_dot2c_f32_bf16 v11, v46, v46
    v_dot2c_f32_bf16 v10, v47, v12
    v_dot2c_f32_bf16 v11, v47, v47
    v_dot2c_f32_bf16 v10, v48, v12
    v_dot2c_f32_bf16 v11, v48, v48
    v_dot2c_f32_bf16 v10, v49, v12
    v_dot2c_f32_bf16 v11, v49, v49
    v_dot2c_f32_bf16 v10, v50, v12
    v_dot2c_f32_bf16 v11, v50, v50
    v_dot2c_f32_bf16 v10, v51, v12
    v_dot2c_f32_bf16 v11, v51, v51
    v_dot2c_f32_bf16 v10, v52, v12
    v_dot2c_f32_bf16 v11, v52, v52
    v_dot2c_f32_bf16 v10, v53, v12
    v_dot2c_f32_bf16 v11, v53, v53
    v_dot2c_f32_bf16 v10, v54, v12
    v_dot2c_f32_bf16 v11, v54, v54
    v_dot2c_f32_bf16 v10, v55, v12
    v_dot2c_f32_bf16 v11, v55, v55
    v_dot2c_f32_bf16 v10, v56, v12
    v_dot2c_f32_bf16 v11, v56, v56
    v_dot2c_f32_bf16 v10, v57, v12
    v_dot2c_f32_bf16 v11, v57, v57
    v_dot2c_f32_bf16 v10, v58, v12
    v_dot2c_f32_bf16 v11, v58, v58
    v_dot2c_f32_bf16 v10, v59, v12
    v_dot2c_f32_bf16 v11, v59, v59
    v_dot2c_f32_bf16 v10, v60, v12
    v_dot2c_f32_bf16 v11, v60, v60
    v_dot2c_f32_bf16 v10, v61, v12
    v_dot2c_f32_bf16 v11, v61, v61
    v_dot2c_f32_bf16 v10, v62, v12
    v_dot2c_f32_bf16 v11, v62, v62
    v_dot2c_f32_bf16 v10, v63, v12
    v_dot2c_f32_bf16 v11, v63, v63
    v_dot2c_f32_bf16 v10, v64, v12
    v_dot2c_f32_bf16 v11, v64, v64
    v_dot2c_f32_bf16 v10, v65, v12
    v_dot2c_f32_bf16 v11, v65, v65
    v_dot2c_f32_bf16 v10, v66, v12
    v_dot2c_f32_bf16 v11, v66, v66
    v_dot2c_f32_bf16 v10, v67, v12
    v_dot2c_f32_bf16 v11, v67, v67
    v_dot2c_f32_bf16 v10, v68, v12
    v_dot2c_f32_bf16 v11, v68, v68
    v_dot2c_f32_bf16 v10, v69, v12
    v_dot2c_f32_bf16 v11, v69, v69
    v_dot2c_f32_bf16 v10, v70, v12
    v_dot2c_f32_bf16 v11, v70, v70
    v_dot2c_f32_bf16 v10, v71, v12
    v_dot2c_f32_bf16 v11, v71, v71
    v_dot2c_f32_bf16 v10, v72, v12
    v_dot2c_f32_bf16 v11, v72, v72
    v_dot2c_f32_bf16 v10, v73, v12
    v_dot2c_f32_bf16 v11, v73, v73
    v_dot2c_f32_bf16 v10, v74, v12
    v_dot2c_f32_bf16 v11, v74, v74
    v_dot2c_f32_bf16 v10, v75, v12
    v_dot2c_f32_bf16 v11, v75, v75
    v_dot2c_f32_bf16 v10, v76, v12
    v_dot2c_f32_bf16 v11, v76, v76
    v_dot2c_f32_bf16 v10, v77, v12
    v_dot2c_f32_bf16 v11, v77, v77
    v_dot2c_f32_bf16 v10, v78, v12
    v_dot2c_f32_bf16 v11, v78, v78
    v_dot2c_f32_bf16 v10, v79, v12
    v_dot2c_f32_bf16 v11, v79, v79
    v_dot2c_f32_bf16 v10, v80, v12
    v_dot2c_f32_bf16 v11, v80, v80
    v_dot2c_f32_bf16 v10, v81, v12
    v_dot2c_f32_bf16 v11, v81, v81
    v_dot2c_f32_bf16 v10, v82, v12
    v_dot2c_f32_bf16 v11, v82, v82
    v_dot2c_f32_bf16 v10, v83, v12
    v_dot2c_f32_bf16 v11, v83, v83
    v_dot2c_f32_bf16 v10, v84, v12
    v_dot2c_f32_bf16 v11, v84, v84
    v_dot2c_f32_bf16 v10, v85, v12
    v_dot2c_f32_bf16 v11, v85, v85
    v_dot2c_f32_bf16 v10, v86, v12
    v_dot2c_f32_bf16 v11, v86, v86
    v_dot2c_f32_bf16 v10, v87, v12
    v_dot2c_f32_bf16 v11, v87, v87
    v_dot2c_f32_bf16 v10, v88, v12
    v_dot2c_f32_bf16 v11, v88, v88
    v_dot2c_f32_bf16 v10, v89, v12
    v_dot2c_f32_bf16 v11, v89, v89
    v_dot2c_f32_bf16 v10, v90, v12
    v_dot2c_f32_bf16 v11, v90, v90
    v_dot2c_f32_bf16 v10, v91, v12
    v_dot2c_f32_bf16 v11, v91, v91
    v_dot2c_f32_bf16 v10, v92, v12
    v_dot2c_f32_bf16 v11, v92, v92
    v_dot2c_f32_bf16 v10, v93, v12
    v_dot2c_f32_bf16 v11, v93, v93
    v_dot2c_f32_bf16 v10, v94, v12
    v_dot2c_f32_bf16 v11, v94, v94
    v_dot2c_f32_bf16 v10, v95, v12
    v_dot2c_f32_bf16 v11, v95, v95
    s_nop 3
    v_add_f32_dpp v10, v10, v10 quad_perm:[1,0,3,2] row_mask:0xf bank_mask:0xf
    v_add_f32_dpp v11, v11, v11 quad_perm:[1,0,3,2] row_mask:0xf bank_mask:0xf
    s_nop 1
    v_add_f32_dpp v10, v10, v10 quad_perm:[2,3,0,1] row_mask:0xf bank_mask:0xf
    v_add_f32_dpp v11, v11, v11 quad_perm:[2,3,0,1] row_mask:0xf bank_mask:0xf
    s_nop 1
    v_mul_f32 v10, 0x3acccccd, v10
    v_mul_f32 v11, 0x3acccccd, v11
    v_fma_f32 v11, -v10, v10, v11
    v_max_f32 v11, 0, v11
    v_mov_b32 v14, 0x3727c5ac
    v_add_f32 v14, v14, v11
    v_rsq_f32 v14, v14
    s_nop 0
    v_mul_f32 v15, v10, v14
    v_lshlrev_b32 v12, 16, v16
    v_and_b32 v13, 0xffff0000, v16
    v_fma_f32 v12, v12, v14, -v15
    v_fma_f32 v13, v13, v14, -v15
    v_cvt_pk_bf16_f32 v16, v12, v13
    v_lshlrev_b32 v12, 16, v17
    v_and_b32 v13, 0xffff0000, v17
    v_fma_f32 v12, v12, v14, -v15
    v_fma_f32 v13, v13, v14, -v15
    v_cvt_pk_bf16_f32 v17, v12, v13
    v_lshlrev_b32 v12, 16, v18
    v_and_b32 v13, 0xffff0000, v18
    v_fma_f32 v12, v12, v14, -v15
    v_fma_f32 v13, v13, v14, -v15
    v_cvt_pk_bf16_f32 v18, v12, v13
    v_lshlrev_b32 v12, 16, v19
    v_and_b32 v13, 0xffff0000, v19
    v_fma_f32 v12, v12, v14, -v15
    v_fma_f32 v13, v13, v14, -v15
    v_cvt_pk_bf16_f32 v19, v12, v13
    v_lshlrev_b32 v12, 16, v20
    v_and_b32 v13, 0xffff0000, v20
    v_fma_f32 v12, v12, v14, -v15
    v_fma_f32 v13, v13, v14, -v15
    v_cvt_pk_bf16_f32 v20, v12, v13
    v_lshlrev_b32 v12, 16, v21
    v_and_b32 v13, 0xffff0000, v21
    v_fma_f32 v12, v12, v14, -v15
    v_fma_f32 v13, v13, v14, -v15
    v_cvt_pk_bf16_f32 v21, v12, v13
    v_lshlrev_b32 v12, 16, v22
    v_and_b32 v13, 0xffff0000, v22
    v_fma_f32 v12, v12, v14, -v15
    v_fma_f32 v13, v13, v14, -v15
    v_cvt_pk_bf16_f32 v22, v12, v13
    v_lshlrev_b32 v12, 16, v23
    v_and_b32 v13, 0xffff0000, v23
    v_fma_f32 v12, v12, v14, -v15
    v_fma_f32 v13, v13, v14, -v15
    v_cvt_pk_bf16_f32 v23, v12, v13
    v_lshlrev_b32 v12, 16, v24
    v_and_b32 v13, 0xffff0000, v24
    v_fma_f32 v12, v12, v14, -v15
    v_fma_f32 v13, v13, v14, -v15
    v_cvt_pk_bf16_f32 v24, v12, v13
    v_lshlrev_b32 v12, 16, v25
    v_and_b32 v13, 0xffff0000, v25
    v_fma_f32 v12, v12, v14, -v15
    v_fma_f32 v13, v13, v14, -v15
    v_cvt_pk_bf16_f32 v25, v12, v13
    v_lshlrev_b32 v12, 16, v26
    v_and_b32 v13, 0xffff0000, v26
    v_fma_f32 v12, v12, v14, -v15
    v_fma_f32 v13, v13, v14, -v15
    v_cvt_pk_bf16_f32 v26, v12, v13
    v_lshlrev_b32 v12, 16, v27
    v_and_b32 v13, 0xffff0000, v27
    v_fma_f32 v12, v12, v14, -v15
    v_fma_f32 v13, v13, v14, -v15
    v_cvt_pk_bf16_f32 v27, v12, v13
    v_lshlrev_b32 v12, 16, v28
    v_and_b32 v13, 0xffff0000, v28
    v_fma_f32 v12, v12, v14, -v15
    v_fma_f32 v13, v13, v14, -v15
    v_cvt_pk_bf16_f32 v28, v12, v13
    v_lshlrev_b32 v12, 16, v29
    v_and_b32 v13, 0xffff0000, v29
    v_fma_f32 v12, v12, v14, -v15
    v_fma_f32 v13, v13, v14, -v15
    v_cvt_pk_bf16_f32 v29, v12, v13
    v_lshlrev_b32 v12, 16, v30
    v_and_b32 v13, 0xffff0000, v30
    v_fma_f32 v12, v12, v14, -v15
    v_fma_f32 v13, v13, v14, -v15
    v_cvt_pk_bf16_f32 v30, v12, v13
    v_lshlrev_b32 v12, 16, v31
    v_and_b32 v13, 0xffff0000, v31
    v_fma_f32 v12, v12, v14, -v15
    v_fma_f32 v13, v13, v14, -v15
    v_cvt_pk_bf16_f32 v31, v12, v13
    v_lshlrev_b32 v12, 16, v32
    v_and_b32 v13, 0xffff0000, v32
    v_fma_f32 v12, v12, v14, -v15
    v_fma_f32 v13, v13, v14, -v15
    v_cvt_pk_bf16_f32 v32, v12, v13
    v_lshlrev_b32 v12, 16, v33
    v_and_b32 v13, 0xffff0000, v33
    v_fma_f32 v12, v12, v14, -v15
    v_fma_f32 v13, v13, v14, -v15
    v_cvt_pk_bf16_f32 v33, v12, v13
    v_lshlrev_b32 v12, 16, v34
    v_and_b32 v13, 0xffff0000, v34
    v_fma_f32 v12, v12, v14, -v15
    v_fma_f32 v13, v13, v14, -v15
    v_cvt_pk_bf16_f32 v34, v12, v13
    v_lshlrev_b32 v12, 16, v35
    v_and_b32 v13, 0xffff0000, v35
    v_fma_f32 v12, v12, v14, -v15
    v_fma_f32 v13, v13, v14, -v15
    v_cvt_pk_bf16_f32 v35, v12, v13
    v_lshlrev_b32 v12, 16, v36
    v_and_b32 v13, 0xffff0000, v36
    v_fma_f32 v12, v12, v14, -v15
    v_fma_f32 v13, v13, v14, -v15
    v_cvt_pk_bf16_f32 v36, v12, v13
    v_lshlrev_b32 v12, 16, v37
    v_and_b32 v13, 0xffff0000, v37
    v_fma_f32 v12, v12, v14, -v15
    v_fma_f32 v13, v13, v14, -v15
    v_cvt_pk_bf16_f32 v37, v12, v13
    v_lshlrev_b32 v12, 16, v38
    v_and_b32 v13, 0xffff0000, v38
    v_fma_f32 v12, v12, v14, -v15
    v_fma_f32 v13, v13, v14, -v15
    v_cvt_pk_bf16_f32 v38, v12, v13
    v_lshlrev_b32 v12, 16, v39
    v_and_b32 v13, 0xffff0000, v39
    v_fma_f32 v12, v12, v14, -v15
    v_fma_f32 v13, v13, v14, -v15
    v_cvt_pk_bf16_f32 v39, v12, v13
    v_lshlrev_b32 v12, 16, v40
    v_and_b32 v13, 0xffff0000, v40
    v_fma_f32 v12, v12, v14, -v15
    v_fma_f32 v13, v13, v14, -v15
    v_cvt_pk_bf16_f32 v40, v12, v13
    v_lshlrev_b32 v12, 16, v41
    v_and_b32 v13, 0xffff0000, v41
    v_fma_f32 v12, v12, v14, -v15
    v_fma_f32 v13, v13, v14, -v15
    v_cvt_pk_bf16_f32 v41, v12, v13
    v_lshlrev_b32 v12, 16, v42
    v_and_b32 v13, 0xffff0000, v42
    v_fma_f32 v12, v12, v14, -v15
    v_fma_f32 v13, v13, v14, -v15
    v_cvt_pk_bf16_f32 v42, v12, v13
    v_lshlrev_b32 v12, 16, v43
    v_and_b32 v13, 0xffff0000, v43
    v_fma_f32 v12, v12, v14, -v15
    v_fma_f32 v13, v13, v14, -v15
    v_cvt_pk_bf16_f32 v43, v12, v13
    v_lshlrev_b32 v12, 16, v44
    v_and_b32 v13, 0xffff0000, v44
    v_fma_f32 v12, v12, v14, -v15
    v_fma_f32 v13, v13, v14, -v15
    v_cvt_pk_bf16_f32 v44, v12, v13
    v_lshlrev_b32 v12, 16, v45
    v_and_b32 v13, 0xffff0000, v45
    v_fma_f32 v12, v12, v14, -v15
    v_fma_f32 v13, v13, v14, -v15
    v_cvt_pk_bf16_f32 v45, v12, v13
    v_lshlrev_b32 v12, 16, v46
    v_and_b32 v13, 0xffff0000, v46
    v_fma_f32 v12, v12, v14, -v15
    v_fma_f32 v13, v13, v14, -v15
    v_cvt_pk_bf16_f32 v46, v12, v13
    v_lshlrev_b32 v12, 16, v47
    v_and_b32 v13, 0xffff0000, v47
    v_fma_f32 v12, v12, v14, -v15
    v_fma_f32 v13, v13, v14, -v15
    v_cvt_pk_bf16_f32 v47, v12, v13
    v_lshlrev_b32 v12, 16, v48
    v_and_b32 v13, 0xffff0000, v48
    v_fma_f32 v12, v12, v14, -v15
    v_fma_f32 v13, v13, v14, -v15
    v_cvt_pk_bf16_f32 v48, v12, v13
    v_lshlrev_b32 v12, 16, v49
    v_and_b32 v13, 0xffff0000, v49
    v_fma_f32 v12, v12, v14, -v15
    v_fma_f32 v13, v13, v14, -v15
    v_cvt_pk_bf16_f32 v49, v12, v13
    v_lshlrev_b32 v12, 16, v50
    v_and_b32 v13, 0xffff0000, v50
    v_fma_f32 v12, v12, v14, -v15
    v_fma_f32 v13, v13, v14, -v15
    v_cvt_pk_bf16_f32 v50, v12, v13
    v_lshlrev_b32 v12, 16, v51
    v_and_b32 v13, 0xffff0000, v51
    v_fma_f32 v12, v12, v14, -v15
    v_fma_f32 v13, v13, v14, -v15
    v_cvt_pk_bf16_f32 v51, v12, v13
    v_lshlrev_b32 v12, 16, v52
    v_and_b32 v13, 0xffff0000, v52
    v_fma_f32 v12, v12, v14, -v15
    v_fma_f32 v13, v13, v14, -v15
    v_cvt_pk_bf16_f32 v52, v12, v13
    v_lshlrev_b32 v12, 16, v53
    v_and_b32 v13, 0xffff0000, v53
    v_fma_f32 v12, v12, v14, -v15
    v_fma_f32 v13, v13, v14, -v15
    v_cvt_pk_bf16_f32 v53, v12, v13
    v_lshlrev_b32 v12, 16, v54
    v_and_b32 v13, 0xffff0000, v54
    v_fma_f32 v12, v12, v14, -v15
    v_fma_f32 v13, v13, v14, -v15
    v_cvt_pk_bf16_f32 v54, v12, v13
    v_lshlrev_b32 v12, 16, v55
    v_and_b32 v13, 0xffff0000, v55
    v_fma_f32 v12, v12, v14, -v15
    v_fma_f32 v13, v13, v14, -v15
    v_cvt_pk_bf16_f32 v55, v12, v13
    v_lshlrev_b32 v12, 16, v56
    v_and_b32 v13, 0xffff0000, v56
    v_fma_f32 v12, v12, v14, -v15
    v_fma_f32 v13, v13, v14, -v15
    v_cvt_pk_bf16_f32 v56, v12, v13
    v_lshlrev_b32 v12, 16, v57
    v_and_b32 v13, 0xffff0000, v57
    v_fma_f32 v12, v12, v14, -v15
    v_fma_f32 v13, v13, v14, -v15
    v_cvt_pk_bf16_f32 v57, v12, v13
    v_lshlrev_b32 v12, 16, v58
    v_and_b32 v13, 0xffff0000, v58
    v_fma_f32 v12, v12, v14, -v15
    v_fma_f32 v13, v13, v14, -v15
    v_cvt_pk_bf16_f32 v58, v12, v13
    v_lshlrev_b32 v12, 16, v59
    v_and_b32 v13, 0xffff0000, v59
    v_fma_f32 v12, v12, v14, -v15
    v_fma_f32 v13, v13, v14, -v15
    v_cvt_pk_bf16_f32 v59, v12, v13
    v_lshlrev_b32 v12, 16, v60
    v_and_b32 v13, 0xffff0000, v60
    v_fma_f32 v12, v12, v14, -v15
    v_fma_f32 v13, v13, v14, -v15
    v_cvt_pk_bf16_f32 v60, v12, v13
    v_lshlrev_b32 v12, 16, v61
    v_and_b32 v13, 0xffff0000, v61
    v_fma_f32 v12, v12, v14, -v15
    v_fma_f32 v13, v13, v14, -v15
    v_cvt_pk_bf16_f32 v61, v12, v13
    v_lshlrev_b32 v12, 16, v62
    v_and_b32 v13, 0xffff0000, v62
    v_fma_f32 v12, v12, v14, -v15
    v_fma_f32 v13, v13, v14, -v15
    v_cvt_pk_bf16_f32 v62, v12, v13
    v_lshlrev_b32 v12, 16, v63
    v_and_b32 v13, 0xffff0000, v63
    v_fma_f32 v12, v12, v14, -v15
    v_fma_f32 v13, v13, v14, -v15
    v_cvt_pk_bf16_f32 v63, v12, v13
    v_lshlrev_b32 v12, 16, v64
    v_and_b32 v13, 0xffff0000, v64
    v_fma_f32 v12, v12, v14, -v15
    v_fma_f32 v13, v13, v14, -v15
    v_cvt_pk_bf16_f32 v64, v12, v13
    v_lshlrev_b32 v12, 16, v65
    v_and_b32 v13, 0xffff0000, v65
    v_fma_f32 v12, v12, v14, -v15
    v_fma_f32 v13, v13, v14, -v15
    v_cvt_pk_bf16_f32 v65, v12, v13
    v_lshlrev_b32 v12, 16, v66
    v_and_b32 v13, 0xffff0000, v66
    v_fma_f32 v12, v12, v14, -v15
    v_fma_f32 v13, v13, v14, -v15
    v_cvt_pk_bf16_f32 v66, v12, v13
    v_lshlrev_b32 v12, 16, v67
    v_and_b32 v13, 0xffff0000, v67
    v_fma_f32 v12, v12, v14, -v15
    v_fma_f32 v13, v13, v14, -v15
    v_cvt_pk_bf16_f32 v67, v12, v13
    v_lshlrev_b32 v12, 16, v68
    v_and_b32 v13, 0xffff0000, v68
    v_fma_f32 v12, v12, v14, -v15
    v_fma_f32 v13, v13, v14, -v15
    v_cvt_pk_bf16_f32 v68, v12, v13
    v_lshlrev_b32 v12, 16, v69
    v_and_b32 v13, 0xffff0000, v69
    v_fma_f32 v12, v12, v14, -v15
    v_fma_f32 v13, v13, v14, -v15
    v_cvt_pk_bf16_f32 v69, v12, v13
    v_lshlrev_b32 v12, 16, v70
    v_and_b32 v13, 0xffff0000, v70
    v_fma_f32 v12, v12, v14, -v15
    v_fma_f32 v13, v13, v14, -v15
    v_cvt_pk_bf16_f32 v70, v12, v13
    v_lshlrev_b32 v12, 16, v71
    v_and_b32 v13, 0xffff0000, v71
    v_fma_f32 v12, v12, v14, -v15
    v_fma_f32 v13, v13, v14, -v15
    v_cvt_pk_bf16_f32 v71, v12, v13
    v_lshlrev_b32 v12, 16, v72
    v_and_b32 v13, 0xffff0000, v72
    v_fma_f32 v12, v12, v14, -v15
    v_fma_f32 v13, v13, v14, -v15
    v_cvt_pk_bf16_f32 v72, v12, v13
    v_lshlrev_b32 v12, 16, v73
    v_and_b32 v13, 0xffff0000, v73
    v_fma_f32 v12, v12, v14, -v15
    v_fma_f32 v13, v13, v14, -v15
    v_cvt_pk_bf16_f32 v73, v12, v13
    v_lshlrev_b32 v12, 16, v74
    v_and_b32 v13, 0xffff0000, v74
    v_fma_f32 v12, v12, v14, -v15
    v_fma_f32 v13, v13, v14, -v15
    v_cvt_pk_bf16_f32 v74, v12, v13
    v_lshlrev_b32 v12, 16, v75
    v_and_b32 v13, 0xffff0000, v75
    v_fma_f32 v12, v12, v14, -v15
    v_fma_f32 v13, v13, v14, -v15
    v_cvt_pk_bf16_f32 v75, v12, v13
    v_lshlrev_b32 v12, 16, v76
    v_and_b32 v13, 0xffff0000, v76
    v_fma_f32 v12, v12, v14, -v15
    v_fma_f32 v13, v13, v14, -v15
    v_cvt_pk_bf16_f32 v76, v12, v13
    v_lshlrev_b32 v12, 16, v77
    v_and_b32 v13, 0xffff0000, v77
    v_fma_f32 v12, v12, v14, -v15
    v_fma_f32 v13, v13, v14, -v15
    v_cvt_pk_bf16_f32 v77, v12, v13
    v_lshlrev_b32 v12, 16, v78
    v_and_b32 v13, 0xffff0000, v78
    v_fma_f32 v12, v12, v14, -v15
    v_fma_f32 v13, v13, v14, -v15
    v_cvt_pk_bf16_f32 v78, v12, v13
    v_lshlrev_b32 v12, 16, v79
    v_and_b32 v13, 0xffff0000, v79
    v_fma_f32 v12, v12, v14, -v15
    v_fma_f32 v13, v13, v14, -v15
    v_cvt_pk_bf16_f32 v79, v12, v13
    v_lshlrev_b32 v12, 16, v80
    v_and_b32 v13, 0xffff0000, v80
    v_fma_f32 v12, v12, v14, -v15
    v_fma_f32 v13, v13, v14, -v15
    v_cvt_pk_bf16_f32 v80, v12, v13
    v_lshlrev_b32 v12, 16, v81
    v_and_b32 v13, 0xffff0000, v81
    v_fma_f32 v12, v12, v14, -v15
    v_fma_f32 v13, v13, v14, -v15
    v_cvt_pk_bf16_f32 v81, v12, v13
    v_lshlrev_b32 v12, 16, v82
    v_and_b32 v13, 0xffff0000, v82
    v_fma_f32 v12, v12, v14, -v15
    v_fma_f32 v13, v13, v14, -v15
    v_cvt_pk_bf16_f32 v82, v12, v13
    v_lshlrev_b32 v12, 16, v83
    v_and_b32 v13, 0xffff0000, v83
    v_fma_f32 v12, v12, v14, -v15
    v_fma_f32 v13, v13, v14, -v15
    v_cvt_pk_bf16_f32 v83, v12, v13
    v_lshlrev_b32 v12, 16, v84
    v_and_b32 v13, 0xffff0000, v84
    v_fma_f32 v12, v12, v14, -v15
    v_fma_f32 v13, v13, v14, -v15
    v_cvt_pk_bf16_f32 v84, v12, v13
    v_lshlrev_b32 v12, 16, v85
    v_and_b32 v13, 0xffff0000, v85
    v_fma_f32 v12, v12, v14, -v15
    v_fma_f32 v13, v13, v14, -v15
    v_cvt_pk_bf16_f32 v85, v12, v13
    v_lshlrev_b32 v12, 16, v86
    v_and_b32 v13, 0xffff0000, v86
    v_fma_f32 v12, v12, v14, -v15
    v_fma_f32 v13, v13, v14, -v15
    v_cvt_pk_bf16_f32 v86, v12, v13
    v_lshlrev_b32 v12, 16, v87
    v_and_b32 v13, 0xffff0000, v87
    v_fma_f32 v12, v12, v14, -v15
    v_fma_f32 v13, v13, v14, -v15
    v_cvt_pk_bf16_f32 v87, v12, v13
    v_lshlrev_b32 v12, 16, v88
    v_and_b32 v13, 0xffff0000, v88
    v_fma_f32 v12, v12, v14, -v15
    v_fma_f32 v13, v13, v14, -v15
    v_cvt_pk_bf16_f32 v88, v12, v13
    v_lshlrev_b32 v12, 16, v89
    v_and_b32 v13, 0xffff0000, v89
    v_fma_f32 v12, v12, v14, -v15
    v_fma_f32 v13, v13, v14, -v15
    v_cvt_pk_bf16_f32 v89, v12, v13
    v_lshlrev_b32 v12, 16, v90
    v_and_b32 v13, 0xffff0000, v90
    v_fma_f32 v12, v12, v14, -v15
    v_fma_f32 v13, v13, v14, -v15
    v_cvt_pk_bf16_f32 v90, v12, v13
    v_lshlrev_b32 v12, 16, v91
    v_and_b32 v13, 0xffff0000, v91
    v_fma_f32 v12, v12, v14, -v15
    v_fma_f32 v13, v13, v14, -v15
    v_cvt_pk_bf16_f32 v91, v12, v13
    v_lshlrev_b32 v12, 16, v92
    v_and_b32 v13, 0xffff0000, v92
    v_fma_f32 v12, v12, v14, -v15
    v_fma_f32 v13, v13, v14, -v15
    v_cvt_pk_bf16_f32 v92, v12, v13
    v_lshlrev_b32 v12, 16, v93
    v_and_b32 v13, 0xffff0000, v93
    v_fma_f32 v12, v12, v14, -v15
    v_fma_f32 v13, v13, v14, -v15
    v_cvt_pk_bf16_f32 v93, v12, v13
    v_lshlrev_b32 v12, 16, v94
    v_and_b32 v13, 0xffff0000, v94
    v_fma_f32 v12, v12, v14, -v15
    v_fma_f32 v13, v13, v14, -v15
    v_cvt_pk_bf16_f32 v94, v12, v13
    v_lshlrev_b32 v12, 16, v95
    v_and_b32 v13, 0xffff0000, v95
    v_fma_f32 v12, v12, v14, -v15
    v_fma_f32 v13, v13, v14, -v15
    v_cvt_pk_bf16_f32 v95, v12, v13
    ds_write_b128 v9, v[16:19] offset:0
    ds_write_b128 v9, v[20:23] offset:64
    ds_write_b128 v9, v[24:27] offset:128
    ds_write_b128 v9, v[28:31] offset:192
    ds_write_b128 v9, v[32:35] offset:256
    ds_write_b128 v9, v[36:39] offset:320
    ds_write_b128 v9, v[40:43] offset:384
    ds_write_b128 v9, v[44:47] offset:448
    ds_write_b128 v9, v[48:51] offset:512
    ds_write_b128 v9, v[52:55] offset:576
    ds_write_b128 v9, v[56:59] offset:640
    ds_write_b128 v9, v[60:63] offset:704
    ds_write_b128 v9, v[64:67] offset:768
    ds_write_b128 v9, v[68:71] offset:832
    ds_write_b128 v9, v[72:75] offset:896
    ds_write_b128 v9, v[76:79] offset:960
    ds_write_b128 v9, v[80:83] offset:1024
    ds_write_b128 v9, v[84:87] offset:1088
    ds_write_b128 v9, v[88:91] offset:1152
    ds_write_b128 v9, v[92:95] offset:1216
    s_waitcnt lgkmcnt(0)
    s_barrier
    s_mul_i32 s36, s35, 81920
    v_mov_b32 v192, 0
    v_mov_b32 v193, 0
    v_mov_b32 v194, 0
    v_mov_b32 v195, 0
    v_mov_b32 v196, 0
    v_mov_b32 v197, 0
    v_mov_b32 v198, 0
    v_mov_b32 v199, 0
    v_mov_b32 v200, 0
    v_mov_b32 v201, 0
    v_mov_b32 v202, 0
    v_mov_b32 v203, 0
    v_mov_b32 v204, 0
    v_mov_b32 v205, 0
    v_mov_b32 v206, 0
    v_mov_b32 v207, 0
    v_mov_b32 v208, 0
    v_mov_b32 v209, 0
    v_mov_b32 v210, 0
    v_mov_b32 v211, 0
    v_mov_b32 v212, 0
    v_mov_b32 v213, 0
    v_mov_b32 v214, 0
    v_mov_b32 v215, 0
    v_mov_b32 v216, 0
    v_mov_b32 v217, 0
    v_mov_b32 v218, 0
    v_mov_b32 v219, 0
    v_mov_b32 v220, 0
    v_mov_b32 v221, 0
    v_mov_b32 v222, 0
    v_mov_b32 v223, 0
    v_mov_b32 v224, 0
    v_mov_b32 v225, 0
    v_mov_b32 v226, 0
    v_mov_b32 v227, 0
    v_mov_b32 v228, 0
    v_mov_b32 v229, 0
    v_mov_b32 v230, 0
    v_mov_b32 v231, 0
    v_mov_b32 v232, 0
    v_mov_b32 v233, 0
    v_mov_b32 v234, 0
    v_mov_b32 v235, 0
    v_mov_b32 v236, 0
    v_mov_b32 v237, 0
    v_mov_b32 v238, 0
    v_mov_b32 v239, 0
    v_mov_b32 v240, 0
    v_mov_b32 v241, 0
    v_mov_b32 v242, 0
    v_mov_b32 v243, 0
    v_mov_b32 v244, 0
    v_mov_b32 v245, 0
    v_mov_b32 v246, 0
    v_mov_b32 v247, 0
    v_mov_b32 v248, 0
    v_mov_b32 v249, 0
    v_mov_b32 v250, 0
    v_mov_b32 v251, 0
    v_mov_b32 v252, 0
    v_mov_b32 v253, 0
    v_mov_b32 v254, 0
    v_mov_b32 v255, 0
    v_add_u32 v44, 0, v5
    v_add_u32 v45, 40960, v5
    v_mul_u32_u24 v46, 1296, v2
    v_lshl_add_u32 v46, v3, 4, v46
    s_mov_b32 s40, s36
    s_add_u32 s41, s40, 4096
    s_add_u32 s42, s40, 8192
    buffer_load_dwordx4 v[64:67], v44, s[8:11], s40 offen offset:0
    buffer_load_dwordx4 v[68:71], v45, s[8:11], s40 offen offset:0
    buffer_load_dwordx4 v[72:75], v44, s[8:11], s40 offen offset:1024
    buffer_load_dwordx4 v[76:79], v45, s[8:11], s40 offen offset:1024
    buffer_load_dwordx4 v[80:83], v44, s[8:11], s40 offen offset:2048
    buffer_load_dwordx4 v[84:87], v45, s[8:11], s40 offen offset:2048
    buffer_load_dwordx4 v[88:91], v44, s[8:11], s40 offen offset:3072
    buffer_load_dwordx4 v[92:95], v45, s[8:11], s40 offen offset:3072
    buffer_load_dwordx4 v[96:99], v44, s[8:11], s41 offen offset:0
    buffer_load_dwordx4 v[100:103], v45, s[8:11], s41 offen offset:0
    buffer_load_dwordx4 v[104:107], v44, s[8:11], s41 offen offset:1024
    buffer_load_dwordx4 v[108:111], v45, s[8:11], s41 offen offset:1024
    buffer_load_dwordx4 v[112:115], v44, s[8:11], s41 offen offset:2048
    buffer_load_dwordx4 v[116:119], v45, s[8:11], s41 offen offset:2048
    buffer_load_dwordx4 v[120:123], v44, s[8:11], s41 offen offset:3072
    buffer_load_dwordx4 v[124:127], v45, s[8:11], s41 offen offset:3072
    buffer_load_dwordx4 v[128:131], v44, s[8:11], s42 offen offset:0
    buffer_load_dwordx4 v[132:135], v45, s[8:11], s42 offen offset:0
    buffer_load_dwordx4 v[136:139], v44, s[8:11], s42 offen offset:1024
    buffer_load_dwordx4 v[140:143], v45, s[8:11], s42 offen offset:1024
    s_add_u32 s40, s40, 10240
    s_add_u32 s41, s41, 10240
    s_add_u32 s42, s42, 10240
    ds_read_b128 v[48:51], v46 offset:0
    ds_read_b128 v[52:55], v46 offset:41472
    s_mov_b32 s48, 4
gl_k1a_kernel:
    ds_read_b128 v[56:59], v46 offset:32
    ds_read_b128 v[60:63], v46 offset:41504
    s_waitcnt vmcnt(18) lgkmcnt(2)
    v_mfma_f32_32x32x16_bf16 v[192:207], v[64:67], v[48:51], v[192:207]
    v_mfma_f32_32x32x16_bf16 v[208:223], v[68:71], v[48:51], v[208:223]
    v_mfma_f32_32x32x16_bf16 v[224:239], v[64:67], v[52:55], v[224:239]
    v_mfma_f32_32x32x16_bf16 v[240:255], v[68:71], v[52:55], v[240:255]
    buffer_load_dwordx4 v[64:67], v44, s[8:11], s40 offen offset:0
    buffer_load_dwordx4 v[68:71], v45, s[8:11], s40 offen offset:0
    ds_read_b128 v[48:51], v46 offset:64
    ds_read_b128 v[52:55], v46 offset:41536
    s_waitcnt vmcnt(18) lgkmcnt(2)
    v_mfma_f32_32x32x16_bf16 v[192:207], v[72:75], v[56:59], v[192:207]
    v_mfma_f32_32x32x16_bf16 v[208:223], v[76:79], v[56:59], v[208:223]
    v_mfma_f32_32x32x16_bf16 v[224:239], v[72:75], v[60:63], v[224:239]
    v_mfma_f32_32x32x16_bf16 v[240:255], v[76:79], v[60:63], v[240:255]
    buffer_load_dwordx4 v[72:75], v44, s[8:11], s40 offen offset:1024
    buffer_load_dwordx4 v[76:79], v45, s[8:11], s40 offen offset:1024
    ds_read_b128 v[56:59], v46 offset:96
    ds_read_b128 v[60:63], v46 offset:41568
    s_waitcnt vmcnt(18) lgkmcnt(2)
    v_mfma_f32_32x32x16_bf16 v[192:207], v[80:83], v[48:51], v[192:207]
    v_mfma_f32_32x32x16_bf16 v[208:223], v[84:87], v[48:51], v[208:223]
    v_mfma_f32_32x32x16_bf16 v[224:239], v[80:83], v[52:55], v[224:239]
    v_mfma_f32_32x32x16_bf16 v[240:255], v[84:87], v[52:55], v[240:255]
    buffer_load_dwordx4 v[80:83], v44, s[8:11], s40 offen offset:2048
    buffer_load_dwordx4 v[84:87], v45, s[8:11], s40 offen offset:2048
    ds_read_b128 v[48:51], v46 offset:128
    ds_read_b128 v[52:55], v46 offset:41600
    s_waitcnt vmcnt(18) lgkmcnt(2)
    v_mfma_f32_32x32x16_bf16 v[192:207], v[88:91], v[56:59], v[192:207]
    v_mfma_f32_32x32x16_bf16 v[208:223], v[92:95], v[56:59], v[208:223]
    v_mfma_f32_32x32x16_bf16 v[224:239], v[88:91], v[60:63], v[224:239]
    v_mfma_f32_32x32x16_bf16 v[240:255], v[92:95], v[60:63], v[240:255]
    buffer_load_dwordx4 v[88:91], v44, s[8:11], s40 offen offset:3072
    buffer_load_dwordx4 v[92:95], v45, s[8:11], s40 offen offset:3072
    ds_read_b128 v[56:59], v46 offset:160
    ds_read_b128 v[60:63], v46 offset:41632
    s_waitcnt vmcnt(18) lgkmcnt(2)
    v_mfma_f32_32x32x16_bf16 v[192:207], v[96:99], v[48:51], v[192:207]
    v_mfma_f32_32x32x16_bf16 v[208:223], v[100:103], v[48:51], v[208:223]
    v_mfma_f32_32x32x16_bf16 v[224:239], v[96:99], v[52:55], v[224:239]
    v_mfma_f32_32x32x16_bf16 v[240:255], v[100:103], v[52:55], v[240:255]
    buffer_load_dwordx4 v[96:99], v44, s[8:11], s41 offen offset:0
    buffer_load_dwordx4 v[100:103], v45, s[8:11], s41 offen offset:0
    ds_read_b128 v[48:51], v46 offset:192
    ds_read_b128 v[52:55], v46 offset:41664
    s_waitcnt vmcnt(18) lgkmcnt(2)
    v_mfma_f32_32x32x16_bf16 v[192:207], v[104:107], v[56:59], v[192:207]
    v_mfma_f32_32x32x16_bf16 v[208:223], v[108:111], v[56:59], v[208:223]
    v_mfma_f32_32x32x16_bf16 v[224:239], v[104:107], v[60:63], v[224:239]
    v_mfma_f32_32x32x16_bf16 v[240:255], v[108:111], v[60:63], v[240:255]
    buffer_load_dwordx4 v[104:107], v44, s[8:11], s41 offen offset:1024
    buffer_load_dwordx4 v[108:111], v45, s[8:11], s41 offen offset:1024
    ds_read_b128 v[56:59], v46 offset:224
    ds_read_b128 v[60:63], v46 offset:41696
    s_waitcnt vmcnt(18) lgkmcnt(2)
    v_mfma_f32_32x32x16_bf16 v[192:207], v[112:115], v[48:51], v[192:207]
    v_mfma_f32_32x32x16_bf16 v[208:223], v[116:119], v[48:51], v[208:223]
    v_mfma_f32_32x32x16_bf16 v[224:239], v[112:115], v[52:55], v[224:239]
    v_mfma_f32_32x32x16_bf16 v[240:255], v[116:119], v[52:55], v[240:255]
    buffer_load_dwordx4 v[112:115], v44, s[8:11], s41 offen offset:2048
    buffer_load_dwordx4 v[116:119], v45, s[8:11], s41 offen offset:2048
    ds_read_b128 v[48:51], v46 offset:256
    ds_read_b128 v[52:55], v46 offset:41728
    s_waitcnt vmcnt(18) lgkmcnt(2)
    v_mfma_f32_32x32x16_bf16 v[192:207], v[120:123], v[56:59], v[192:207]
    v_mfma_f32_32x32x16_bf16 v[208:223], v[124:127], v[56:59], v[208:223]
    v_mfma_f32_32x32x16_bf16 v[224:239], v[120:123], v[60:63], v[224:239]
    v_mfma_f32_32x32x16_bf16 v[240:255], v[124:127], v[60:63], v[240:255]
    buffer_load_dwordx4 v[120:123], v44, s[8:11], s41 offen offset:3072
    buffer_load_dwordx4 v[124:127], v45, s[8:11], s41 offen offset:3072
    ds_read_b128 v[56:59], v46 offset:288
    ds_read_b128 v[60:63], v46 offset:41760
    s_waitcnt vmcnt(18) lgkmcnt(2)
    v_mfma_f32_32x32x16_bf16 v[192:207], v[128:131], v[48:51], v[192:207]
    v_mfma_f32_32x32x16_bf16 v[208:223], v[132:135], v[48:51], v[208:223]
    v_mfma_f32_32x32x16_bf16 v[224:239], v[128:131], v[52:55], v[224:239]
    v_mfma_f32_32x32x16_bf16 v[240:255], v[132:135], v[52:55], v[240:255]
    buffer_load_dwordx4 v[128:131], v44, s[8:11], s42 offen offset:0
    buffer_load_dwordx4 v[132:135], v45, s[8:11], s42 offen offset:0
    ds_read_b128 v[48:51], v46 offset:320
    ds_read_b128 v[52:55], v46 offset:41792
    s_waitcnt vmcnt(18) lgkmcnt(2)
    v_mfma_f32_32x32x16_bf16 v[192:207], v[136:139], v[56:59], v[192:207]
    v_mfma_f32_32x32x16_bf16 v[208:223], v[140:143], v[56:59], v[208:223]
    v_mfma_f32_32x32x16_bf16 v[224:239], v[136:139], v[60:63], v[224:239]
    v_mfma_f32_32x32x16_bf16 v[240:255], v[140:143], v[60:63], v[240:255]
    buffer_load_dwordx4 v[136:139], v44, s[8:11], s42 offen offset:1024
    buffer_load_dwordx4 v[140:143], v45, s[8:11], s42 offen offset:1024
    s_add_u32 s40, s40, 10240
    s_add_u32 s41, s41, 10240
    s_add_u32 s42, s42, 10240
    v_add_u32 v46, 320, v46
    s_sub_u32 s48, s48, 1
    s_cmp_lg_u32 s48, 0
    s_cbranch_scc1 gl_k1a_kernel
    s_waitcnt vmcnt(0) lgkmcnt(0)
    s_nop 15
    s_mov_b32 s37, 1069066811
    s_mul_i32 s38, s32, 13824
    s_add_u32 s38, s38, 82944
    s_mov_b32 s44, -1
    s_mov_b32 s45, 0
    s_mov_b32 s46, 0
    s_mov_b32 s47, -1
    s_mul_i32 s39, s35, 80
    s_add_u32 s39, s39, 10076160
    v_max3_f32 v6, v192, v193, v194
    v_min3_f32 v7, v192, v193, v194
    v_max3_f32 v6, v6, v195, v196
    v_min3_f32 v7, v7, v195, v196
    v_max3_f32 v6, v6, v197, v198
    v_min3_f32 v7, v7, v197, v198
    v_max3_f32 v6, v6, v199, v200
    v_min3_f32 v7, v7, v199, v200
    v_max3_f32 v6, v6, v201, v202
    v_min3_f32 v7, v7, v201, v202
    v_max3_f32 v6, v6, v203, v204
    v_min3_f32 v7, v7, v203, v204
    v_max3_f32 v6, v6, v205, v206
    v_min3_f32 v7, v7, v205, v206
    v_max3_f32 v6, v6, v207, v208
    v_min3_f32 v7, v7, v207, v208
    v_max3_f32 v6, v6, v209, v210
    v_min3_f32 v7, v7, v209, v210
    v_max_f32 v6, v6, v211
    v_min_f32 v7, v7, v211
    v_mul_f32 v6, s37, v6
    v_mul_f32 v7, s37, v7
    v_fma_f32 v64, v192, s37, -v6
    v_fma_f32 v84, -v192, s37, v7
    v_fma_f32 v65, v193, s37, -v6
    v_fma_f32 v85, -v193, s37, v7
    v_fma_f32 v66, v194, s37, -v6
    v_fma_f32 v86, -v194, s37, v7
    v_fma_f32 v67, v195, s37, -v6
    v_fma_f32 v87, -v195, s37, v7
    v_fma_f32 v68, v196, s37, -v6
    v_fma_f32 v88, -v196, s37, v7
    v_fma_f32 v69, v197, s37, -v6
    v_fma_f32 v89, -v197, s37, v7
    v_fma_f32 v70, v198, s37, -v6
    v_fma_f32 v90, -v198, s37, v7
    v_fma_f32 v71, v199, s37, -v6
    v_fma_f32 v91, -v199, s37, v7
    v_fma_f32 v72, v200, s37, -v6
    v_fma_f32 v92, -v200, s37, v7
    v_fma_f32 v73, v201, s37, -v6
    v_fma_f32 v93, -v201, s37, v7
    v_fma_f32 v74, v202, s37, -v6
    v_fma_f32 v94, -v202, s37, v7
    v_fma_f32 v75, v203, s37, -v6
    v_fma_f32 v95, -v203, s37, v7
    v_fma_f32 v76, v204, s37, -v6
    v_fma_f32 v96, -v204, s37, v7
    v_fma_f32 v77, v205, s37, -v6
    v_fma_f32 v97, -v205, s37, v7
    v_fma_f32 v78, v206, s37, -v6
    v_fma_f32 v98, -v206, s37, v7
    v_fma_f32 v79, v207, s37, -v6
    v_fma_f32 v99, -v207, s37, v7
    v_fma_f32 v80, v208, s37, -v6
    v_fma_f32 v100, -v208, s37, v7
    v_fma_f32 v81, v209, s37, -v6
    v_fma_f32 v101, -v209, s37, v7
    v_fma_f32 v82, v210, s37, -v6
    v_fma_f32 v102, -v210, s37, v7
    v_fma_f32 v83, v211, s37, -v6
    v_fma_f32 v103, -v211, s37, v7
    v_exp_f32 v64, v64
    v_exp_f32 v65, v65
    v_exp_f32 v66, v66
    v_exp_f32 v67, v67
    v_exp_f32 v68, v68
    v_exp_f32 v69, v69
    v_exp_f32 v70, v70
    v_exp_f32 v71, v71
    v_exp_f32 v72, v72
    v_exp_f32 v73, v73
    v_exp_f32 v74, v74
    v_exp_f32 v75, v75
    v_exp_f32 v76, v76
    v_exp_f32 v77, v77
    v_exp_f32 v78, v78
    v_exp_f32 v79, v79
    v_exp_f32 v80, v80
    v_exp_f32 v81, v81
    v_exp_f32 v82, v82
    v_exp_f32 v83, v83
    v_exp_f32 v84, v84
    v_exp_f32 v85, v85
    v_exp_f32 v86, v86
    v_exp_f32 v87, v87
    v_exp_f32 v88, v88
    v_exp_f32 v89, v89
    v_exp_f32 v90, v90
    v_exp_f32 v91, v91
    v_exp_f32 v92, v92
    v_exp_f32 v93, v93
    v_exp_f32 v94, v94
    v_exp_f32 v95, v95
    v_exp_f32 v96, v96
    v_exp_f32 v97, v97
    v_exp_f32 v98, v98
    v_exp_f32 v99, v99
    v_exp_f32 v100, v100
    v_exp_f32 v101, v101
    v_exp_f32 v102, v102
    v_exp_f32 v103, v103
    s_nop 0
    v_add_f32 v6, v64, v65
    v_add_f32 v6, v6, v66
    v_add_f32 v6, v6, v67
    v_add_f32 v6, v6, v68
    v_add_f32 v6, v6, v69
    v_add_f32 v6, v6, v70
    v_add_f32 v6, v6, v71
    v_add_f32 v6, v6, v72
    v_add_f32 v6, v6, v73
    v_add_f32 v6, v6, v74
    v_add_f32 v6, v6, v75
    v_add_f32 v6, v6, v76
    v_add_f32 v6, v6, v77
    v_add_f32 v6, v6, v78
    v_add_f32 v6, v6, v79
    v_add_f32 v6, v6, v80
    v_add_f32 v6, v6, v81
    v_add_f32 v6, v6, v82
    v_add_f32 v6, v6, v83
    v_rcp_f32 v6, v6
    s_nop 0
    v_mul_f32 v64, v64, v6
    v_mul_f32 v65, v65, v6
    v_mul_f32 v66, v66, v6
    v_mul_f32 v67, v67, v6
    v_mul_f32 v68, v68, v6
    v_mul_f32 v69, v69, v6
    v_mul_f32 v70, v70, v6
    v_mul_f32 v71, v71, v6
    v_mul_f32 v72, v72, v6
    v_mul_f32 v73, v73, v6
    v_mul_f32 v74, v74, v6
    v_mul_f32 v75, v75, v6
    v_mul_f32 v76, v76, v6
    v_mul_f32 v77, v77, v6
    v_mul_f32 v78, v78, v6
    v_mul_f32 v79, v79, v6
    v_mul_f32 v80, v80, v6
    v_mul_f32 v81, v81, v6
    v_mul_f32 v82, v82, v6
    v_mul_f32 v83, v83, v6
    v_add_f32 v6, v84, v85
    v_add_f32 v6, v6, v86
    v_add_f32 v6, v6, v87
    v_add_f32 v6, v6, v88
    v_add_f32 v6, v6, v89
    v_add_f32 v6, v6, v90
    v_add_f32 v6, v6, v91
    v_add_f32 v6, v6, v92
    v_add_f32 v6, v6, v93
    v_add_f32 v6, v6, v94
    v_add_f32 v6, v6, v95
    v_add_f32 v6, v6, v96
    v_add_f32 v6, v6, v97
    v_add_f32 v6, v6, v98
    v_add_f32 v6, v6, v99
    v_add_f32 v6, v6, v100
    v_add_f32 v6, v6, v101
    v_add_f32 v6, v6, v102
    v_add_f32 v6, v6, v103
    v_rcp_f32 v6, v6
    s_nop 0
    v_mul_f32 v84, v84, v6
    v_mul_f32 v85, v85, v6
    v_mul_f32 v86, v86, v6
    v_mul_f32 v87, v87, v6
    v_mul_f32 v88, v88, v6
    v_mul_f32 v89, v89, v6
    v_mul_f32 v90, v90, v6
    v_mul_f32 v91, v91, v6
    v_mul_f32 v92, v92, v6
    v_mul_f32 v93, v93, v6
    v_mul_f32 v94, v94, v6
    v_mul_f32 v95, v95, v6
    v_mul_f32 v96, v96, v6
    v_mul_f32 v97, v97, v6
    v_mul_f32 v98, v98, v6
    v_mul_f32 v99, v99, v6
    v_mul_f32 v100, v100, v6
    v_mul_f32 v101, v101, v6
    v_mul_f32 v102, v102, v6
    v_mul_f32 v103, v103, v6
    v_cvt_pk_bf16_f32 v104, v64, v65
    v_cvt_pk_bf16_f32 v105, v66, v67
    v_cvt_pk_bf16_f32 v106, v68, v69
    v_cvt_pk_bf16_f32 v107, v70, v71
    v_cvt_pk_bf16_f32 v108, v72, v73
    v_cvt_pk_bf16_f32 v109, v74, v75
    v_cvt_pk_bf16_f32 v110, v76, v77
    v_cvt_pk_bf16_f32 v111, v78, v79
    v_cvt_pk_bf16_f32 v112, v80, v81
    v_cvt_pk_bf16_f32 v113, v82, v83
    v_cvt_pk_bf16_f32 v114, v84, v85
    v_cvt_pk_bf16_f32 v115, v86, v87
    v_cvt_pk_bf16_f32 v116, v88, v89
    v_cvt_pk_bf16_f32 v117, v90, v91
    v_cvt_pk_bf16_f32 v118, v92, v93
    v_cvt_pk_bf16_f32 v119, v94, v95
    v_cvt_pk_bf16_f32 v120, v96, v97
    v_cvt_pk_bf16_f32 v121, v98, v99
    v_cvt_pk_bf16_f32 v122, v100, v101
    v_cvt_pk_bf16_f32 v123, v102, v103
    v_cvt_pk_bf16_f32 v24, v212, v213
    v_cvt_pk_bf16_f32 v25, v214, v215
    v_cvt_pk_bf16_f32 v26, v216, v217
    v_cvt_pk_bf16_f32 v27, v218, v219
    v_cvt_pk_bf16_f32 v28, v220, v221
    v_add_u32 v8, s34, v2
    v_add_u32 v8, 0, v8
    v_mul_u32_u24 v8, 2560, v8
    v_add_u32 v9, 0, v2
    v_lshl_add_u32 v9, v9, 1, s38
    v_mul_u32_u24 v10, 1440, v3
    v_add_u32 v10, v10, v9
    v_mov_b32 v11, 0x3f80
    s_mov_b64 exec, s[44:45]
    buffer_store_dwordx4 v[104:107], v8, s[8:11], s39 offen offset:0
    buffer_store_dwordx4 v[108:111], v8, s[8:11], s39 offen offset:16
    buffer_store_dwordx4 v[112:115], v8, s[8:11], s39 offen offset:32
    buffer_store_dwordx4 v[116:119], v8, s[8:11], s39 offen offset:48
    buffer_store_dwordx4 v[120:123], v8, s[8:11], s39 offen offset:64
    ds_write_b16 v9, v11 offset:12096
    s_mov_b64 exec, s[46:47]
    ds_write_b16 v9, v104 offset:0
    ds_write_b16_d16_hi v9, v104 offset:144
    ds_write_b16 v9, v105 offset:288
    ds_write_b16_d16_hi v9, v105 offset:432
    ds_write_b16 v9, v106 offset:576
    ds_write_b16_d16_hi v9, v106 offset:720
    ds_write_b16 v9, v107 offset:864
    ds_write_b16_d16_hi v9, v107 offset:1008
    ds_write_b16 v9, v108 offset:1152
    ds_write_b16_d16_hi v9, v108 offset:1296
    ds_write_b16 v9, v109 offset:1440
    ds_write_b16_d16_hi v9, v109 offset:1584
    ds_write_b16 v9, v110 offset:1728
    ds_write_b16_d16_hi v9, v110 offset:1872
    ds_write_b16 v9, v111 offset:2016
    ds_write_b16_d16_hi v9, v111 offset:2160
    ds_write_b16 v9, v112 offset:2304
    ds_write_b16_d16_hi v9, v112 offset:2448
    ds_write_b16 v9, v113 offset:2592
    ds_write_b16_d16_hi v9, v113 offset:2736
    ds_write_b16 v9, v114 offset:2880
    ds_write_b16_d16_hi v9, v114 offset:3024
    ds_write_b16 v9, v115 offset:3168
    ds_write_b16_d16_hi v9, v115 offset:3312
    ds_write_b16 v9, v116 offset:3456
    ds_write_b16_d16_hi v9, v116 offset:3600
    ds_write_b16 v9, v117 offset:3744
    ds_write_b16_d16_hi v9, v117 offset:3888
    ds_write_b16 v9, v118 offset:4032
    ds_write_b16_d16_hi v9, v118 offset:4176
    ds_write_b16 v9, v119 offset:4320
    ds_write_b16_d16_hi v9, v119 offset:4464
    ds_write_b16 v9, v120 offset:4608
    ds_write_b16_d16_hi v9, v120 offset:4752
    ds_write_b16 v9, v121 offset:4896
    ds_write_b16_d16_hi v9, v121 offset:5040
    ds_write_b16 v9, v122 offset:5184
    ds_write_b16_d16_hi v9, v122 offset:5328
    ds_write_b16 v9, v123 offset:5472
    ds_write_b16_d16_hi v9, v123 offset:5616
    s_mov_b64 exec, -1
    ds_write_b16 v10, v24 offset:9216
    ds_write_b16_d16_hi v10, v24 offset:9360
    ds_write_b16 v10, v25 offset:9504
    ds_write_b16_d16_hi v10, v25 offset:9648
    ds_write_b16 v10, v26 offset:9792
    ds_write_b16_d16_hi v10, v26 offset:9936
    ds_write_b16 v10, v27 offset:10080
    ds_write_b16_d16_hi v10, v27 offset:10224
    ds_write_b16 v10, v28 offset:10368
    ds_write_b16_d16_hi v10, v28 offset:10512
    v_max3_f32 v6, v224, v225, v226
    v_min3_f32 v7, v224, v225, v226
    v_max3_f32 v6, v6, v227, v228
    v_min3_f32 v7, v7, v227, v228
    v_max3_f32 v6, v6, v229, v230
    v_min3_f32 v7, v7, v229, v230
    v_max3_f32 v6, v6, v231, v232
    v_min3_f32 v7, v7, v231, v232
    v_max3_f32 v6, v6, v233, v234
    v_min3_f32 v7, v7, v233, v234
    v_max3_f32 v6, v6, v235, v236
    v_min3_f32 v7, v7, v235, v236
    v_max3_f32 v6, v6, v237, v238
    v_min3_f32 v7, v7, v237, v238
    v_max3_f32 v6, v6, v239, v240
    v_min3_f32 v7, v7, v239, v240
    v_max3_f32 v6, v6, v241, v242
    v_min3_f32 v7, v7, v241, v242
    v_max_f32 v6, v6, v243
    v_min_f32 v7, v7, v243
    v_mul_f32 v6, s37, v6
    v_mul_f32 v7, s37, v7
    v_fma_f32 v64, v224, s37, -v6
    v_fma_f32 v84, -v224, s37, v7
    v_fma_f32 v65, v225, s37, -v6
    v_fma_f32 v85, -v225, s37, v7
    v_fma_f32 v66, v226, s37, -v6
    v_fma_f32 v86, -v226, s37, v7
    v_fma_f32 v67, v227, s37, -v6
    v_fma_f32 v87, -v227, s37, v7
    v_fma_f32 v68, v228, s37, -v6
    v_fma_f32 v88, -v228, s37, v7
    v_fma_f32 v69, v229, s37, -v6
    v_fma_f32 v89, -v229, s37, v7
    v_fma_f32 v70, v230, s37, -v6
    v_fma_f32 v90, -v230, s37, v7
    v_fma_f32 v71, v231, s37, -v6
    v_fma_f32 v91, -v231, s37, v7
    v_fma_f32 v72, v232, s37, -v6
    v_fma_f32 v92, -v232, s37, v7
    v_fma_f32 v73, v233, s37, -v6
    v_fma_f32 v93, -v233, s37, v7
    v_fma_f32 v74, v234, s37, -v6
    v_fma_f32 v94, -v234, s37, v7
    v_fma_f32 v75, v235, s37, -v6
    v_fma_f32 v95, -v235, s37, v7
    v_fma_f32 v76, v236, s37, -v6
    v_fma_f32 v96, -v236, s37, v7
    v_fma_f32 v77, v237, s37, -v6
    v_fma_f32 v97, -v237, s37, v7
    v_fma_f32 v78, v238, s37, -v6
    v_fma_f32 v98, -v238, s37, v7
    v_fma_f32 v79, v239, s37, -v6
    v_fma_f32 v99, -v239, s37, v7
    v_fma_f32 v80, v240, s37, -v6
    v_fma_f32 v100, -v240, s37, v7
    v_fma_f32 v81, v241, s37, -v6
    v_fma_f32 v101, -v241, s37, v7
    v_fma_f32 v82, v242, s37, -v6
    v_fma_f32 v102, -v242, s37, v7
    v_fma_f32 v83, v243, s37, -v6
    v_fma_f32 v103, -v243, s37, v7
    v_exp_f32 v64, v64
    v_exp_f32 v65, v65
    v_exp_f32 v66, v66
    v_exp_f32 v67, v67
    v_exp_f32 v68, v68
    v_exp_f32 v69, v69
    v_exp_f32 v70, v70
    v_exp_f32 v71, v71
    v_exp_f32 v72, v72
    v_exp_f32 v73, v73
    v_exp_f32 v74, v74
    v_exp_f32 v75, v75
    v_exp_f32 v76, v76
    v_exp_f32 v77, v77
    v_exp_f32 v78, v78
    v_exp_f32 v79, v79
    v_exp_f32 v80, v80
    v_exp_f32 v81, v81
    v_exp_f32 v82, v82
    v_exp_f32 v83, v83
    v_exp_f32 v84, v84
    v_exp_f32 v85, v85
    v_exp_f32 v86, v86
    v_exp_f32 v87, v87
    v_exp_f32 v88, v88
    v_exp_f32 v89, v89
    v_exp_f32 v90, v90
    v_exp_f32 v91, v91
    v_exp_f32 v92, v92
    v_exp_f32 v93, v93
    v_exp_f32 v94, v94
    v_exp_f32 v95, v95
    v_exp_f32 v96, v96
    v_exp_f32 v97, v97
    v_exp_f32 v98, v98
    v_exp_f32 v99, v99
    v_exp_f32 v100, v100
    v_exp_f32 v101, v101
    v_exp_f32 v102, v102
    v_exp_f32 v103, v103
    s_nop 0
    v_add_f32 v6, v64, v65
    v_add_f32 v6, v6, v66
    v_add_f32 v6, v6, v67
    v_add_f32 v6, v6, v68
    v_add_f32 v6, v6, v69
    v_add_f32 v6, v6, v70
    v_add_f32 v6, v6, v71
    v_add_f32 v6, v6, v72
    v_add_f32 v6, v6, v73
    v_add_f32 v6, v6, v74
    v_add_f32 v6, v6, v75
    v_add_f32 v6, v6, v76
    v_add_f32 v6, v6, v77
    v_add_f32 v6, v6, v78
    v_add_f32 v6, v6, v79
    v_add_f32 v6, v6, v80
    v_add_f32 v6, v6, v81
    v_add_f32 v6, v6, v82
    v_add_f32 v6, v6, v83
    v_rcp_f32 v6, v6
    s_nop 0
    v_mul_f32 v64, v64, v6
    v_mul_f32 v65, v65, v6
    v_mul_f32 v66, v66, v6
    v_mul_f32 v67, v67, v6
    v_mul_f32 v68, v68, v6
    v_mul_f32 v69, v69, v6
    v_mul_f32 v70, v70, v6
    v_mul_f32 v71, v71, v6
    v_mul_f32 v72, v72, v6
    v_mul_f32 v73, v73, v6
    v_mul_f32 v74, v74, v6
    v_mul_f32 v75, v75, v6
    v_mul_f32 v76, v76, v6
    v_mul_f32 v77, v77, v6
    v_mul_f32 v78, v78, v6
    v_mul_f32 v79, v79, v6
    v_mul_f32 v80, v80, v6
    v_mul_f32 v81, v81, v6
    v_mul_f32 v82, v82, v6
    v_mul_f32 v83, v83, v6
    v_add_f32 v6, v84, v85
    v_add_f32 v6, v6, v86
    v_add_f32 v6, v6, v87
    v_add_f32 v6, v6, v88
    v_add_f32 v6, v6, v89
    v_add_f32 v6, v6, v90
    v_add_f32 v6, v6, v91
    v_add_f32 v6, v6, v92
    v_add_f32 v6, v6, v93
    v_add_f32 v6, v6, v94
    v_add_f32 v6, v6, v95
    v_add_f32 v6, v6, v96
    v_add_f32 v6, v6, v97
    v_add_f32 v6, v6, v98
    v_add_f32 v6, v6, v99
    v_add_f32 v6, v6, v100
    v_add_f32 v6, v6, v101
    v_add_f32 v6, v6, v102
    v_add_f32 v6, v6, v103
    v_rcp_f32 v6, v6
    s_nop 0
    v_mul_f32 v84, v84, v6
    v_mul_f32 v85, v85, v6
    v_mul_f32 v86, v86, v6
    v_mul_f32 v87, v87, v6
    v_mul_f32 v88, v88, v6
    v_mul_f32 v89, v89, v6
    v_mul_f32 v90, v90, v6
    v_mul_f32 v91, v91, v6
    v_mul_f32 v92, v92, v6
    v_mul_f32 v93, v93, v6
    v_mul_f32 v94, v94, v6
    v_mul_f32 v95, v95, v6
    v_mul_f32 v96, v96, v6
    v_mul_f32 v97, v97, v6
    v_mul_f32 v98, v98, v6
    v_mul_f32 v99, v99, v6
    v_mul_f32 v100, v100, v6
    v_mul_f32 v101, v101, v6
    v_mul_f32 v102, v102, v6
    v_mul_f32 v103, v103, v6
    v_cvt_pk_bf16_f32 v104, v64, v65
    v_cvt_pk_bf16_f32 v105, v66, v67
    v_cvt_pk_bf16_f32 v106, v68, v69
    v_cvt_pk_bf16_f32 v107, v70, v71
    v_cvt_pk_bf16_f32 v108, v72, v73
    v_cvt_pk_bf16_f32 v109, v74, v75
    v_cvt_pk_bf16_f32 v110, v76, v77
    v_cvt_pk_bf16_f32 v111, v78, v79
    v_cvt_pk_bf16_f32 v112, v80, v81
    v_cvt_pk_bf16_f32 v113, v82, v83
    v_cvt_pk_bf16_f32 v114, v84, v85
    v_cvt_pk_bf16_f32 v115, v86, v87
    v_cvt_pk_bf16_f32 v116, v88, v89
    v_cvt_pk_bf16_f32 v117, v90, v91
    v_cvt_pk_bf16_f32 v118, v92, v93
    v_cvt_pk_bf16_f32 v119, v94, v95
    v_cvt_pk_bf16_f32 v120, v96, v97
    v_cvt_pk_bf16_f32 v121, v98, v99
    v_cvt_pk_bf16_f32 v122, v100, v101
    v_cvt_pk_bf16_f32 v123, v102, v103
    v_cvt_pk_bf16_f32 v24, v244, v245
    v_cvt_pk_bf16_f32 v25, v246, v247
    v_cvt_pk_bf16_f32 v26, v248, v249
    v_cvt_pk_bf16_f32 v27, v250, v251
    v_cvt_pk_bf16_f32 v28, v252, v253
    v_add_u32 v8, s34, v2
    v_add_u32 v8, 32, v8
    v_mul_u32_u24 v8, 2560, v8
    v_add_u32 v9, 32, v2
    v_lshl_add_u32 v9, v9, 1, s38
    v_mul_u32_u24 v10, 1440, v3
    v_add_u32 v10, v10, v9
    v_mov_b32 v11, 0x3f80
    s_mov_b64 exec, s[44:45]
    buffer_store_dwordx4 v[104:107], v8, s[8:11], s39 offen offset:0
    buffer_store_dwordx4 v[108:111], v8, s[8:11], s39 offen offset:16
    buffer_store_dwordx4 v[112:115], v8, s[8:11], s39 offen offset:32
    buffer_store_dwordx4 v[116:119], v8, s[8:11], s39 offen offset:48
    buffer_store_dwordx4 v[120:123], v8, s[8:11], s39 offen offset:64
    ds_write_b16 v9, v11 offset:12096
    s_mov_b64 exec, s[46:47]
    ds_write_b16 v9, v104 offset:0
    ds_write_b16_d16_hi v9, v104 offset:144
    ds_write_b16 v9, v105 offset:288
    ds_write_b16_d16_hi v9, v105 offset:432
    ds_write_b16 v9, v106 offset:576
    ds_write_b16_d16_hi v9, v106 offset:720
    ds_write_b16 v9, v107 offset:864
    ds_write_b16_d16_hi v9, v107 offset:1008
    ds_write_b16 v9, v108 offset:1152
    ds_write_b16_d16_hi v9, v108 offset:1296
    ds_write_b16 v9, v109 offset:1440
    ds_write_b16_d16_hi v9, v109 offset:1584
    ds_write_b16 v9, v110 offset:1728
    ds_write_b16_d16_hi v9, v110 offset:1872
    ds_write_b16 v9, v111 offset:2016
    ds_write_b16_d16_hi v9, v111 offset:2160
    ds_write_b16 v9, v112 offset:2304
    ds_write_b16_d16_hi v9, v112 offset:2448
    ds_write_b16 v9, v113 offset:2592
    ds_write_b16_d16_hi v9, v113 offset:2736
    ds_write_b16 v9, v114 offset:2880
    ds_write_b16_d16_hi v9, v114 offset:3024
    ds_write_b16 v9, v115 offset:3168
    ds_write_b16_d16_hi v9, v115 offset:3312
    ds_write_b16 v9, v116 offset:3456
    ds_write_b16_d16_hi v9, v116 offset:3600
    ds_write_b16 v9, v117 offset:3744
    ds_write_b16_d16_hi v9, v117 offset:3888
    ds_write_b16 v9, v118 offset:4032
    ds_write_b16_d16_hi v9, v118 offset:4176
    ds_write_b16 v9, v119 offset:4320
    ds_write_b16_d16_hi v9, v119 offset:4464
    ds_write_b16 v9, v120 offset:4608
    ds_write_b16_d16_hi v9, v120 offset:4752
    ds_write_b16 v9, v121 offset:4896
    ds_write_b16_d16_hi v9, v121 offset:5040
    ds_write_b16 v9, v122 offset:5184
    ds_write_b16_d16_hi v9, v122 offset:5328
    ds_write_b16 v9, v123 offset:5472
    ds_write_b16_d16_hi v9, v123 offset:5616
    s_mov_b64 exec, -1
    ds_write_b16 v10, v24 offset:9216
    ds_write_b16_d16_hi v10, v24 offset:9360
    ds_write_b16 v10, v25 offset:9504
    ds_write_b16_d16_hi v10, v25 offset:9648
    ds_write_b16 v10, v26 offset:9792
    ds_write_b16_d16_hi v10, v26 offset:9936
    ds_write_b16 v10, v27 offset:10080
    ds_write_b16_d16_hi v10, v27 offset:10224
    ds_write_b16 v10, v28 offset:10368
    ds_write_b16_d16_hi v10, v28 offset:10512
    v_mul_u32_u24 v9, 144, v2
    v_lshl_add_u32 v9, v3, 4, v9
    v_add_u32 v9, s38, v9
    s_waitcnt lgkmcnt(0)
    ds_read_b128 v[64:67], v9 offset:9216
    ds_read_b128 v[80:83], v9 offset:0
    ds_read_b128 v[96:99], v9 offset:4608
    ds_read_b128 v[68:71], v9 offset:9248
    ds_read_b128 v[84:87], v9 offset:32
    ds_read_b128 v[100:103], v9 offset:4640
    ds_read_b128 v[72:75], v9 offset:9280
    ds_read_b128 v[88:91], v9 offset:64
    ds_read_b128 v[104:107], v9 offset:4672
    ds_read_b128 v[76:79], v9 offset:9312
    ds_read_b128 v[92:95], v9 offset:96
    ds_read_b128 v[108:111], v9 offset:4704
    v_mov_b32 v128, 0
    v_mov_b32 v129, 0
    v_mov_b32 v130, 0
    v_mov_b32 v131, 0
    v_mov_b32 v132, 0
    v_mov_b32 v133, 0
    v_mov_b32 v134, 0
    v_mov_b32 v135, 0
    v_mov_b32 v136, 0
    v_mov_b32 v137, 0
    v_mov_b32 v138, 0
    v_mov_b32 v139, 0
    v_mov_b32 v140, 0
    v_mov_b32 v141, 0
    v_mov_b32 v142, 0
    v_mov_b32 v143, 0
    v_mov_b32 v144, 0
    v_mov_b32 v145, 0
    v_mov_b32 v146, 0
    v_mov_b32 v147, 0
    v_mov_b32 v148, 0
    v_mov_b32 v149, 0
    v_mov_b32 v150, 0
    v_mov_b32 v151, 0
    v_mov_b32 v152, 0
    v_mov_b32 v153, 0
    v_mov_b32 v154, 0
    v_mov_b32 v155, 0
    v_mov_b32 v156, 0
    v_mov_b32 v157, 0
    v_mov_b32 v158, 0
    v_mov_b32 v159, 0
    s_waitcnt lgkmcnt(0)
    v_mfma_f32_32x32x16_bf16 v[128:143], v[80:83], v[64:67], v[128:143]
    v_mfma_f32_32x32x16_bf16 v[144:159], v[96:99], v[64:67], v[144:159]
    v_mfma_f32_32x32x16_bf16 v[128:143], v[84:87], v[68:71], v[128:143]
    v_mfma_f32_32x32x16_bf16 v[144:159], v[100:103], v[68:71], v[144:159]
    v_mfma_f32_32x32x16_bf16 v[128:143], v[88:91], v[72:75], v[128:143]
    v_mfma_f32_32x32x16_bf16 v[144:159], v[104:107], v[72:75], v[144:159]
    v_mfma_f32_32x32x16_bf16 v[128:143], v[92:95], v[76:79], v[128:143]
    v_mfma_f32_32x32x16_bf16 v[144:159], v[108:111], v[76:79], v[144:159]
    s_lshl_b32 s39, s33, 5
    s_add_u32 s39, s39, s35
    s_mul_i32 s39, s39, 5120
    s_add_u32 s39, s39, 15319040
    v_lshlrev_b32 v8, 9, v3
    v_lshl_add_u32 v8, v2, 2, v8
    v_add_u32 v7, 4096, v8
    v_cmp_gt_u32 vcc, 21, v2
    s_nop 1
    s_nop 15
    s_mov_b64 exec, vcc
    buffer_store_dword v128, v8, s[8:11], s39 offen offset:0
    buffer_store_dword v129, v8, s[8:11], s39 offen offset:128
    buffer_store_dword v130, v8, s[8:11], s39 offen offset:256
    buffer_store_dword v131, v8, s[8:11], s39 offen offset:384
    buffer_store_dword v132, v8, s[8:11], s39 offen offset:1024
    buffer_store_dword v133, v8, s[8:11], s39 offen offset:1152
    buffer_store_dword v134, v8, s[8:11], s39 offen offset:1280
    buffer_store_dword v135, v8, s[8:11], s39 offen offset:1408
    buffer_store_dword v136, v8, s[8:11], s39 offen offset:2048
    buffer_store_dword v137, v8, s[8:11], s39 offen offset:2176
    buffer_store_dword v138, v8, s[8:11], s39 offen offset:2304
    buffer_store_dword v139, v8, s[8:11], s39 offen offset:2432
    buffer_store_dword v140, v8, s[8:11], s39 offen offset:3072
    buffer_store_dword v141, v8, s[8:11], s39 offen offset:3200
    buffer_store_dword v142, v8, s[8:11], s39 offen offset:3328
    buffer_store_dword v143, v8, s[8:11], s39 offen offset:3456
    buffer_store_dword v144, v7, s[8:11], s39 offen offset:0
    buffer_store_dword v145, v7, s[8:11], s39 offen offset:128
    buffer_store_dword v146, v7, s[8:11], s39 offen offset:256
    buffer_store_dword v147, v7, s[8:11], s39 offen offset:384
k1a_kernel_end:
    s_endpgm
.p2align 8
.globl kra_kernel
.type kra_kernel,@function
kra_kernel:
    s_cmp_ge_u32 s2, 192
    s_cbranch_scc1 kra_kernel_end
    s_load_dwordx2 s[4:5], s[0:1], 80
    s_load_dwordx2 s[6:7], s[0:1], 64
    s_load_dwordx2 s[20:21], s[0:1], 0
    s_waitcnt lgkmcnt(0)
    s_mov_b32 s8, s4
    s_and_b32 s9, s5, 0xffff
    s_mov_b32 s10, 268435456
    s_mov_b32 s11, 0x20000
    s_mov_b32 s12, s6
    s_and_b32 s13, s7, 0xffff
    s_mov_b32 s14, 2621440
    s_mov_b32 s15, 0x20000
    s_mov_b32 s16, s20
    s_and_b32 s17, s21, 0xffff
    s_mov_b32 s18, 2621440
    s_mov_b32 s19, 0x20000
    s_mul_hi_u32 s33, s2, 0xaaaaaaab
    s_lshr_b32 s33, s33, 2
    s_mul_i32 s34, s33, 6
    s_sub_u32 s34, s2, s34
    s_lshl_b32 s34, s34, 8
    v_add_u32 v1, s34, v0
    v_lshrrev_b32 v2, 9, v1
    v_bfe_u32 v3, v1, 3, 5
    v_bfe_u32 v4, v1, 8, 1
    v_and_b32 v5, 7, v1
    v_lshlrev_b32 v6, 4, v2
    v_lshl_add_u32 v6, v4, 3, v6
    v_add_u32 v6, v6, v5
    v_cmp_eq_u32 vcc, 24, v3
    s_nop 1
    v_cndmask_b32 v7, v3, 20, vcc
    v_cmp_gt_u32 vcc, 21, v7
    s_nop 1
    v_cmp_gt_u32 s[40:41], 40, v6
    s_nop 1
    s_and_b64 vcc, vcc, s[40:41]
    v_lshlrev_b32 v8, 7, v6
    v_lshl_add_u32 v8, v7, 2, v8
    v_mov_b32 v9, 0x10000000
    v_cndmask_b32 v8, v9, v8, vcc
    s_mul_i32 s35, s33, 5120
    s_add_u32 s35, s35, 15319040
    buffer_load_dword v16, v8, s[8:11], s35 offen
    s_add_u32 s35, s35, 163840
    buffer_load_dword v17, v8, s[8:11], s35 offen
    s_add_u32 s35, s35, 163840
    buffer_load_dword v18, v8, s[8:11], s35 offen
    s_add_u32 s35, s35, 163840
    buffer_load_dword v19, v8, s[8:11], s35 offen
    s_add_u32 s35, s35, 163840
    buffer_load_dword v20, v8, s[8:11], s35 offen
    s_add_u32 s35, s35, 163840
    buffer_load_dword v21, v8, s[8:11], s35 offen
    s_add_u32 s35, s35, 163840
    buffer_load_dword v22, v8, s[8:11], s35 offen
    s_add_u32 s35, s35, 163840
    buffer_load_dword v23, v8, s[8:11], s35 offen
    s_add_u32 s35, s35, 163840
    buffer_load_dword v24, v8, s[8:11], s35 offen
    s_add_u32 s35, s35, 163840
    buffer_load_dword v25, v8, s[8:11], s35 offen
    s_add_u32 s35, s35, 163840
    buffer_load_dword v26, v8, s[8:11], s35 offen
    s_add_u32 s35, s35, 163840
    buffer_load_dword v27, v8, s[8:11], s35 offen
    s_add_u32 s35, s35, 163840
    buffer_load_dword v28, v8, s[8:11], s35 offen
    s_add_u32 s35, s35, 163840
    buffer_load_dword v29, v8, s[8:11], s35 offen
    s_add_u32 s35, s35, 163840
    buffer_load_dword v30, v8, s[8:11], s35 offen
    s_add_u32 s35, s35, 163840
    buffer_load_dword v31, v8, s[8:11], s35 offen
    s_add_u32 s35, s35, 163840
    buffer_load_dword v32, v8, s[8:11], s35 offen
    s_add_u32 s35, s35, 163840
    buffer_load_dword v33, v8, s[8:11], s35 offen
    s_add_u32 s35, s35, 163840
    buffer_load_dword v34, v8, s[8:11], s35 offen
    s_add_u32 s35, s35, 163840
    buffer_load_dword v35, v8, s[8:11], s35 offen
    s_add_u32 s35, s35, 163840
    buffer_load_dword v36, v8, s[8:11], s35 offen
    s_add_u32 s35, s35, 163840
    buffer_load_dword v37, v8, s[8:11], s35 offen
    s_add_u32 s35, s35, 163840
    buffer_load_dword v38, v8, s[8:11], s35 offen
    s_add_u32 s35, s35, 163840
    buffer_load_dword v39, v8, s[8:11], s35 offen
    s_add_u32 s35, s35, 163840
    buffer_load_dword v40, v8, s[8:11], s35 offen
    s_add_u32 s35, s35, 163840
    buffer_load_dword v41, v8, s[8:11], s35 offen
    s_add_u32 s35, s35, 163840
    buffer_load_dword v42, v8, s[8:11], s35 offen
    s_add_u32 s35, s35, 163840
    buffer_load_dword v43, v8, s[8:11], s35 offen
    s_add_u32 s35, s35, 163840
    buffer_load_dword v44, v8, s[8:11], s35 offen
    s_add_u32 s35, s35, 163840
    buffer_load_dword v45, v8, s[8:11], s35 offen
    s_add_u32 s35, s35, 163840
    buffer_load_dword v46, v8, s[8:11], s35 offen
    s_add_u32 s35, s35, 163840
    buffer_load_dword v47, v8, s[8:11], s35 offen
    s_add_u32 s35, s35, 163840
    s_waitcnt vmcnt(0)
    v_add_f32 v16, v16, v17
    v_add_f32 v16, v16, v18
    v_add_f32 v16, v16, v19
    v_add_f32 v16, v16, v20
    v_add_f32 v16, v16, v21
    v_add_f32 v16, v16, v22
    v_add_f32 v16, v16, v23
    v_add_f32 v16, v16, v24
    v_add_f32 v16, v16, v25
    v_add_f32 v16, v16, v26
    v_add_f32 v16, v16, v27
    v_add_f32 v16, v16, v28
    v_add_f32 v16, v16, v29
    v_add_f32 v16, v16, v30
    v_add_f32 v16, v16, v31
    v_add_f32 v16, v16, v32
    v_add_f32 v16, v16, v33
    v_add_f32 v16, v16, v34
    v_add_f32 v16, v16, v35
    v_add_f32 v16, v16, v36
    v_add_f32 v16, v16, v37
    v_add_f32 v16, v16, v38
    v_add_f32 v16, v16, v39
    v_add_f32 v16, v16, v40
    v_add_f32 v16, v16, v41
    v_add_f32 v16, v16, v42
    v_add_f32 v16, v16, v43
    v_add_f32 v16, v16, v44
    v_add_f32 v16, v16, v45
    v_add_f32 v16, v16, v46
    v_add_f32 v16, v16, v47
    v_cvt_pk_bf16_f32 v16, v16, v16
    v_lshlrev_b32 v1, 1, v1
    s_mul_i32 s35, s33, 3072
    s_add_u32 s35, s35, 20561920
    buffer_store_short v16, v1, s[8:11], s35 offen
kra_kernel_end:
    s_endpgm
.p2align 8
.globl k2a_kernel
.type k2a_kernel,@function
k2a_kernel:
    s_cmp_ge_u32 s2, 160
    s_cbranch_scc1 k2a_kernel_end
    s_load_dwordx2 s[4:5], s[0:1], 80
    s_load_dwordx2 s[6:7], s[0:1], 64
    s_load_dwordx2 s[20:21], s[0:1], 0
    s_waitcnt lgkmcnt(0)
    s_mov_b32 s8, s4
    s_and_b32 s9, s5, 0xffff
    s_mov_b32 s10, 268435456
    s_mov_b32 s11, 0x20000
    s_mov_b32 s12, s6
    s_and_b32 s13, s7, 0xffff
    s_mov_b32 s14, 2621440
    s_mov_b32 s15, 0x20000
    s_mov_b32 s16, s20
    s_and_b32 s17, s21, 0xffff
    s_mov_b32 s18, 2621440
    s_mov_b32 s19, 0x20000
    v_lshrrev_b32 v1, 6, v0
    s_nop 0
    v_readfirstlane_b32 s32, v1
    v_and_b32 v2, 31, v0
    v_bfe_u32 v3, v0, 5, 1
    v_and_b32 v4, 63, v0
    v_lshlrev_b32 v5, 4, v4
    s_mul_hi_u32 s33, s2, 0xcccccccd
    s_lshr_b32 s33, s33, 2
    s_mul_i32 s35, s33, 5
    s_sub_u32 s35, s2, s35
    s_lshl_b32 s34, s33, 6
    s_mov_b32 s44, -1
    s_mov_b32 s45, 0
    s_mov_b32 s46, 0
    s_mov_b32 s47, -1
    v_add_u32 v6, s34, v2
    v_add_u32 v6, 0, v6
    v_mul_u32_u24 v6, 2560, v6
    v_lshl_add_u32 v6, v3, 4, v6
    v_add_u32 v7, s34, v2
    v_add_u32 v7, 32, v7
    v_mul_u32_u24 v7, 2560, v7
    v_lshl_add_u32 v7, v3, 4, v7
    v_mov_b32 v20, 0x7ff00000
    v_cndmask_b32 v21, v6, v20, s[46:47]
    v_cndmask_b32 v22, v7, v20, s[46:47]
    v_add_u32 v8, 0, v2
    v_mul_u32_u24 v8, 1296, v8
    v_lshl_add_u32 v8, v3, 3, v8
    v_add_u32 v9, 32, v2
    v_mul_u32_u24 v9, 1296, v9
    v_lshl_add_u32 v9, v3, 3, v9
    s_lshl_b32 s36, s32, 3
    s_add_u32 s37, s36, 0
    s_mul_i32 s38, s37, 3072
    s_add_u32 s38, s38, 20561920
    s_mul_i32 s39, s37, 80
    s_add_u32 s39, s39, 10076160
    buffer_load_dwordx4 v[64:67], v5, s[8:11], s38 offen offset:0
    buffer_load_dwordx4 v[68:71], v5, s[8:11], s38 offen offset:1024
    buffer_load_dwordx4 v[72:75], v5, s[8:11], s38 offen offset:2048
    buffer_load_dwordx4 v[76:79], v6, s[8:11], s39 offen offset:0
    buffer_load_dwordx4 v[80:83], v6, s[8:11], s39 offen offset:32
    buffer_load_dwordx4 v[84:87], v21, s[8:11], s39 offen offset:64
    buffer_load_dwordx4 v[88:91], v7, s[8:11], s39 offen offset:0
    buffer_load_dwordx4 v[92:95], v7, s[8:11], s39 offen offset:32
    buffer_load_dwordx4 v[96:99], v22, s[8:11], s39 offen offset:64
    s_add_u32 s37, s36, 1
    s_mul_i32 s38, s37, 3072
    s_add_u32 s38, s38, 20561920
    s_mul_i32 s39, s37, 80
    s_add_u32 s39, s39, 10076160
    buffer_load_dwordx4 v[100:103], v5, s[8:11], s38 offen offset:0
    buffer_load_dwordx4 v[104:107], v5, s[8:11], s38 offen offset:1024
    buffer_load_dwordx4 v[108:111], v5, s[8:11], s38 offen offset:2048
    buffer_load_dwordx4 v[112:115], v6, s[8:11], s39 offen offset:0
    buffer_load_dwordx4 v[116:119], v6, s[8:11], s39 offen offset:32
    buffer_load_dwordx4 v[120:123], v21, s[8:11], s39 offen offset:64
    buffer_load_dwordx4 v[124:127], v7, s[8:11], s39 offen offset:0
    buffer_load_dwordx4 v[128:131], v7, s[8:11], s39 offen offset:32
    buffer_load_dwordx4 v[132:135], v22, s[8:11], s39 offen offset:64
    s_waitcnt vmcnt(9)
    v_mov_b32 v144, 0
    v_mov_b32 v145, 0
    v_mov_b32 v146, 0
    v_mov_b32 v147, 0
    v_mov_b32 v148, 0
    v_mov_b32 v149, 0
    v_mov_b32 v150, 0
    v_mov_b32 v151, 0
    v_mov_b32 v152, 0
    v_mov_b32 v153, 0
    v_mov_b32 v154, 0
    v_mov_b32 v155, 0
    v_mov_b32 v156, 0
    v_mov_b32 v157, 0
    v_mov_b32 v158, 0
    v_mov_b32 v159, 0
    v_mov_b32 v160, 0
    v_mov_b32 v161, 0
    v_mov_b32 v162, 0
    v_mov_b32 v163, 0
    v_mov_b32 v164, 0
    v_mov_b32 v165, 0
    v_mov_b32 v166, 0
    v_mov_b32 v167, 0
    v_mov_b32 v168, 0
    v_mov_b32 v169, 0
    v_mov_b32 v170, 0
    v_mov_b32 v171, 0
    v_mov_b32 v172, 0
    v_mov_b32 v173, 0
    v_mov_b32 v174, 0
    v_mov_b32 v175, 0
    s_nop 1
    v_mfma_f32_32x32x16_bf16 v[144:159], v[64:67], v[76:79], v[144:159]
    v_mfma_f32_32x32x16_bf16 v[160:175], v[64:67], v[88:91], v[160:175]
    v_mfma_f32_32x32x16_bf16 v[144:159], v[68:71], v[80:83], v[144:159]
    v_mfma_f32_32x32x16_bf16 v[160:175], v[68:71], v[92:95], v[160:175]
    v_mfma_f32_32x32x16_bf16 v[144:159], v[72:75], v[84:87], v[144:159]
    v_mfma_f32_32x32x16_bf16 v[160:175], v[72:75], v[96:99], v[160:175]
    s_nop 15
    s_add_u32 s37, s36, 0
    s_mul_i32 s37, s37, 40
    v_cndmask_b32 v10, v156, v152, s[46:47]
    v_add_f32 v10, 0x358637bd, v10
    v_rcp_f32 v10, v10
    s_nop 0
    v_mul_f32 v144, v144, v10
    v_mul_f32 v145, v145, v10
    v_mul_f32 v146, v146, v10
    v_mul_f32 v147, v147, v10
    v_mul_f32 v148, v148, v10
    v_mul_f32 v149, v149, v10
    v_mul_f32 v150, v150, v10
    v_mul_f32 v151, v151, v10
    v_mul_f32 v152, v152, v10
    v_mul_f32 v153, v153, v10
    v_mul_f32 v154, v154, v10
    v_mul_f32 v155, v155, v10
    v_cvt_pk_bf16_f32 v12, v144, v145
    v_cvt_pk_bf16_f32 v13, v146, v147
    v_cvt_pk_bf16_f32 v14, v148, v149
    v_cvt_pk_bf16_f32 v15, v150, v151
    v_cvt_pk_bf16_f32 v16, v152, v153
    v_cvt_pk_bf16_f32 v17, v154, v155
    v_add_u32 v11, s37, v8
    ds_write_b64 v11, v[12:13]
    ds_write_b64 v11, v[14:15] offset:16
    s_mov_b64 exec, s[44:45]
    ds_write_b64 v11, v[16:17] offset:32
    s_mov_b64 exec, -1
    v_cndmask_b32 v10, v172, v168, s[46:47]
    v_add_f32 v10, 0x358637bd, v10
    v_rcp_f32 v10, v10
    s_nop 0
    v_mul_f32 v160, v160, v10
    v_mul_f32 v161, v161, v10
    v_mul_f32 v162, v162, v10
    v_mul_f32 v163, v163, v10
    v_mul_f32 v164, v164, v10
    v_mul_f32 v165, v165, v10
    v_mul_f32 v166, v166, v10
    v_mul_f32 v167, v167, v10
    v_mul_f32 v168, v168, v10
    v_mul_f32 v169, v169, v10
    v_mul_f32 v170, v170, v10
    v_mul_f32 v171, v171, v10
    v_cvt_pk_bf16_f32 v12, v160, v161
    v_cvt_pk_bf16_f32 v13, v162, v163
    v_cvt_pk_bf16_f32 v14, v164, v165
    v_cvt_pk_bf16_f32 v15, v166, v167
    v_cvt_pk_bf16_f32 v16, v168, v169
    v_cvt_pk_bf16_f32 v17, v170, v171
    v_add_u32 v11, s37, v9
    ds_write_b64 v11, v[12:13]
    ds_write_b64 v11, v[14:15] offset:16
    s_mov_b64 exec, s[44:45]
    ds_write_b64 v11, v[16:17] offset:32
    s_mov_b64 exec, -1
    s_add_u32 s37, s36, 2
    s_mul_i32 s38, s37, 3072
    s_add_u32 s38, s38, 20561920
    s_mul_i32 s39, s37, 80
    s_add_u32 s39, s39, 10076160
    buffer_load_dwordx4 v[64:67], v5, s[8:11], s38 offen offset:0
    buffer_load_dwordx4 v[68:71], v5, s[8:11], s38 offen offset:1024
    buffer_load_dwordx4 v[72:75], v5, s[8:11], s38 offen offset:2048
    buffer_load_dwordx4 v[76:79], v6, s[8:11], s39 offen offset:0
    buffer_load_dwordx4 v[80:83], v6, s[8:11], s39 offen offset:32
    buffer_load_dwordx4 v[84:87], v21, s[8:11], s39 offen offset:64
    buffer_load_dwordx4 v[88:91], v7, s[8:11], s39 offen offset:0
    buffer_load_dwordx4 v[92:95], v7, s[8:11], s39 offen offset:32
    buffer_load_dwordx4 v[96:99], v22, s[8:11], s39 offen offset:64
    s_waitcnt vmcnt(9)
    v_mov_b32 v144, 0
    v_mov_b32 v145, 0
    v_mov_b32 v146, 0
    v_mov_b32 v147, 0
    v_mov_b32 v148, 0
    v_mov_b32 v149, 0
    v_mov_b32 v150, 0
    v_mov_b32 v151, 0
    v_mov_b32 v152, 0
    v_mov_b32 v153, 0
    v_mov_b32 v154, 0
    v_mov_b32 v155, 0
    v_mov_b32 v156, 0
    v_mov_b32 v157, 0
    v_mov_b32 v158, 0
    v_mov_b32 v159, 0
    v_mov_b32 v160, 0
    v_mov_b32 v161, 0
    v_mov_b32 v162, 0
    v_mov_b32 v163, 0
    v_mov_b32 v164, 0
    v_mov_b32 v165, 0
    v_mov_b32 v166, 0
    v_mov_b32 v167, 0
    v_mov_b32 v168, 0
    v_mov_b32 v169, 0
    v_mov_b32 v170, 0
    v_mov_b32 v171, 0
    v_mov_b32 v172, 0
    v_mov_b32 v173, 0
    v_mov_b32 v174, 0
    v_mov_b32 v175, 0
    s_nop 1
    v_mfma_f32_32x32x16_bf16 v[144:159], v[100:103], v[112:115], v[144:159]
    v_mfma_f32_32x32x16_bf16 v[160:175], v[100:103], v[124:127], v[160:175]
    v_mfma_f32_32x32x16_bf16 v[144:159], v[104:107], v[116:119], v[144:159]
    v_mfma_f32_32x32x16_bf16 v[160:175], v[104:107], v[128:131], v[160:175]
    v_mfma_f32_32x32x16_bf16 v[144:159], v[108:111], v[120:123], v[144:159]
    v_mfma_f32_32x32x16_bf16 v[160:175], v[108:111], v[132:135], v[160:175]
    s_nop 15
    s_add_u32 s37, s36, 1
    s_mul_i32 s37, s37, 40
    v_cndmask_b32 v10, v156, v152, s[46:47]
    v_add_f32 v10, 0x358637bd, v10
    v_rcp_f32 v10, v10
    s_nop 0
    v_mul_f32 v144, v144, v10
    v_mul_f32 v145, v145, v10
    v_mul_f32 v146, v146, v10
    v_mul_f32 v147, v147, v10
    v_mul_f32 v148, v148, v10
    v_mul_f32 v149, v149, v10
    v_mul_f32 v150, v150, v10
    v_mul_f32 v151, v151, v10
    v_mul_f32 v152, v152, v10
    v_mul_f32 v153, v153, v10
    v_mul_f32 v154, v154, v10
    v_mul_f32 v155, v155, v10
    v_cvt_pk_bf16_f32 v12, v144, v145
    v_cvt_pk_bf16_f32 v13, v146, v147
    v_cvt_pk_bf16_f32 v14, v148, v149
    v_cvt_pk_bf16_f32 v15, v150, v151
    v_cvt_pk_bf16_f32 v16, v152, v153
    v_cvt_pk_bf16_f32 v17, v154, v155
    v_add_u32 v11, s37, v8
    ds_write_b64 v11, v[12:13]
    ds_write_b64 v11, v[14:15] offset:16
    s_mov_b64 exec, s[44:45]
    ds_write_b64 v11, v[16:17] offset:32
    s_mov_b64 exec, -1
    v_cndmask_b32 v10, v172, v168, s[46:47]
    v_add_f32 v10, 0x358637bd, v10
    v_rcp_f32 v10, v10
    s_nop 0
    v_mul_f32 v160, v160, v10
    v_mul_f32 v161, v161, v10
    v_mul_f32 v162, v162, v10
    v_mul_f32 v163, v163, v10
    v_mul_f32 v164, v164, v10
    v_mul_f32 v165, v165, v10
    v_mul_f32 v166, v166, v10
    v_mul_f32 v167, v167, v10
    v_mul_f32 v168, v168, v10
    v_mul_f32 v169, v169, v10
    v_mul_f32 v170, v170, v10
    v_mul_f32 v171, v171, v10
    v_cvt_pk_bf16_f32 v12, v160, v161
    v_cvt_pk_bf16_f32 v13, v162, v163
    v_cvt_pk_bf16_f32 v14, v164, v165
    v_cvt_pk_bf16_f32 v15, v166, v167
    v_cvt_pk_bf16_f32 v16, v168, v169
    v_cvt_pk_bf16_f32 v17, v170, v171
    v_add_u32 v11, s37, v9
    ds_write_b64 v11, v[12:13]
    ds_write_b64 v11, v[14:15] offset:16
    s_mov_b64 exec, s[44:45]
    ds_write_b64 v11, v[16:17] offset:32
    s_mov_b64 exec, -1
    s_add_u32 s37, s36, 3
    s_mul_i32 s38, s37, 3072
    s_add_u32 s38, s38, 20561920
    s_mul_i32 s39, s37, 80
    s_add_u32 s39, s39, 10076160
    buffer_load_dwordx4 v[100:103], v5, s[8:11], s38 offen offset:0
    buffer_load_dwordx4 v[104:107], v5, s[8:11], s38 offen offset:1024
    buffer_load_dwordx4 v[108:111], v5, s[8:11], s38 offen offset:2048
    buffer_load_dwordx4 v[112:115], v6, s[8:11], s39 offen offset:0
    buffer_load_dwordx4 v[116:119], v6, s[8:11], s39 offen offset:32
    buffer_load_dwordx4 v[120:123], v21, s[8:11], s39 offen offset:64
    buffer_load_dwordx4 v[124:127], v7, s[8:11], s39 offen offset:0
    buffer_load_dwordx4 v[128:131], v7, s[8:11], s39 offen offset:32
    buffer_load_dwordx4 v[132:135], v22, s[8:11], s39 offen offset:64
    s_waitcnt vmcnt(9)
    v_mov_b32 v144, 0
    v_mov_b32 v145, 0
    v_mov_b32 v146, 0
    v_mov_b32 v147, 0
    v_mov_b32 v148, 0
    v_mov_b32 v149, 0
    v_mov_b32 v150, 0
    v_mov_b32 v151, 0
    v_mov_b32 v152, 0
    v_mov_b32 v153, 0
    v_mov_b32 v154, 0
    v_mov_b32 v155, 0
    v_mov_b32 v156, 0
    v_mov_b32 v157, 0
    v_mov_b32 v158, 0
    v_mov_b32 v159, 0
    v_mov_b32 v160, 0
    v_mov_b32 v161, 0
    v_mov_b32 v162, 0
    v_mov_b32 v163, 0
    v_mov_b32 v164, 0
    v_mov_b32 v165, 0
    v_mov_b32 v166, 0
    v_mov_b32 v167, 0
    v_mov_b32 v168, 0
    v_mov_b32 v169, 0
    v_mov_b32 v170, 0
    v_mov_b32 v171, 0
    v_mov_b32 v172, 0
    v_mov_b32 v173, 0
    v_mov_b32 v174, 0
    v_mov_b32 v175, 0
    s_nop 1
    v_mfma_f32_32x32x16_bf16 v[144:159], v[64:67], v[76:79], v[144:159]
    v_mfma_f32_32x32x16_bf16 v[160:175], v[64:67], v[88:91], v[160:175]
    v_mfma_f32_32x32x16_bf16 v[144:159], v[68:71], v[80:83], v[144:159]
    v_mfma_f32_32x32x16_bf16 v[160:175], v[68:71], v[92:95], v[160:175]
    v_mfma_f32_32x32x16_bf16 v[144:159], v[72:75], v[84:87], v[144:159]
    v_mfma_f32_32x32x16_bf16 v[160:175], v[72:75], v[96:99], v[160:175]
    s_nop 15
    s_add_u32 s37, s36, 2
    s_mul_i32 s37, s37, 40
    v_cndmask_b32 v10, v156, v152, s[46:47]
    v_add_f32 v10, 0x358637bd, v10
    v_rcp_f32 v10, v10
    s_nop 0
    v_mul_f32 v144, v144, v10
    v_mul_f32 v145, v145, v10
    v_mul_f32 v146, v146, v10
    v_mul_f32 v147, v147, v10
    v_mul_f32 v148, v148, v10
    v_mul_f32 v149, v149, v10
    v_mul_f32 v150, v150, v10
    v_mul_f32 v151, v151, v10
    v_mul_f32 v152, v152, v10
    v_mul_f32 v153, v153, v10
    v_mul_f32 v154, v154, v10
    v_mul_f32 v155, v155, v10
    v_cvt_pk_bf16_f32 v12, v144, v145
    v_cvt_pk_bf16_f32 v13, v146, v147
    v_cvt_pk_bf16_f32 v14, v148, v149
    v_cvt_pk_bf16_f32 v15, v150, v151
    v_cvt_pk_bf16_f32 v16, v152, v153
    v_cvt_pk_bf16_f32 v17, v154, v155
    v_add_u32 v11, s37, v8
    ds_write_b64 v11, v[12:13]
    ds_write_b64 v11, v[14:15] offset:16
    s_mov_b64 exec, s[44:45]
    ds_write_b64 v11, v[16:17] offset:32
    s_mov_b64 exec, -1
    v_cndmask_b32 v10, v172, v168, s[46:47]
    v_add_f32 v10, 0x358637bd, v10
    v_rcp_f32 v10, v10
    s_nop 0
    v_mul_f32 v160, v160, v10
    v_mul_f32 v161, v161, v10
    v_mul_f32 v162, v162, v10
    v_mul_f32 v163, v163, v10
    v_mul_f32 v164, v164, v10
    v_mul_f32 v165, v165, v10
    v_mul_f32 v166, v166, v10
    v_mul_f32 v167, v167, v10
    v_mul_f32 v168, v168, v10
    v_mul_f32 v169, v169, v10
    v_mul_f32 v170, v170, v10
    v_mul_f32 v171, v171, v10
    v_cvt_pk_bf16_f32 v12, v160, v161
    v_cvt_pk_bf16_f32 v13, v162, v163
    v_cvt_pk_bf16_f32 v14, v164, v165
    v_cvt_pk_bf16_f32 v15, v166, v167
    v_cvt_pk_bf16_f32 v16, v168, v169
    v_cvt_pk_bf16_f32 v17, v170, v171
    v_add_u32 v11, s37, v9
    ds_write_b64 v11, v[12:13]
    ds_write_b64 v11, v[14:15] offset:16
    s_mov_b64 exec, s[44:45]
    ds_write_b64 v11, v[16:17] offset:32
    s_mov_b64 exec, -1
    s_add_u32 s37, s36, 4
    s_mul_i32 s38, s37, 3072
    s_add_u32 s38, s38, 20561920
    s_mul_i32 s39, s37, 80
    s_add_u32 s39, s39, 10076160
    buffer_load_dwordx4 v[64:67], v5, s[8:11], s38 offen offset:0
    buffer_load_dwordx4 v[68:71], v5, s[8:11], s38 offen offset:1024
    buffer_load_dwordx4 v[72:75], v5, s[8:11], s38 offen offset:2048
    buffer_load_dwordx4 v[76:79], v6, s[8:11], s39 offen offset:0
    buffer_load_dwordx4 v[80:83], v6, s[8:11], s39 offen offset:32
    buffer_load_dwordx4 v[84:87], v21, s[8:11], s39 offen offset:64
    buffer_load_dwordx4 v[88:91], v7, s[8:11], s39 offen offset:0
    buffer_load_dwordx4 v[92:95], v7, s[8:11], s39 offen offset:32
    buffer_load_dwordx4 v[96:99], v22, s[8:11], s39 offen offset:64
    s_waitcnt vmcnt(9)
    v_mov_b32 v144, 0
    v_mov_b32 v145, 0
    v_mov_b32 v146, 0
    v_mov_b32 v147, 0
    v_mov_b32 v148, 0
    v_mov_b32 v149, 0
    v_mov_b32 v150, 0
    v_mov_b32 v151, 0
    v_mov_b32 v152, 0
    v_mov_b32 v153, 0
    v_mov_b32 v154, 0
    v_mov_b32 v155, 0
    v_mov_b32 v156, 0
    v_mov_b32 v157, 0
    v_mov_b32 v158, 0
    v_mov_b32 v159, 0
    v_mov_b32 v160, 0
    v_mov_b32 v161, 0
    v_mov_b32 v162, 0
    v_mov_b32 v163, 0
    v_mov_b32 v164, 0
    v_mov_b32 v165, 0
    v_mov_b32 v166, 0
    v_mov_b32 v167, 0
    v_mov_b32 v168, 0
    v_mov_b32 v169, 0
    v_mov_b32 v170, 0
    v_mov_b32 v171, 0
    v_mov_b32 v172, 0
    v_mov_b32 v173, 0
    v_mov_b32 v174, 0
    v_mov_b32 v175, 0
    s_nop 1
    v_mfma_f32_32x32x16_bf16 v[144:159], v[100:103], v[112:115], v[144:159]
    v_mfma_f32_32x32x16_bf16 v[160:175], v[100:103], v[124:127], v[160:175]
    v_mfma_f32_32x32x16_bf16 v[144:159], v[104:107], v[116:119], v[144:159]
    v_mfma_f32_32x32x16_bf16 v[160:175], v[104:107], v[128:131], v[160:175]
    v_mfma_f32_32x32x16_bf16 v[144:159], v[108:111], v[120:123], v[144:159]
    v_mfma_f32_32x32x16_bf16 v[160:175], v[108:111], v[132:135], v[160:175]
    s_nop 15
    s_add_u32 s37, s36, 3
    s_mul_i32 s37, s37, 40
    v_cndmask_b32 v10, v156, v152, s[46:47]
    v_add_f32 v10, 0x358637bd, v10
    v_rcp_f32 v10, v10
    s_nop 0
    v_mul_f32 v144, v144, v10
    v_mul_f32 v145, v145, v10
    v_mul_f32 v146, v146, v10
    v_mul_f32 v147, v147, v10
    v_mul_f32 v148, v148, v10
    v_mul_f32 v149, v149, v10
    v_mul_f32 v150, v150, v10
    v_mul_f32 v151, v151, v10
    v_mul_f32 v152, v152, v10
    v_mul_f32 v153, v153, v10
    v_mul_f32 v154, v154, v10
    v_mul_f32 v155, v155, v10
    v_cvt_pk_bf16_f32 v12, v144, v145
    v_cvt_pk_bf16_f32 v13, v146, v147
    v_cvt_pk_bf16_f32 v14, v148, v149
    v_cvt_pk_bf16_f32 v15, v150, v151
    v_cvt_pk_bf16_f32 v16, v152, v153
    v_cvt_pk_bf16_f32 v17, v154, v155
    v_add_u32 v11, s37, v8
    ds_write_b64 v11, v[12:13]
    ds_write_b64 v11, v[14:15] offset:16
    s_mov_b64 exec, s[44:45]
    ds_write_b64 v11, v[16:17] offset:32
    s_mov_b64 exec, -1
    v_cndmask_b32 v10, v172, v168, s[46:47]
    v_add_f32 v10, 0x358637bd, v10
    v_rcp_f32 v10, v10
    s_nop 0
    v_mul_f32 v160, v160, v10
    v_mul_f32 v161, v161, v10
    v_mul_f32 v162, v162, v10
    v_mul_f32 v163, v163, v10
    v_mul_f32 v164, v164, v10
    v_mul_f32 v165, v165, v10
    v_mul_f32 v166, v166, v10
    v_mul_f32 v167, v167, v10
    v_mul_f32 v168, v168, v10
    v_mul_f32 v169, v169, v10
    v_mul_f32 v170, v170, v10
    v_mul_f32 v171, v171, v10
    v_cvt_pk_bf16_f32 v12, v160, v161
    v_cvt_pk_bf16_f32 v13, v162, v163
    v_cvt_pk_bf16_f32 v14, v164, v165
    v_cvt_pk_bf16_f32 v15, v166, v167
    v_cvt_pk_bf16_f32 v16, v168, v169
    v_cvt_pk_bf16_f32 v17, v170, v171
    v_add_u32 v11, s37, v9
    ds_write_b64 v11, v[12:13]
    ds_write_b64 v11, v[14:15] offset:16
    s_mov_b64 exec, s[44:45]
    ds_write_b64 v11, v[16:17] offset:32
    s_mov_b64 exec, -1
    s_add_u32 s37, s36, 5
    s_mul_i32 s38, s37, 3072
    s_add_u32 s38, s38, 20561920
    s_mul_i32 s39, s37, 80
    s_add_u32 s39, s39, 10076160
    buffer_load_dwordx4 v[100:103], v5, s[8:11], s38 offen offset:0
    buffer_load_dwordx4 v[104:107], v5, s[8:11], s38 offen offset:1024
    buffer_load_dwordx4 v[108:111], v5, s[8:11], s38 offen offset:2048
    buffer_load_dwordx4 v[112:115], v6, s[8:11], s39 offen offset:0
    buffer_load_dwordx4 v[116:119], v6, s[8:11], s39 offen offset:32
    buffer_load_dwordx4 v[120:123], v21, s[8:11], s39 offen offset:64
    buffer_load_dwordx4 v[124:127], v7, s[8:11], s39 offen offset:0
    buffer_load_dwordx4 v[128:131], v7, s[8:11], s39 offen offset:32
    buffer_load_dwordx4 v[132:135], v22, s[8:11], s39 offen offset:64
    s_waitcnt vmcnt(9)
    v_mov_b32 v144, 0
    v_mov_b32 v145, 0
    v_mov_b32 v146, 0
    v_mov_b32 v147, 0
    v_mov_b32 v148, 0
    v_mov_b32 v149, 0
    v_mov_b32 v150, 0
    v_mov_b32 v151, 0
    v_mov_b32 v152, 0
    v_mov_b32 v153, 0
    v_mov_b32 v154, 0
    v_mov_b32 v155, 0
    v_mov_b32 v156, 0
    v_mov_b32 v157, 0
    v_mov_b32 v158, 0
    v_mov_b32 v159, 0
    v_mov_b32 v160, 0
    v_mov_b32 v161, 0
    v_mov_b32 v162, 0
    v_mov_b32 v163, 0
    v_mov_b32 v164, 0
    v_mov_b32 v165, 0
    v_mov_b32 v166, 0
    v_mov_b32 v167, 0
    v_mov_b32 v168, 0
    v_mov_b32 v169, 0
    v_mov_b32 v170, 0
    v_mov_b32 v171, 0
    v_mov_b32 v172, 0
    v_mov_b32 v173, 0
    v_mov_b32 v174, 0
    v_mov_b32 v175, 0
    s_nop 1
    v_mfma_f32_32x32x16_bf16 v[144:159], v[64:67], v[76:79], v[144:159]
    v_mfma_f32_32x32x16_bf16 v[160:175], v[64:67], v[88:91], v[160:175]
    v_mfma_f32_32x32x16_bf16 v[144:159], v[68:71], v[80:83], v[144:159]
    v_mfma_f32_32x32x16_bf16 v[160:175], v[68:71], v[92:95], v[160:175]
    v_mfma_f32_32x32x16_bf16 v[144:159], v[72:75], v[84:87], v[144:159]
    v_mfma_f32_32x32x16_bf16 v[160:175], v[72:75], v[96:99], v[160:175]
    s_nop 15
    s_add_u32 s37, s36, 4
    s_mul_i32 s37, s37, 40
    v_cndmask_b32 v10, v156, v152, s[46:47]
    v_add_f32 v10, 0x358637bd, v10
    v_rcp_f32 v10, v10
    s_nop 0
    v_mul_f32 v144, v144, v10
    v_mul_f32 v145, v145, v10
    v_mul_f32 v146, v146, v10
    v_mul_f32 v147, v147, v10
    v_mul_f32 v148, v148, v10
    v_mul_f32 v149, v149, v10
    v_mul_f32 v150, v150, v10
    v_mul_f32 v151, v151, v10
    v_mul_f32 v152, v152, v10
    v_mul_f32 v153, v153, v10
    v_mul_f32 v154, v154, v10
    v_mul_f32 v155, v155, v10
    v_cvt_pk_bf16_f32 v12, v144, v145
    v_cvt_pk_bf16_f32 v13, v146, v147
    v_cvt_pk_bf16_f32 v14, v148, v149
    v_cvt_pk_bf16_f32 v15, v150, v151
    v_cvt_pk_bf16_f32 v16, v152, v153
    v_cvt_pk_bf16_f32 v17, v154, v155
    v_add_u32 v11, s37, v8
    ds_write_b64 v11, v[12:13]
    ds_write_b64 v11, v[14:15] offset:16
    s_mov_b64 exec, s[44:45]
    ds_write_b64 v11, v[16:17] offset:32
    s_mov_b64 exec, -1
    v_cndmask_b32 v10, v172, v168, s[46:47]
    v_add_f32 v10, 0x358637bd, v10
    v_rcp_f32 v10, v10
    s_nop 0
    v_mul_f32 v160, v160, v10
    v_mul_f32 v161, v161, v10
    v_mul_f32 v162, v162, v10
    v_mul_f32 v163, v163, v10
    v_mul_f32 v164, v164, v10
    v_mul_f32 v165, v165, v10
    v_mul_f32 v166, v166, v10
    v_mul_f32 v167, v167, v10
    v_mul_f32 v168, v168, v10
    v_mul_f32 v169, v169, v10
    v_mul_f32 v170, v170, v10
    v_mul_f32 v171, v171, v10
    v_cvt_pk_bf16_f32 v12, v160, v161
    v_cvt_pk_bf16_f32 v13, v162, v163
    v_cvt_pk_bf16_f32 v14, v164, v165
    v_cvt_pk_bf16_f32 v15, v166, v167
    v_cvt_pk_bf16_f32 v16, v168, v169
    v_cvt_pk_bf16_f32 v17, v170, v171
    v_add_u32 v11, s37, v9
    ds_write_b64 v11, v[12:13]
    ds_write_b64 v11, v[14:15] offset:16
    s_mov_b64 exec, s[44:45]
    ds_write_b64 v11, v[16:17] offset:32
    s_mov_b64 exec, -1
    s_add_u32 s37, s36, 6
    s_mul_i32 s38, s37, 3072
    s_add_u32 s38, s38, 20561920
    s_mul_i32 s39, s37, 80
    s_add_u32 s39, s39, 10076160
    buffer_load_dwordx4 v[64:67], v5, s[8:11], s38 offen offset:0
    buffer_load_dwordx4 v[68:71], v5, s[8:11], s38 offen offset:1024
    buffer_load_dwordx4 v[72:75], v5, s[8:11], s38 offen offset:2048
    buffer_load_dwordx4 v[76:79], v6, s[8:11], s39 offen offset:0
    buffer_load_dwordx4 v[80:83], v6, s[8:11], s39 offen offset:32
    buffer_load_dwordx4 v[84:87], v21, s[8:11], s39 offen offset:64
    buffer_load_dwordx4 v[88:91], v7, s[8:11], s39 offen offset:0
    buffer_load_dwordx4 v[92:95], v7, s[8:11], s39 offen offset:32
    buffer_load_dwordx4 v[96:99], v22, s[8:11], s39 offen offset:64
    s_waitcnt vmcnt(9)
    v_mov_b32 v144, 0
    v_mov_b32 v145, 0
    v_mov_b32 v146, 0
    v_mov_b32 v147, 0
    v_mov_b32 v148, 0
    v_mov_b32 v149, 0
    v_mov_b32 v150, 0
    v_mov_b32 v151, 0
    v_mov_b32 v152, 0
    v_mov_b32 v153, 0
    v_mov_b32 v154, 0
    v_mov_b32 v155, 0
    v_mov_b32 v156, 0
    v_mov_b32 v157, 0
    v_mov_b32 v158, 0
    v_mov_b32 v159, 0
    v_mov_b32 v160, 0
    v_mov_b32 v161, 0
    v_mov_b32 v162, 0
    v_mov_b32 v163, 0
    v_mov_b32 v164, 0
    v_mov_b32 v165, 0
    v_mov_b32 v166, 0
    v_mov_b32 v167, 0
    v_mov_b32 v168, 0
    v_mov_b32 v169, 0
    v_mov_b32 v170, 0
    v_mov_b32 v171, 0
    v_mov_b32 v172, 0
    v_mov_b32 v173, 0
    v_mov_b32 v174, 0
    v_mov_b32 v175, 0
    s_nop 1
    v_mfma_f32_32x32x16_bf16 v[144:159], v[100:103], v[112:115], v[144:159]
    v_mfma_f32_32x32x16_bf16 v[160:175], v[100:103], v[124:127], v[160:175]
    v_mfma_f32_32x32x16_bf16 v[144:159], v[104:107], v[116:119], v[144:159]
    v_mfma_f32_32x32x16_bf16 v[160:175], v[104:107], v[128:131], v[160:175]
    v_mfma_f32_32x32x16_bf16 v[144:159], v[108:111], v[120:123], v[144:159]
    v_mfma_f32_32x32x16_bf16 v[160:175], v[108:111], v[132:135], v[160:175]
    s_nop 15
    s_add_u32 s37, s36, 5
    s_mul_i32 s37, s37, 40
    v_cndmask_b32 v10, v156, v152, s[46:47]
    v_add_f32 v10, 0x358637bd, v10
    v_rcp_f32 v10, v10
    s_nop 0
    v_mul_f32 v144, v144, v10
    v_mul_f32 v145, v145, v10
    v_mul_f32 v146, v146, v10
    v_mul_f32 v147, v147, v10
    v_mul_f32 v148, v148, v10
    v_mul_f32 v149, v149, v10
    v_mul_f32 v150, v150, v10
    v_mul_f32 v151, v151, v10
    v_mul_f32 v152, v152, v10
    v_mul_f32 v153, v153, v10
    v_mul_f32 v154, v154, v10
    v_mul_f32 v155, v155, v10
    v_cvt_pk_bf16_f32 v12, v144, v145
    v_cvt_pk_bf16_f32 v13, v146, v147
    v_cvt_pk_bf16_f32 v14, v148, v149
    v_cvt_pk_bf16_f32 v15, v150, v151
    v_cvt_pk_bf16_f32 v16, v152, v153
    v_cvt_pk_bf16_f32 v17, v154, v155
    v_add_u32 v11, s37, v8
    ds_write_b64 v11, v[12:13]
    ds_write_b64 v11, v[14:15] offset:16
    s_mov_b64 exec, s[44:45]
    ds_write_b64 v11, v[16:17] offset:32
    s_mov_b64 exec, -1
    v_cndmask_b32 v10, v172, v168, s[46:47]
    v_add_f32 v10, 0x358637bd, v10
    v_rcp_f32 v10, v10
    s_nop 0
    v_mul_f32 v160, v160, v10
    v_mul_f32 v161, v161, v10
    v_mul_f32 v162, v162, v10
    v_mul_f32 v163, v163, v10
    v_mul_f32 v164, v164, v10
    v_mul_f32 v165, v165, v10
    v_mul_f32 v166, v166, v10
    v_mul_f32 v167, v167, v10
    v_mul_f32 v168, v168, v10
    v_mul_f32 v169, v169, v10
    v_mul_f32 v170, v170, v10
    v_mul_f32 v171, v171, v10
    v_cvt_pk_bf16_f32 v12, v160, v161
    v_cvt_pk_bf16_f32 v13, v162, v163
    v_cvt_pk_bf16_f32 v14, v164, v165
    v_cvt_pk_bf16_f32 v15, v166, v167
    v_cvt_pk_bf16_f32 v16, v168, v169
    v_cvt_pk_bf16_f32 v17, v170, v171
    v_add_u32 v11, s37, v9
    ds_write_b64 v11, v[12:13]
    ds_write_b64 v11, v[14:15] offset:16
    s_mov_b64 exec, s[44:45]
    ds_write_b64 v11, v[16:17] offset:32
    s_mov_b64 exec, -1
    s_add_u32 s37, s36, 7
    s_mul_i32 s38, s37, 3072
    s_add_u32 s38, s38, 20561920
    s_mul_i32 s39, s37, 80
    s_add_u32 s39, s39, 10076160
    buffer_load_dwordx4 v[100:103], v5, s[8:11], s38 offen offset:0
    buffer_load_dwordx4 v[104:107], v5, s[8:11], s38 offen offset:1024
    buffer_load_dwordx4 v[108:111], v5, s[8:11], s38 offen offset:2048
    buffer_load_dwordx4 v[112:115], v6, s[8:11], s39 offen offset:0
    buffer_load_dwordx4 v[116:119], v6, s[8:11], s39 offen offset:32
    buffer_load_dwordx4 v[120:123], v21, s[8:11], s39 offen offset:64
    buffer_load_dwordx4 v[124:127], v7, s[8:11], s39 offen offset:0
    buffer_load_dwordx4 v[128:131], v7, s[8:11], s39 offen offset:32
    buffer_load_dwordx4 v[132:135], v22, s[8:11], s39 offen offset:64
    s_waitcnt vmcnt(9)
    v_mov_b32 v144, 0
    v_mov_b32 v145, 0
    v_mov_b32 v146, 0
    v_mov_b32 v147, 0
    v_mov_b32 v148, 0
    v_mov_b32 v149, 0
    v_mov_b32 v150, 0
    v_mov_b32 v151, 0
    v_mov_b32 v152, 0
    v_mov_b32 v153, 0
    v_mov_b32 v154, 0
    v_mov_b32 v155, 0
    v_mov_b32 v156, 0
    v_mov_b32 v157, 0
    v_mov_b32 v158, 0
    v_mov_b32 v159, 0
    v_mov_b32 v160, 0
    v_mov_b32 v161, 0
    v_mov_b32 v162, 0
    v_mov_b32 v163, 0
    v_mov_b32 v164, 0
    v_mov_b32 v165, 0
    v_mov_b32 v166, 0
    v_mov_b32 v167, 0
    v_mov_b32 v168, 0
    v_mov_b32 v169, 0
    v_mov_b32 v170, 0
    v_mov_b32 v171, 0
    v_mov_b32 v172, 0
    v_mov_b32 v173, 0
    v_mov_b32 v174, 0
    v_mov_b32 v175, 0
    s_nop 1
    v_mfma_f32_32x32x16_bf16 v[144:159], v[64:67], v[76:79], v[144:159]
    v_mfma_f32_32x32x16_bf16 v[160:175], v[64:67], v[88:91], v[160:175]
    v_mfma_f32_32x32x16_bf16 v[144:159], v[68:71], v[80:83], v[144:159]
    v_mfma_f32_32x32x16_bf16 v[160:175], v[68:71], v[92:95], v[160:175]
    v_mfma_f32_32x32x16_bf16 v[144:159], v[72:75], v[84:87], v[144:159]
    v_mfma_f32_32x32x16_bf16 v[160:175], v[72:75], v[96:99], v[160:175]
    s_nop 15
    s_add_u32 s37, s36, 6
    s_mul_i32 s37, s37, 40
    v_cndmask_b32 v10, v156, v152, s[46:47]
    v_add_f32 v10, 0x358637bd, v10
    v_rcp_f32 v10, v10
    s_nop 0
    v_mul_f32 v144, v144, v10
    v_mul_f32 v145, v145, v10
    v_mul_f32 v146, v146, v10
    v_mul_f32 v147, v147, v10
    v_mul_f32 v148, v148, v10
    v_mul_f32 v149, v149, v10
    v_mul_f32 v150, v150, v10
    v_mul_f32 v151, v151, v10
    v_mul_f32 v152, v152, v10
    v_mul_f32 v153, v153, v10
    v_mul_f32 v154, v154, v10
    v_mul_f32 v155, v155, v10
    v_cvt_pk_bf16_f32 v12, v144, v145
    v_cvt_pk_bf16_f32 v13, v146, v147
    v_cvt_pk_bf16_f32 v14, v148, v149
    v_cvt_pk_bf16_f32 v15, v150, v151
    v_cvt_pk_bf16_f32 v16, v152, v153
    v_cvt_pk_bf16_f32 v17, v154, v155
    v_add_u32 v11, s37, v8
    ds_write_b64 v11, v[12:13]
    ds_write_b64 v11, v[14:15] offset:16
    s_mov_b64 exec, s[44:45]
    ds_write_b64 v11, v[16:17] offset:32
    s_mov_b64 exec, -1
    v_cndmask_b32 v10, v172, v168, s[46:47]
    v_add_f32 v10, 0x358637bd, v10
    v_rcp_f32 v10, v10
    s_nop 0
    v_mul_f32 v160, v160, v10
    v_mul_f32 v161, v161, v10
    v_mul_f32 v162, v162, v10
    v_mul_f32 v163, v163, v10
    v_mul_f32 v164, v164, v10
    v_mul_f32 v165, v165, v10
    v_mul_f32 v166, v166, v10
    v_mul_f32 v167, v167, v10
    v_mul_f32 v168, v168, v10
    v_mul_f32 v169, v169, v10
    v_mul_f32 v170, v170, v10
    v_mul_f32 v171, v171, v10
    v_cvt_pk_bf16_f32 v12, v160, v161
    v_cvt_pk_bf16_f32 v13, v162, v163
    v_cvt_pk_bf16_f32 v14, v164, v165
    v_cvt_pk_bf16_f32 v15, v166, v167
    v_cvt_pk_bf16_f32 v16, v168, v169
    v_cvt_pk_bf16_f32 v17, v170, v171
    v_add_u32 v11, s37, v9
    ds_write_b64 v11, v[12:13]
    ds_write_b64 v11, v[14:15] offset:16
    s_mov_b64 exec, s[44:45]
    ds_write_b64 v11, v[16:17] offset:32
    s_mov_b64 exec, -1
    s_waitcnt vmcnt(0)
    v_mov_b32 v144, 0
    v_mov_b32 v145, 0
    v_mov_b32 v146, 0
    v_mov_b32 v147, 0
    v_mov_b32 v148, 0
    v_mov_b32 v149, 0
    v_mov_b32 v150, 0
    v_mov_b32 v151, 0
    v_mov_b32 v152, 0
    v_mov_b32 v153, 0
    v_mov_b32 v154, 0
    v_mov_b32 v155, 0
    v_mov_b32 v156, 0
    v_mov_b32 v157, 0
    v_mov_b32 v158, 0
    v_mov_b32 v159, 0
    v_mov_b32 v160, 0
    v_mov_b32 v161, 0
    v_mov_b32 v162, 0
    v_mov_b32 v163, 0
    v_mov_b32 v164, 0
    v_mov_b32 v165, 0
    v_mov_b32 v166, 0
    v_mov_b32 v167, 0
    v_mov_b32 v168, 0
    v_mov_b32 v169, 0
    v_mov_b32 v170, 0
    v_mov_b32 v171, 0
    v_mov_b32 v172, 0
    v_mov_b32 v173, 0
    v_mov_b32 v174, 0
    v_mov_b32 v175, 0
    s_nop 1
    v_mfma_f32_32x32x16_bf16 v[144:159], v[100:103], v[112:115], v[144:159]
    v_mfma_f32_32x32x16_bf16 v[160:175], v[100:103], v[124:127], v[160:175]
    v_mfma_f32_32x32x16_bf16 v[144:159], v[104:107], v[116:119], v[144:159]
    v_mfma_f32_32x32x16_bf16 v[160:175], v[104:107], v[128:131], v[160:175]
    v_mfma_f32_32x32x16_bf16 v[144:159], v[108:111], v[120:123], v[144:159]
    v_mfma_f32_32x32x16_bf16 v[160:175], v[108:111], v[132:135], v[160:175]
    s_nop 15
    s_add_u32 s37, s36, 7
    s_mul_i32 s37, s37, 40
    v_cndmask_b32 v10, v156, v152, s[46:47]
    v_add_f32 v10, 0x358637bd, v10
    v_rcp_f32 v10, v10
    s_nop 0
    v_mul_f32 v144, v144, v10
    v_mul_f32 v145, v145, v10
    v_mul_f32 v146, v146, v10
    v_mul_f32 v147, v147, v10
    v_mul_f32 v148, v148, v10
    v_mul_f32 v149, v149, v10
    v_mul_f32 v150, v150, v10
    v_mul_f32 v151, v151, v10
    v_mul_f32 v152, v152, v10
    v_mul_f32 v153, v153, v10
    v_mul_f32 v154, v154, v10
    v_mul_f32 v155, v155, v10
    v_cvt_pk_bf16_f32 v12, v144, v145
    v_cvt_pk_bf16_f32 v13, v146, v147
    v_cvt_pk_bf16_f32 v14, v148, v149
    v_cvt_pk_bf16_f32 v15, v150, v151
    v_cvt_pk_bf16_f32 v16, v152, v153
    v_cvt_pk_bf16_f32 v17, v154, v155
    v_add_u32 v11, s37, v8
    ds_write_b64 v11, v[12:13]
    ds_write_b64 v11, v[14:15] offset:16
    s_mov_b64 exec, s[44:45]
    ds_write_b64 v11, v[16:17] offset:32
    s_mov_b64 exec, -1
    v_cndmask_b32 v10, v172, v168, s[46:47]
    v_add_f32 v10, 0x358637bd, v10
    v_rcp_f32 v10, v10
    s_nop 0
    v_mul_f32 v160, v160, v10
    v_mul_f32 v161, v161, v10
    v_mul_f32 v162, v162, v10
    v_mul_f32 v163, v163, v10
    v_mul_f32 v164, v164, v10
    v_mul_f32 v165, v165, v10
    v_mul_f32 v166, v166, v10
    v_mul_f32 v167, v167, v10
    v_mul_f32 v168, v168, v10
    v_mul_f32 v169, v169, v10
    v_mul_f32 v170, v170, v10
    v_mul_f32 v171, v171, v10
    v_cvt_pk_bf16_f32 v12, v160, v161
    v_cvt_pk_bf16_f32 v13, v162, v163
    v_cvt_pk_bf16_f32 v14, v164, v165
    v_cvt_pk_bf16_f32 v15, v166, v167
    v_cvt_pk_bf16_f32 v16, v168, v169
    v_cvt_pk_bf16_f32 v17, v170, v171
    v_add_u32 v11, s37, v9
    ds_write_b64 v11, v[12:13]
    ds_write_b64 v11, v[14:15] offset:16
    s_mov_b64 exec, s[44:45]
    ds_write_b64 v11, v[16:17] offset:32
    s_mov_b64 exec, -1
    s_waitcnt lgkmcnt(0)
    s_barrier
    s_lshl_b32 s37, s35, 2
    s_add_u32 s37, s37, s32
    s_mul_i32 s36, s37, 40960
    s_add_u32 s36, s36, 2621440
    v_mov_b32 v192, 0
    v_mov_b32 v193, 0
    v_mov_b32 v194, 0
    v_mov_b32 v195, 0
    v_mov_b32 v196, 0
    v_mov_b32 v197, 0
    v_mov_b32 v198, 0
    v_mov_b32 v199, 0
    v_mov_b32 v200, 0
    v_mov_b32 v201, 0
    v_mov_b32 v202, 0
    v_mov_b32 v203, 0
    v_mov_b32 v204, 0
    v_mov_b32 v205, 0
    v_mov_b32 v206, 0
    v_mov_b32 v207, 0
    v_mov_b32 v208, 0
    v_mov_b32 v209, 0
    v_mov_b32 v210, 0
    v_mov_b32 v211, 0
    v_mov_b32 v212, 0
    v_mov_b32 v213, 0
    v_mov_b32 v214, 0
    v_mov_b32 v215, 0
    v_mov_b32 v216, 0
    v_mov_b32 v217, 0
    v_mov_b32 v218, 0
    v_mov_b32 v219, 0
    v_mov_b32 v220, 0
    v_mov_b32 v221, 0
    v_mov_b32 v222, 0
    v_mov_b32 v223, 0
    v_add_u32 v44, 0, v5
    v_mul_u32_u24 v46, 1296, v2
    v_lshl_add_u32 v46, v3, 4, v46
    s_mov_b32 s40, s36
    s_add_u32 s41, s40, 4096
    s_add_u32 s42, s40, 8192
    s_add_u32 s43, s40, 12288
    s_add_u32 s44, s40, 16384
    buffer_load_dwordx4 v[64:67], v44, s[8:11], s40 offen offset:0
    buffer_load_dwordx4 v[68:71], v44, s[8:11], s40 offen offset:1024
    buffer_load_dwordx4 v[72:75], v44, s[8:11], s40 offen offset:2048
    buffer_load_dwordx4 v[76:79], v44, s[8:11], s40 offen offset:3072
    buffer_load_dwordx4 v[80:83], v44, s[8:11], s41 offen offset:0
    buffer_load_dwordx4 v[84:87], v44, s[8:11], s41 offen offset:1024
    buffer_load_dwordx4 v[88:91], v44, s[8:11], s41 offen offset:2048
    buffer_load_dwordx4 v[92:95], v44, s[8:11], s41 offen offset:3072
    buffer_load_dwordx4 v[96:99], v44, s[8:11], s42 offen offset:0
    buffer_load_dwordx4 v[100:103], v44, s[8:11], s42 offen offset:1024
    buffer_load_dwordx4 v[104:107], v44, s[8:11], s42 offen offset:2048
    buffer_load_dwordx4 v[108:111], v44, s[8:11], s42 offen offset:3072
    buffer_load_dwordx4 v[112:115], v44, s[8:11], s43 offen offset:0
    buffer_load_dwordx4 v[116:119], v44, s[8:11], s43 offen offset:1024
    buffer_load_dwordx4 v[120:123], v44, s[8:11], s43 offen offset:2048
    buffer_load_dwordx4 v[124:127], v44, s[8:11], s43 offen offset:3072
    buffer_load_dwordx4 v[128:131], v44, s[8:11], s44 offen offset:0
    buffer_load_dwordx4 v[132:135], v44, s[8:11], s44 offen offset:1024
    buffer_load_dwordx4 v[136:139], v44, s[8:11], s44 offen offset:2048
    buffer_load_dwordx4 v[140:143], v44, s[8:11], s44 offen offset:3072
    s_add_u32 s40, s40, 20480
    s_add_u32 s41, s41, 20480
    s_add_u32 s42, s42, 20480
    s_add_u32 s43, s43, 20480
    s_add_u32 s44, s44, 20480
    ds_read_b128 v[48:51], v46 offset:0
    ds_read_b128 v[52:55], v46 offset:41472
    s_mov_b32 s48, 2
gl_k2a_kernel:
    ds_read_b128 v[56:59], v46 offset:32
    ds_read_b128 v[60:63], v46 offset:41504
    s_waitcnt vmcnt(19) lgkmcnt(2)
    v_mfma_f32_32x32x16_bf16 v[192:207], v[64:67], v[48:51], v[192:207]
    v_mfma_f32_32x32x16_bf16 v[208:223], v[64:67], v[52:55], v[208:223]
    buffer_load_dwordx4 v[64:67], v44, s[8:11], s40 offen offset:0
    ds_read_b128 v[48:51], v46 offset:64
    ds_read_b128 v[52:55], v46 offset:41536
    s_waitcnt vmcnt(19) lgkmcnt(2)
    v_mfma_f32_32x32x16_bf16 v[192:207], v[68:71], v[56:59], v[192:207]
    v_mfma_f32_32x32x16_bf16 v[208:223], v[68:71], v[60:63], v[208:223]
    buffer_load_dwordx4 v[68:71], v44, s[8:11], s40 offen offset:1024
    ds_read_b128 v[56:59], v46 offset:96
    ds_read_b128 v[60:63], v46 offset:41568
    s_waitcnt vmcnt(19) lgkmcnt(2)
    v_mfma_f32_32x32x16_bf16 v[192:207], v[72:75], v[48:51], v[192:207]
    v_mfma_f32_32x32x16_bf16 v[208:223], v[72:75], v[52:55], v[208:223]
    buffer_load_dwordx4 v[72:75], v44, s[8:11], s40 offen offset:2048
    ds_read_b128 v[48:51], v46 offset:128
    ds_read_b128 v[52:55], v46 offset:41600
    s_waitcnt vmcnt(19) lgkmcnt(2)
    v_mfma_f32_32x32x16_bf16 v[192:207], v[76:79], v[56:59], v[192:207]
    v_mfma_f32_32x32x16_bf16 v[208:223], v[76:79], v[60:63], v[208:223]
    buffer_load_dwordx4 v[76:79], v44, s[8:11], s40 offen offset:3072
    ds_read_b128 v[56:59], v46 offset:160
    ds_read_b128 v[60:63], v46 offset:41632
    s_waitcnt vmcnt(19) lgkmcnt(2)
    v_mfma_f32_32x32x16_bf16 v[192:207], v[80:83], v[48:51], v[192:207]
    v_mfma_f32_32x32x16_bf16 v[208:223], v[80:83], v[52:55], v[208:223]
    buffer_load_dwordx4 v[80:83], v44, s[8:11], s41 offen offset:0
    ds_read_b128 v[48:51], v46 offset:192
    ds_read_b128 v[52:55], v46 offset:41664
    s_waitcnt vmcnt(19) lgkmcnt(2)
    v_mfma_f32_32x32x16_bf16 v[192:207], v[84:87], v[56:59], v[192:207]
    v_mfma_f32_32x32x16_bf16 v[208:223], v[84:87], v[60:63], v[208:223]
    buffer_load_dwordx4 v[84:87], v44, s[8:11], s41 offen offset:1024
    ds_read_b128 v[56:59], v46 offset:224
    ds_read_b128 v[60:63], v46 offset:41696
    s_waitcnt vmcnt(19) lgkmcnt(2)
    v_mfma_f32_32x32x16_bf16 v[192:207], v[88:91], v[48:51], v[192:207]
    v_mfma_f32_32x32x16_bf16 v[208:223], v[88:91], v[52:55], v[208:223]
    buffer_load_dwordx4 v[88:91], v44, s[8:11], s41 offen offset:2048
    ds_read_b128 v[48:51], v46 offset:256
    ds_read_b128 v[52:55], v46 offset:41728
    s_waitcnt vmcnt(19) lgkmcnt(2)
    v_mfma_f32_32x32x16_bf16 v[192:207], v[92:95], v[56:59], v[192:207]
    v_mfma_f32_32x32x16_bf16 v[208:223], v[92:95], v[60:63], v[208:223]
    buffer_load_dwordx4 v[92:95], v44, s[8:11], s41 offen offset:3072
    ds_read_b128 v[56:59], v46 offset:288
    ds_read_b128 v[60:63], v46 offset:41760
    s_waitcnt vmcnt(19) lgkmcnt(2)
    v_mfma_f32_32x32x16_bf16 v[192:207], v[96:99], v[48:51], v[192:207]
    v_mfma_f32_32x32x16_bf16 v[208:223], v[96:99], v[52:55], v[208:223]
    buffer_load_dwordx4 v[96:99], v44, s[8:11], s42 offen offset:0
    ds_read_b128 v[48:51], v46 offset:320
    ds_read_b128 v[52:55], v46 offset:41792
    s_waitcnt vmcnt(19) lgkmcnt(2)
    v_mfma_f32_32x32x16_bf16 v[192:207], v[100:103], v[56:59], v[192:207]
    v_mfma_f32_32x32x16_bf16 v[208:223], v[100:103], v[60:63], v[208:223]
    buffer_load_dwordx4 v[100:103], v44, s[8:11], s42 offen offset:1024
    ds_read_b128 v[56:59], v46 offset:352
    ds_read_b128 v[60:63], v46 offset:41824
    s_waitcnt vmcnt(19) lgkmcnt(2)
    v_mfma_f32_32x32x16_bf16 v[192:207], v[104:107], v[48:51], v[192:207]
    v_mfma_f32_32x32x16_bf16 v[208:223], v[104:107], v[52:55], v[208:223]
    buffer_load_dwordx4 v[104:107], v44, s[8:11], s42 offen offset:2048
    ds_read_b128 v[48:51], v46 offset:384
    ds_read_b128 v[52:55], v46 offset:41856
    s_waitcnt vmcnt(19) lgkmcnt(2)
    v_mfma_f32_32x32x16_bf16 v[192:207], v[108:111], v[56:59], v[192:207]
    v_mfma_f32_32x32x16_bf16 v[208:223], v[108:111], v[60:63], v[208:223]
    buffer_load_dwordx4 v[108:111], v44, s[8:11], s42 offen offset:3072
    ds_read_b128 v[56:59], v46 offset:416
    ds_read_b128 v[60:63], v46 offset:41888
    s_waitcnt vmcnt(19) lgkmcnt(2)
    v_mfma_f32_32x32x16_bf16 v[192:207], v[112:115], v[48:51], v[192:207]
    v_mfma_f32_32x32x16_bf16 v[208:223], v[112:115], v[52:55], v[208:223]
    buffer_load_dwordx4 v[112:115], v44, s[8:11], s43 offen offset:0
    ds_read_b128 v[48:51], v46 offset:448
    ds_read_b128 v[52:55], v46 offset:41920
    s_waitcnt vmcnt(19) lgkmcnt(2)
    v_mfma_f32_32x32x16_bf16 v[192:207], v[116:119], v[56:59], v[192:207]
    v_mfma_f32_32x32x16_bf16 v[208:223], v[116:119], v[60:63], v[208:223]
    buffer_load_dwordx4 v[116:119], v44, s[8:11], s43 offen offset:1024
    ds_read_b128 v[56:59], v46 offset:480
    ds_read_b128 v[60:63], v46 offset:41952
    s_waitcnt vmcnt(19) lgkmcnt(2)
    v_mfma_f32_32x32x16_bf16 v[192:207], v[120:123], v[48:51], v[192:207]
    v_mfma_f32_32x32x16_bf16 v[208:223], v[120:123], v[52:55], v[208:223]
    buffer_load_dwordx4 v[120:123], v44, s[8:11], s43 offen offset:2048
    ds_read_b128 v[48:51], v46 offset:512
    ds_read_b128 v[52:55], v46 offset:41984
    s_waitcnt vmcnt(19) lgkmcnt(2)
    v_mfma_f32_32x32x16_bf16 v[192:207], v[124:127], v[56:59], v[192:207]
    v_mfma_f32_32x32x16_bf16 v[208:223], v[124:127], v[60:63], v[208:223]
    buffer_load_dwordx4 v[124:127], v44, s[8:11], s43 offen offset:3072
    ds_read_b128 v[56:59], v46 offset:544
    ds_read_b128 v[60:63], v46 offset:42016
    s_waitcnt vmcnt(19) lgkmcnt(2)
    v_mfma_f32_32x32x16_bf16 v[192:207], v[128:131], v[48:51], v[192:207]
    v_mfma_f32_32x32x16_bf16 v[208:223], v[128:131], v[52:55], v[208:223]
    buffer_load_dwordx4 v[128:131], v44, s[8:11], s44 offen offset:0
    ds_read_b128 v[48:51], v46 offset:576
    ds_read_b128 v[52:55], v46 offset:42048
    s_waitcnt vmcnt(19) lgkmcnt(2)
    v_mfma_f32_32x32x16_bf16 v[192:207], v[132:135], v[56:59], v[192:207]
    v_mfma_f32_32x32x16_bf16 v[208:223], v[132:135], v[60:63], v[208:223]
    buffer_load_dwordx4 v[132:135], v44, s[8:11], s44 offen offset:1024
    ds_read_b128 v[56:59], v46 offset:608
    ds_read_b128 v[60:63], v46 offset:42080
    s_waitcnt vmcnt(19) lgkmcnt(2)
    v_mfma_f32_32x32x16_bf16 v[192:207], v[136:139], v[48:51], v[192:207]
    v_mfma_f32_32x32x16_bf16 v[208:223], v[136:139], v[52:55], v[208:223]
    buffer_load_dwordx4 v[136:139], v44, s[8:11], s44 offen offset:2048
    ds_read_b128 v[48:51], v46 offset:640
    ds_read_b128 v[52:55], v46 offset:42112
    s_waitcnt vmcnt(19) lgkmcnt(2)
    v_mfma_f32_32x32x16_bf16 v[192:207], v[140:143], v[56:59], v[192:207]
    v_mfma_f32_32x32x16_bf16 v[208:223], v[140:143], v[60:63], v[208:223]
    buffer_load_dwordx4 v[140:143], v44, s[8:11], s44 offen offset:3072
    s_add_u32 s40, s40, 20480
    s_add_u32 s41, s41, 20480
    s_add_u32 s42, s42, 20480
    s_add_u32 s43, s43, 20480
    s_add_u32 s44, s44, 20480
    v_add_u32 v46, 640, v46
    s_sub_u32 s48, s48, 1
    s_cmp_lg_u32 s48, 0
    s_cbranch_scc1 gl_k2a_kernel
    s_waitcnt vmcnt(0) lgkmcnt(0)
    s_nop 15
    s_lshl_b32 s37, s37, 5
    s_mov_b32 s30, 0
    s_mov_b32 s31, 20660224
    v_add_u32 v6, s34, v2
    v_add_u32 v6, 0, v6
    v_mul_u32_u24 v6, 1280, v6
    v_lshl_add_u32 v6, v3, 3, v6
    v_mov_b32 v7, s37
    v_lshl_add_u32 v6, v7, 1, v6
    buffer_load_dwordx2 v[8:9], v6, s[16:19], s30 offen offset:0
    buffer_load_dwordx2 v[10:11], v6, s[16:19], s30 offen offset:16
    buffer_load_dwordx2 v[12:13], v6, s[16:19], s30 offen offset:32
    buffer_load_dwordx2 v[14:15], v6, s[16:19], s30 offen offset:48
    s_waitcnt vmcnt(0)
    v_lshlrev_b32 v7, 16, v8
    v_add_f32 v192, v192, v7
    v_and_b32 v7, 0xffff0000, v8
    v_add_f32 v193, v193, v7
    v_cvt_pk_bf16_f32 v8, v192, v193
    v_lshlrev_b32 v7, 16, v9
    v_add_f32 v194, v194, v7
    v_and_b32 v7, 0xffff0000, v9
    v_add_f32 v195, v195, v7
    v_cvt_pk_bf16_f32 v9, v194, v195
    buffer_store_dwordx2 v[8:9], v6, s[8:11], s31 offen offset:0
    v_lshlrev_b32 v7, 16, v10
    v_add_f32 v196, v196, v7
    v_and_b32 v7, 0xffff0000, v10
    v_add_f32 v197, v197, v7
    v_cvt_pk_bf16_f32 v10, v196, v197
    v_lshlrev_b32 v7, 16, v11
    v_add_f32 v198, v198, v7
    v_and_b32 v7, 0xffff0000, v11
    v_add_f32 v199, v199, v7
    v_cvt_pk_bf16_f32 v11, v198, v199
    buffer_store_dwordx2 v[10:11], v6, s[8:11], s31 offen offset:16
    v_lshlrev_b32 v7, 16, v12
    v_add_f32 v200, v200, v7
    v_and_b32 v7, 0xffff0000, v12
    v_add_f32 v201, v201, v7
    v_cvt_pk_bf16_f32 v12, v200, v201
    v_lshlrev_b32 v7, 16, v13
    v_add_f32 v202, v202, v7
    v_and_b32 v7, 0xffff0000, v13
    v_add_f32 v203, v203, v7
    v_cvt_pk_bf16_f32 v13, v202, v203
    buffer_store_dwordx2 v[12:13], v6, s[8:11], s31 offen offset:32
    v_lshlrev_b32 v7, 16, v14
    v_add_f32 v204, v204, v7
    v_and_b32 v7, 0xffff0000, v14
    v_add_f32 v205, v205, v7
    v_cvt_pk_bf16_f32 v14, v204, v205
    v_lshlrev_b32 v7, 16, v15
    v_add_f32 v206, v206, v7
    v_and_b32 v7, 0xffff0000, v15
    v_add_f32 v207, v207, v7
    v_cvt_pk_bf16_f32 v15, v206, v207
    buffer_store_dwordx2 v[14:15], v6, s[8:11], s31 offen offset:48
    v_add_u32 v6, s34, v2
    v_add_u32 v6, 32, v6
    v_mul_u32_u24 v6, 1280, v6
    v_lshl_add_u32 v6, v3, 3, v6
    v_mov_b32 v7, s37
    v_lshl_add_u32 v6, v7, 1, v6
    buffer_load_dwordx2 v[8:9], v6, s[16:19], s30 offen offset:0
    buffer_load_dwordx2 v[10:11], v6, s[16:19], s30 offen offset:16
    buffer_load_dwordx2 v[12:13], v6, s[16:19], s30 offen offset:32
    buffer_load_dwordx2 v[14:15], v6, s[16:19], s30 offen offset:48
    s_waitcnt vmcnt(0)
    v_lshlrev_b32 v7, 16, v8
    v_add_f32 v208, v208, v7
    v_and_b32 v7, 0xffff0000, v8
    v_add_f32 v209, v209, v7
    v_cvt_pk_bf16_f32 v8, v208, v209
    v_lshlrev_b32 v7, 16, v9
    v_add_f32 v210, v210, v7
    v_and_b32 v7, 0xffff0000, v9
    v_add_f32 v211, v211, v7
    v_cvt_pk_bf16_f32 v9, v210, v211
    buffer_store_dwordx2 v[8:9], v6, s[8:11], s31 offen offset:0
    v_lshlrev_b32 v7, 16, v10
    v_add_f32 v212, v212, v7
    v_and_b32 v7, 0xffff0000, v10
    v_add_f32 v213, v213, v7
    v_cvt_pk_bf16_f32 v10, v212, v213
    v_lshlrev_b32 v7, 16, v11
    v_add_f32 v214, v214, v7
    v_and_b32 v7, 0xffff0000, v11
    v_add_f32 v215, v215, v7
    v_cvt_pk_bf16_f32 v11, v214, v215
    buffer_store_dwordx2 v[10:11], v6, s[8:11], s31 offen offset:16
    v_lshlrev_b32 v7, 16, v12
    v_add_f32 v216, v216, v7
    v_and_b32 v7, 0xffff0000, v12
    v_add_f32 v217, v217, v7
    v_cvt_pk_bf16_f32 v12, v216, v217
    v_lshlrev_b32 v7, 16, v13
    v_add_f32 v218, v218, v7
    v_and_b32 v7, 0xffff0000, v13
    v_add_f32 v219, v219, v7
    v_cvt_pk_bf16_f32 v13, v218, v219
    buffer_store_dwordx2 v[12:13], v6, s[8:11], s31 offen offset:32
    v_lshlrev_b32 v7, 16, v14
    v_add_f32 v220, v220, v7
    v_and_b32 v7, 0xffff0000, v14
    v_add_f32 v221, v221, v7
    v_cvt_pk_bf16_f32 v14, v220, v221
    v_lshlrev_b32 v7, 16, v15
    v_add_f32 v222, v222, v7
    v_and_b32 v7, 0xffff0000, v15
    v_add_f32 v223, v223, v7
    v_cvt_pk_bf16_f32 v15, v222, v223
    buffer_store_dwordx2 v[14:15], v6, s[8:11], s31 offen offset:48
k2a_kernel_end:
    s_endpgm
.p2align 8
.globl k3a_kernel
.type k3a_kernel,@function
k3a_kernel:
    s_cmp_ge_u32 s2, 448
    s_cbranch_scc1 k3a_kernel_end
    s_load_dwordx2 s[4:5], s[0:1], 80
    s_load_dwordx2 s[6:7], s[0:1], 64
    s_load_dwordx2 s[20:21], s[0:1], 0
    s_waitcnt lgkmcnt(0)
    s_mov_b32 s8, s4
    s_and_b32 s9, s5, 0xffff
    s_mov_b32 s10, 268435456
    s_mov_b32 s11, 0x20000
    s_mov_b32 s12, s6
    s_and_b32 s13, s7, 0xffff
    s_mov_b32 s14, 2621440
    s_mov_b32 s15, 0x20000
    s_mov_b32 s16, s20
    s_and_b32 s17, s21, 0xffff
    s_mov_b32 s18, 2621440
    s_mov_b32 s19, 0x20000
    v_lshrrev_b32 v1, 6, v0
    s_nop 0
    v_readfirstlane_b32 s32, v1
    v_and_b32 v2, 31, v0
    v_bfe_u32 v3, v0, 5, 1
    v_and_b32 v4, 63, v0
    v_lshlrev_b32 v5, 4, v4
    s_mul_hi_u32 s33, s2, 0x92492493
    s_lshr_b32 s33, s33, 3
    s_mul_i32 s35, s33, 14
    s_sub_u32 s35, s2, s35
    s_lshl_b32 s34, s33, 6
    v_lshrrev_b32 v6, 2, v0
    v_and_b32 v7, 3, v0
    v_add_u32 v8, s34, v6
    v_mul_u32_u24 v8, 1280, v8
    v_lshl_add_u32 v8, v7, 4, v8
    s_mov_b32 s30, 20660224
    buffer_load_dwordx4 v[16:19], v8, s[8:11], s30 offen offset:0
    buffer_load_dwordx4 v[20:23], v8, s[8:11], s30 offen offset:64
    buffer_load_dwordx4 v[24:27], v8, s[8:11], s30 offen offset:128
    buffer_load_dwordx4 v[28:31], v8, s[8:11], s30 offen offset:192
    buffer_load_dwordx4 v[32:35], v8, s[8:11], s30 offen offset:256
    buffer_load_dwordx4 v[36:39], v8, s[8:11], s30 offen offset:320
    buffer_load_dwordx4 v[40:43], v8, s[8:11], s30 offen offset:384
    buffer_load_dwordx4 v[44:47], v8, s[8:11], s30 offen offset:448
    buffer_load_dwordx4 v[48:51], v8, s[8:11], s30 offen offset:512
    buffer_load_dwordx4 v[52:55], v8, s[8:11], s30 offen offset:576
    buffer_load_dwordx4 v[56:59], v8, s[8:11], s30 offen offset:640
    buffer_load_dwordx4 v[60:63], v8, s[8:11], s30 offen offset:704
    buffer_load_dwordx4 v[64:67], v8, s[8:11], s30 offen offset:768
    buffer_load_dwordx4 v[68:71], v8, s[8:11], s30 offen offset:832
    buffer_load_dwordx4 v[72:75], v8, s[8:11], s30 offen offset:896
    buffer_load_dwordx4 v[76:79], v8, s[8:11], s30 offen offset:960
    buffer_load_dwordx4 v[80:83], v8, s[8:11], s30 offen offset:1024
    buffer_load_dwordx4 v[84:87], v8, s[8:11], s30 offen offset:1088
    buffer_load_dwordx4 v[88:91], v8, s[8:11], s30 offen offset:1152
    buffer_load_dwordx4 v[92:95], v8, s[8:11], s30 offen offset:1216
    v_mul_u32_u24 v9, 1296, v6
    v_lshl_add_u32 v9, v7, 4, v9
    v_mov_b32 v10, 0
    v_mov_b32 v11, 0
    v_mov_b32 v12, 0x3f803f80
    s_waitcnt vmcnt(0)
    v_dot2c_f32_bf16 v10, v16, v12
    v_dot2c_f32_bf16 v11, v16, v16
    v_dot2c_f32_bf16 v10, v17, v12
    v_dot2c_f32_bf16 v11, v17, v17
    v_dot2c_f32_bf16 v10, v18, v12
    v_dot2c_f32_bf16 v11, v18, v18
    v_dot2c_f32_bf16 v10, v19, v12
    v_dot2c_f32_bf16 v11, v19, v19
    v_dot2c_f32_bf16 v10, v20, v12
    v_dot2c_f32_bf16 v11, v20, v20
    v_dot2c_f32_bf16 v10, v21, v12
    v_dot2c_f32_bf16 v11, v21, v21
    v_dot2c_f32_bf16 v10, v22, v12
    v_dot2c_f32_bf16 v11, v22, v22
    v_dot2c_f32_bf16 v10, v23, v12
    v_dot2c_f32_bf16 v11, v23, v23
    v_dot2c_f32_bf16 v10, v24, v12
    v_dot2c_f32_bf16 v11, v24, v24
    v_dot2c_f32_bf16 v10, v25, v12
    v_dot2c_f32_bf16 v11, v25, v25
    v_dot2c_f32_bf16 v10, v26, v12
    v_dot2c_f32_bf16 v11, v26, v26
    v_dot2c_f32_bf16 v10, v27, v12
    v_dot2c_f32_bf16 v11, v27, v27
    v_dot2c_f32_bf16 v10, v28, v12
    v_dot2c_f32_bf16 v11, v28, v28
    v_dot2c_f32_bf16 v10, v29, v12
    v_dot2c_f32_bf16 v11, v29, v29
    v_dot2c_f32_bf16 v10, v30, v12
    v_dot2c_f32_bf16 v11, v30, v30
    v_dot2c_f32_bf16 v10, v31, v12
    v_dot2c_f32_bf16 v11, v31, v31
    v_dot2c_f32_bf16 v10, v32, v12
    v_dot2c_f32_bf16 v11, v32, v32
    v_dot2c_f32_bf16 v10, v33, v12
    v_dot2c_f32_bf16 v11, v33, v33
    v_dot2c_f32_bf16 v10, v34, v12
    v_dot2c_f32_bf16 v11, v34, v34
    v_dot2c_f32_bf16 v10, v35, v12
    v_dot2c_f32_bf16 v11, v35, v35
    v_dot2c_f32_bf16 v10, v36, v12
    v_dot2c_f32_bf16 v11, v36, v36
    v_dot2c_f32_bf16 v10, v37, v12
    v_dot2c_f32_bf16 v11, v37, v37
    v_dot2c_f32_bf16 v10, v38, v12
    v_dot2c_f32_bf16 v11, v38, v38
    v_dot2c_f32_bf16 v10, v39, v12
    v_dot2c_f32_bf16 v11, v39, v39
    v_dot2c_f32_bf16 v10, v40, v12
    v_dot2c_f32_bf16 v11, v40, v40
    v_dot2c_f32_bf16 v10, v41, v12
    v_dot2c_f32_bf16 v11, v41, v41
    v_dot2c_f32_bf16 v10, v42, v12
    v_dot2c_f32_bf16 v11, v42, v42
    v_dot2c_f32_bf16 v10, v43, v12
    v_dot2c_f32_bf16 v11, v43, v43
    v_dot2c_f32_bf16 v10, v44, v12
    v_dot2c_f32_bf16 v11, v44, v44
    v_dot2c_f32_bf16 v10, v45, v12
    v_dot2c_f32_bf16 v11, v45, v45
    v_dot2c_f32_bf16 v10, v46, v12
    v_dot2c_f32_bf16 v11, v46, v46
    v_dot2c_f32_bf16 v10, v47, v12
    v_dot2c_f32_bf16 v11, v47, v47
    v_dot2c_f32_bf16 v10, v48, v12
    v_dot2c_f32_bf16 v11, v48, v48
    v_dot2c_f32_bf16 v10, v49, v12
    v_dot2c_f32_bf16 v11, v49, v49
    v_dot2c_f32_bf16 v10, v50, v12
    v_dot2c_f32_bf16 v11, v50, v50
    v_dot2c_f32_bf16 v10, v51, v12
    v_dot2c_f32_bf16 v11, v51, v51
    v_dot2c_f32_bf16 v10, v52, v12
    v_dot2c_f32_bf16 v11, v52, v52
    v_dot2c_f32_bf16 v10, v53, v12
    v_dot2c_f32_bf16 v11, v53, v53
    v_dot2c_f32_bf16 v10, v54, v12
    v_dot2c_f32_bf16 v11, v54, v54
    v_dot2c_f32_bf16 v10, v55, v12
    v_dot2c_f32_bf16 v11, v55, v55
    v_dot2c_f32_bf16 v10, v56, v12
    v_dot2c_f32_bf16 v11, v56, v56
    v_dot2c_f32_bf16 v10, v57, v12
    v_dot2c_f32_bf16 v11, v57, v57
    v_dot2c_f32_bf16 v10, v58, v12
    v_dot2c_f32_bf16 v11, v58, v58
    v_dot2c_f32_bf16 v10, v59, v12
    v_dot2c_f32_bf16 v11, v59, v59
    v_dot2c_f32_bf16 v10, v60, v12
    v_dot2c_f32_bf16 v11, v60, v60
    v_dot2c_f32_bf16 v10, v61, v12
    v_dot2c_f32_bf16 v11, v61, v61
    v_dot2c_f32_bf16 v10, v62, v12
    v_dot2c_f32_bf16 v11, v62, v62
    v_dot2c_f32_bf16 v10, v63, v12
    v_dot2c_f32_bf16 v11, v63, v63
    v_dot2c_f32_bf16 v10, v64, v12
    v_dot2c_f32_bf16 v11, v64, v64
    v_dot2c_f32_bf16 v10, v65, v12
    v_dot2c_f32_bf16 v11, v65, v65
    v_dot2c_f32_bf16 v10, v66, v12
    v_dot2c_f32_bf16 v11, v66, v66
    v_dot2c_f32_bf16 v10, v67, v12
    v_dot2c_f32_bf16 v11, v67, v67
    v_dot2c_f32_bf16 v10, v68, v12
    v_dot2c_f32_bf16 v11, v68, v68
    v_dot2c_f32_bf16 v10, v69, v12
    v_dot2c_f32_bf16 v11, v69, v69
    v_dot2c_f32_bf16 v10, v70, v12
    v_dot2c_f32_bf16 v11, v70, v70
    v_dot2c_f32_bf16 v10, v71, v12
    v_dot2c_f32_bf16 v11, v71, v71
    v_dot2c_f32_bf16 v10, v72, v12
    v_dot2c_f32_bf16 v11, v72, v72
    v_dot2c_f32_bf16 v10, v73, v12
    v_dot2c_f32_bf16 v11, v73, v73
    v_dot2c_f32_bf16 v10, v74, v12
    v_dot2c_f32_bf16 v11, v74, v74
    v_dot2c_f32_bf16 v10, v75, v12
    v_dot2c_f32_bf16 v11, v75, v75
    v_dot2c_f32_bf16 v10, v76, v12
    v_dot2c_f32_bf16 v11, v76, v76
    v_dot2c_f32_bf16 v10, v77, v12
    v_dot2c_f32_bf16 v11, v77, v77
    v_dot2c_f32_bf16 v10, v78, v12
    v_dot2c_f32_bf16 v11, v78, v78
    v_dot2c_f32_bf16 v10, v79, v12
    v_dot2c_f32_bf16 v11, v79, v79
    v_dot2c_f32_bf16 v10, v80, v12
    v_dot2c_f32_bf16 v11, v80, v80
    v_dot2c_f32_bf16 v10, v81, v12
    v_dot2c_f32_bf16 v11, v81, v81
    v_dot2c_f32_bf16 v10, v82, v12
    v_dot2c_f32_bf16 v11, v82, v82
    v_dot2c_f32_bf16 v10, v83, v12
    v_dot2c_f32_bf16 v11, v83, v83
    v_dot2c_f32_bf16 v10, v84, v12
    v_dot2c_f32_bf16 v11, v84, v84
    v_dot2c_f32_bf16 v10, v85, v12
    v_dot2c_f32_bf16 v11, v85, v85
    v_dot2c_f32_bf16 v10, v86, v12
    v_dot2c_f32_bf16 v11, v86, v86
    v_dot2c_f32_bf16 v10, v87, v12
    v_dot2c_f32_bf16 v11, v87, v87
    v_dot2c_f32_bf16 v10, v88, v12
    v_dot2c_f32_bf16 v11, v88, v88
    v_dot2c_f32_bf16 v10, v89, v12
    v_dot2c_f32_bf16 v11, v89, v89
    v_dot2c_f32_bf16 v10, v90, v12
    v_dot2c_f32_bf16 v11, v90, v90
    v_dot2c_f32_bf16 v10, v91, v12
    v_dot2c_f32_bf16 v11, v91, v91
    v_dot2c_f32_bf16 v10, v92, v12
    v_dot2c_f32_bf16 v11, v92, v92
    v_dot2c_f32_bf16 v10, v93, v12
    v_dot2c_f32_bf16 v11, v93, v93
    v_dot2c_f32_bf16 v10, v94, v12
    v_dot2c_f32_bf16 v11, v94, v94
    v_dot2c_f32_bf16 v10, v95, v12
    v_dot2c_f32_bf16 v11, v95, v95
    s_nop 3
    v_add_f32_dpp v10, v10, v10 quad_perm:[1,0,3,2] row_mask:0xf bank_mask:0xf
    v_add_f32_dpp v11, v11, v11 quad_perm:[1,0,3,2] row_mask:0xf bank_mask:0xf
    s_nop 1
    v_add_f32_dpp v10, v10, v10 quad_perm:[2,3,0,1] row_mask:0xf bank_mask:0xf
    v_add_f32_dpp v11, v11, v11 quad_perm:[2,3,0,1] row_mask:0xf bank_mask:0xf
    s_nop 1
    v_mul_f32 v10, 0x3acccccd, v10
    v_mul_f32 v11, 0x3acccccd, v11
    v_fma_f32 v11, -v10, v10, v11
    v_max_f32 v11, 0, v11
    v_mov_b32 v14, 0x3727c5ac
    v_add_f32 v14, v14, v11
    v_rsq_f32 v14, v14
    s_nop 0
    v_mul_f32 v15, v10, v14
    v_lshlrev_b32 v12, 16, v16
    v_and_b32 v13, 0xffff0000, v16
    v_fma_f32 v12, v12, v14, -v15
    v_fma_f32 v13, v13, v14, -v15
    v_cvt_pk_bf16_f32 v16, v12, v13
    v_lshlrev_b32 v12, 16, v17
    v_and_b32 v13, 0xffff0000, v17
    v_fma_f32 v12, v12, v14, -v15
    v_fma_f32 v13, v13, v14, -v15
    v_cvt_pk_bf16_f32 v17, v12, v13
    v_lshlrev_b32 v12, 16, v18
    v_and_b32 v13, 0xffff0000, v18
    v_fma_f32 v12, v12, v14, -v15
    v_fma_f32 v13, v13, v14, -v15
    v_cvt_pk_bf16_f32 v18, v12, v13
    v_lshlrev_b32 v12, 16, v19
    v_and_b32 v13, 0xffff0000, v19
    v_fma_f32 v12, v12, v14, -v15
    v_fma_f32 v13, v13, v14, -v15
    v_cvt_pk_bf16_f32 v19, v12, v13
    v_lshlrev_b32 v12, 16, v20
    v_and_b32 v13, 0xffff0000, v20
    v_fma_f32 v12, v12, v14, -v15
    v_fma_f32 v13, v13, v14, -v15
    v_cvt_pk_bf16_f32 v20, v12, v13
    v_lshlrev_b32 v12, 16, v21
    v_and_b32 v13, 0xffff0000, v21
    v_fma_f32 v12, v12, v14, -v15
    v_fma_f32 v13, v13, v14, -v15
    v_cvt_pk_bf16_f32 v21, v12, v13
    v_lshlrev_b32 v12, 16, v22
    v_and_b32 v13, 0xffff0000, v22
    v_fma_f32 v12, v12, v14, -v15
    v_fma_f32 v13, v13, v14, -v15
    v_cvt_pk_bf16_f32 v22, v12, v13
    v_lshlrev_b32 v12, 16, v23
    v_and_b32 v13, 0xffff0000, v23
    v_fma_f32 v12, v12, v14, -v15
    v_fma_f32 v13, v13, v14, -v15
    v_cvt_pk_bf16_f32 v23, v12, v13
    v_lshlrev_b32 v12, 16, v24
    v_and_b32 v13, 0xffff0000, v24
    v_fma_f32 v12, v12, v14, -v15
    v_fma_f32 v13, v13, v14, -v15
    v_cvt_pk_bf16_f32 v24, v12, v13
    v_lshlrev_b32 v12, 16, v25
    v_and_b32 v13, 0xffff0000, v25
    v_fma_f32 v12, v12, v14, -v15
    v_fma_f32 v13, v13, v14, -v15
    v_cvt_pk_bf16_f32 v25, v12, v13
    v_lshlrev_b32 v12, 16, v26
    v_and_b32 v13, 0xffff0000, v26
    v_fma_f32 v12, v12, v14, -v15
    v_fma_f32 v13, v13, v14, -v15
    v_cvt_pk_bf16_f32 v26, v12, v13
    v_lshlrev_b32 v12, 16, v27
    v_and_b32 v13, 0xffff0000, v27
    v_fma_f32 v12, v12, v14, -v15
    v_fma_f32 v13, v13, v14, -v15
    v_cvt_pk_bf16_f32 v27, v12, v13
    v_lshlrev_b32 v12, 16, v28
    v_and_b32 v13, 0xffff0000, v28
    v_fma_f32 v12, v12, v14, -v15
    v_fma_f32 v13, v13, v14, -v15
    v_cvt_pk_bf16_f32 v28, v12, v13
    v_lshlrev_b32 v12, 16, v29
    v_and_b32 v13, 0xffff0000, v29
    v_fma_f32 v12, v12, v14, -v15
    v_fma_f32 v13, v13, v14, -v15
    v_cvt_pk_bf16_f32 v29, v12, v13
    v_lshlrev_b32 v12, 16, v30
    v_and_b32 v13, 0xffff0000, v30
    v_fma_f32 v12, v12, v14, -v15
    v_fma_f32 v13, v13, v14, -v15
    v_cvt_pk_bf16_f32 v30, v12, v13
    v_lshlrev_b32 v12, 16, v31
    v_and_b32 v13, 0xffff0000, v31
    v_fma_f32 v12, v12, v14, -v15
    v_fma_f32 v13, v13, v14, -v15
    v_cvt_pk_bf16_f32 v31, v12, v13
    v_lshlrev_b32 v12, 16, v32
    v_and_b32 v13, 0xffff0000, v32
    v_fma_f32 v12, v12, v14, -v15
    v_fma_f32 v13, v13, v14, -v15
    v_cvt_pk_bf16_f32 v32, v12, v13
    v_lshlrev_b32 v12, 16, v33
    v_and_b32 v13, 0xffff0000, v33
    v_fma_f32 v12, v12, v14, -v15
    v_fma_f32 v13, v13, v14, -v15
    v_cvt_pk_bf16_f32 v33, v12, v13
    v_lshlrev_b32 v12, 16, v34
    v_and_b32 v13, 0xffff0000, v34
    v_fma_f32 v12, v12, v14, -v15
    v_fma_f32 v13, v13, v14, -v15
    v_cvt_pk_bf16_f32 v34, v12, v13
    v_lshlrev_b32 v12, 16, v35
    v_and_b32 v13, 0xffff0000, v35
    v_fma_f32 v12, v12, v14, -v15
    v_fma_f32 v13, v13, v14, -v15
    v_cvt_pk_bf16_f32 v35, v12, v13
    v_lshlrev_b32 v12, 16, v36
    v_and_b32 v13, 0xffff0000, v36
    v_fma_f32 v12, v12, v14, -v15
    v_fma_f32 v13, v13, v14, -v15
    v_cvt_pk_bf16_f32 v36, v12, v13
    v_lshlrev_b32 v12, 16, v37
    v_and_b32 v13, 0xffff0000, v37
    v_fma_f32 v12, v12, v14, -v15
    v_fma_f32 v13, v13, v14, -v15
    v_cvt_pk_bf16_f32 v37, v12, v13
    v_lshlrev_b32 v12, 16, v38
    v_and_b32 v13, 0xffff0000, v38
    v_fma_f32 v12, v12, v14, -v15
    v_fma_f32 v13, v13, v14, -v15
    v_cvt_pk_bf16_f32 v38, v12, v13
    v_lshlrev_b32 v12, 16, v39
    v_and_b32 v13, 0xffff0000, v39
    v_fma_f32 v12, v12, v14, -v15
    v_fma_f32 v13, v13, v14, -v15
    v_cvt_pk_bf16_f32 v39, v12, v13
    v_lshlrev_b32 v12, 16, v40
    v_and_b32 v13, 0xffff0000, v40
    v_fma_f32 v12, v12, v14, -v15
    v_fma_f32 v13, v13, v14, -v15
    v_cvt_pk_bf16_f32 v40, v12, v13
    v_lshlrev_b32 v12, 16, v41
    v_and_b32 v13, 0xffff0000, v41
    v_fma_f32 v12, v12, v14, -v15
    v_fma_f32 v13, v13, v14, -v15
    v_cvt_pk_bf16_f32 v41, v12, v13
    v_lshlrev_b32 v12, 16, v42
    v_and_b32 v13, 0xffff0000, v42
    v_fma_f32 v12, v12, v14, -v15
    v_fma_f32 v13, v13, v14, -v15
    v_cvt_pk_bf16_f32 v42, v12, v13
    v_lshlrev_b32 v12, 16, v43
    v_and_b32 v13, 0xffff0000, v43
    v_fma_f32 v12, v12, v14, -v15
    v_fma_f32 v13, v13, v14, -v15
    v_cvt_pk_bf16_f32 v43, v12, v13
    v_lshlrev_b32 v12, 16, v44
    v_and_b32 v13, 0xffff0000, v44
    v_fma_f32 v12, v12, v14, -v15
    v_fma_f32 v13, v13, v14, -v15
    v_cvt_pk_bf16_f32 v44, v12, v13
    v_lshlrev_b32 v12, 16, v45
    v_and_b32 v13, 0xffff0000, v45
    v_fma_f32 v12, v12, v14, -v15
    v_fma_f32 v13, v13, v14, -v15
    v_cvt_pk_bf16_f32 v45, v12, v13
    v_lshlrev_b32 v12, 16, v46
    v_and_b32 v13, 0xffff0000, v46
    v_fma_f32 v12, v12, v14, -v15
    v_fma_f32 v13, v13, v14, -v15
    v_cvt_pk_bf16_f32 v46, v12, v13
    v_lshlrev_b32 v12, 16, v47
    v_and_b32 v13, 0xffff0000, v47
    v_fma_f32 v12, v12, v14, -v15
    v_fma_f32 v13, v13, v14, -v15
    v_cvt_pk_bf16_f32 v47, v12, v13
    v_lshlrev_b32 v12, 16, v48
    v_and_b32 v13, 0xffff0000, v48
    v_fma_f32 v12, v12, v14, -v15
    v_fma_f32 v13, v13, v14, -v15
    v_cvt_pk_bf16_f32 v48, v12, v13
    v_lshlrev_b32 v12, 16, v49
    v_and_b32 v13, 0xffff0000, v49
    v_fma_f32 v12, v12, v14, -v15
    v_fma_f32 v13, v13, v14, -v15
    v_cvt_pk_bf16_f32 v49, v12, v13
    v_lshlrev_b32 v12, 16, v50
    v_and_b32 v13, 0xffff0000, v50
    v_fma_f32 v12, v12, v14, -v15
    v_fma_f32 v13, v13, v14, -v15
    v_cvt_pk_bf16_f32 v50, v12, v13
    v_lshlrev_b32 v12, 16, v51
    v_and_b32 v13, 0xffff0000, v51
    v_fma_f32 v12, v12, v14, -v15
    v_fma_f32 v13, v13, v14, -v15
    v_cvt_pk_bf16_f32 v51, v12, v13
    v_lshlrev_b32 v12, 16, v52
    v_and_b32 v13, 0xffff0000, v52
    v_fma_f32 v12, v12, v14, -v15
    v_fma_f32 v13, v13, v14, -v15
    v_cvt_pk_bf16_f32 v52, v12, v13
    v_lshlrev_b32 v12, 16, v53
    v_and_b32 v13, 0xffff0000, v53
    v_fma_f32 v12, v12, v14, -v15
    v_fma_f32 v13, v13, v14, -v15
    v_cvt_pk_bf16_f32 v53, v12, v13
    v_lshlrev_b32 v12, 16, v54
    v_and_b32 v13, 0xffff0000, v54
    v_fma_f32 v12, v12, v14, -v15
    v_fma_f32 v13, v13, v14, -v15
    v_cvt_pk_bf16_f32 v54, v12, v13
    v_lshlrev_b32 v12, 16, v55
    v_and_b32 v13, 0xffff0000, v55
    v_fma_f32 v12, v12, v14, -v15
    v_fma_f32 v13, v13, v14, -v15
    v_cvt_pk_bf16_f32 v55, v12, v13
    v_lshlrev_b32 v12, 16, v56
    v_and_b32 v13, 0xffff0000, v56
    v_fma_f32 v12, v12, v14, -v15
    v_fma_f32 v13, v13, v14, -v15
    v_cvt_pk_bf16_f32 v56, v12, v13
    v_lshlrev_b32 v12, 16, v57
    v_and_b32 v13, 0xffff0000, v57
    v_fma_f32 v12, v12, v14, -v15
    v_fma_f32 v13, v13, v14, -v15
    v_cvt_pk_bf16_f32 v57, v12, v13
    v_lshlrev_b32 v12, 16, v58
    v_and_b32 v13, 0xffff0000, v58
    v_fma_f32 v12, v12, v14, -v15
    v_fma_f32 v13, v13, v14, -v15
    v_cvt_pk_bf16_f32 v58, v12, v13
    v_lshlrev_b32 v12, 16, v59
    v_and_b32 v13, 0xffff0000, v59
    v_fma_f32 v12, v12, v14, -v15
    v_fma_f32 v13, v13, v14, -v15
    v_cvt_pk_bf16_f32 v59, v12, v13
    v_lshlrev_b32 v12, 16, v60
    v_and_b32 v13, 0xffff0000, v60
    v_fma_f32 v12, v12, v14, -v15
    v_fma_f32 v13, v13, v14, -v15
    v_cvt_pk_bf16_f32 v60, v12, v13
    v_lshlrev_b32 v12, 16, v61
    v_and_b32 v13, 0xffff0000, v61
    v_fma_f32 v12, v12, v14, -v15
    v_fma_f32 v13, v13, v14, -v15
    v_cvt_pk_bf16_f32 v61, v12, v13
    v_lshlrev_b32 v12, 16, v62
    v_and_b32 v13, 0xffff0000, v62
    v_fma_f32 v12, v12, v14, -v15
    v_fma_f32 v13, v13, v14, -v15
    v_cvt_pk_bf16_f32 v62, v12, v13
    v_lshlrev_b32 v12, 16, v63
    v_and_b32 v13, 0xffff0000, v63
    v_fma_f32 v12, v12, v14, -v15
    v_fma_f32 v13, v13, v14, -v15
    v_cvt_pk_bf16_f32 v63, v12, v13
    v_lshlrev_b32 v12, 16, v64
    v_and_b32 v13, 0xffff0000, v64
    v_fma_f32 v12, v12, v14, -v15
    v_fma_f32 v13, v13, v14, -v15
    v_cvt_pk_bf16_f32 v64, v12, v13
    v_lshlrev_b32 v12, 16, v65
    v_and_b32 v13, 0xffff0000, v65
    v_fma_f32 v12, v12, v14, -v15
    v_fma_f32 v13, v13, v14, -v15
    v_cvt_pk_bf16_f32 v65, v12, v13
    v_lshlrev_b32 v12, 16, v66
    v_and_b32 v13, 0xffff0000, v66
    v_fma_f32 v12, v12, v14, -v15
    v_fma_f32 v13, v13, v14, -v15
    v_cvt_pk_bf16_f32 v66, v12, v13
    v_lshlrev_b32 v12, 16, v67
    v_and_b32 v13, 0xffff0000, v67
    v_fma_f32 v12, v12, v14, -v15
    v_fma_f32 v13, v13, v14, -v15
    v_cvt_pk_bf16_f32 v67, v12, v13
    v_lshlrev_b32 v12, 16, v68
    v_and_b32 v13, 0xffff0000, v68
    v_fma_f32 v12, v12, v14, -v15
    v_fma_f32 v13, v13, v14, -v15
    v_cvt_pk_bf16_f32 v68, v12, v13
    v_lshlrev_b32 v12, 16, v69
    v_and_b32 v13, 0xffff0000, v69
    v_fma_f32 v12, v12, v14, -v15
    v_fma_f32 v13, v13, v14, -v15
    v_cvt_pk_bf16_f32 v69, v12, v13
    v_lshlrev_b32 v12, 16, v70
    v_and_b32 v13, 0xffff0000, v70
    v_fma_f32 v12, v12, v14, -v15
    v_fma_f32 v13, v13, v14, -v15
    v_cvt_pk_bf16_f32 v70, v12, v13
    v_lshlrev_b32 v12, 16, v71
    v_and_b32 v13, 0xffff0000, v71
    v_fma_f32 v12, v12, v14, -v15
    v_fma_f32 v13, v13, v14, -v15
    v_cvt_pk_bf16_f32 v71, v12, v13
    v_lshlrev_b32 v12, 16, v72
    v_and_b32 v13, 0xffff0000, v72
    v_fma_f32 v12, v12, v14, -v15
    v_fma_f32 v13, v13, v14, -v15
    v_cvt_pk_bf16_f32 v72, v12, v13
    v_lshlrev_b32 v12, 16, v73
    v_and_b32 v13, 0xffff0000, v73
    v_fma_f32 v12, v12, v14, -v15
    v_fma_f32 v13, v13, v14, -v15
    v_cvt_pk_bf16_f32 v73, v12, v13
    v_lshlrev_b32 v12, 16, v74
    v_and_b32 v13, 0xffff0000, v74
    v_fma_f32 v12, v12, v14, -v15
    v_fma_f32 v13, v13, v14, -v15
    v_cvt_pk_bf16_f32 v74, v12, v13
    v_lshlrev_b32 v12, 16, v75
    v_and_b32 v13, 0xffff0000, v75
    v_fma_f32 v12, v12, v14, -v15
    v_fma_f32 v13, v13, v14, -v15
    v_cvt_pk_bf16_f32 v75, v12, v13
    v_lshlrev_b32 v12, 16, v76
    v_and_b32 v13, 0xffff0000, v76
    v_fma_f32 v12, v12, v14, -v15
    v_fma_f32 v13, v13, v14, -v15
    v_cvt_pk_bf16_f32 v76, v12, v13
    v_lshlrev_b32 v12, 16, v77
    v_and_b32 v13, 0xffff0000, v77
    v_fma_f32 v12, v12, v14, -v15
    v_fma_f32 v13, v13, v14, -v15
    v_cvt_pk_bf16_f32 v77, v12, v13
    v_lshlrev_b32 v12, 16, v78
    v_and_b32 v13, 0xffff0000, v78
    v_fma_f32 v12, v12, v14, -v15
    v_fma_f32 v13, v13, v14, -v15
    v_cvt_pk_bf16_f32 v78, v12, v13
    v_lshlrev_b32 v12, 16, v79
    v_and_b32 v13, 0xffff0000, v79
    v_fma_f32 v12, v12, v14, -v15
    v_fma_f32 v13, v13, v14, -v15
    v_cvt_pk_bf16_f32 v79, v12, v13
    v_lshlrev_b32 v12, 16, v80
    v_and_b32 v13, 0xffff0000, v80
    v_fma_f32 v12, v12, v14, -v15
    v_fma_f32 v13, v13, v14, -v15
    v_cvt_pk_bf16_f32 v80, v12, v13
    v_lshlrev_b32 v12, 16, v81
    v_and_b32 v13, 0xffff0000, v81
    v_fma_f32 v12, v12, v14, -v15
    v_fma_f32 v13, v13, v14, -v15
    v_cvt_pk_bf16_f32 v81, v12, v13
    v_lshlrev_b32 v12, 16, v82
    v_and_b32 v13, 0xffff0000, v82
    v_fma_f32 v12, v12, v14, -v15
    v_fma_f32 v13, v13, v14, -v15
    v_cvt_pk_bf16_f32 v82, v12, v13
    v_lshlrev_b32 v12, 16, v83
    v_and_b32 v13, 0xffff0000, v83
    v_fma_f32 v12, v12, v14, -v15
    v_fma_f32 v13, v13, v14, -v15
    v_cvt_pk_bf16_f32 v83, v12, v13
    v_lshlrev_b32 v12, 16, v84
    v_and_b32 v13, 0xffff0000, v84
    v_fma_f32 v12, v12, v14, -v15
    v_fma_f32 v13, v13, v14, -v15
    v_cvt_pk_bf16_f32 v84, v12, v13
    v_lshlrev_b32 v12, 16, v85
    v_and_b32 v13, 0xffff0000, v85
    v_fma_f32 v12, v12, v14, -v15
    v_fma_f32 v13, v13, v14, -v15
    v_cvt_pk_bf16_f32 v85, v12, v13
    v_lshlrev_b32 v12, 16, v86
    v_and_b32 v13, 0xffff0000, v86
    v_fma_f32 v12, v12, v14, -v15
    v_fma_f32 v13, v13, v14, -v15
    v_cvt_pk_bf16_f32 v86, v12, v13
    v_lshlrev_b32 v12, 16, v87
    v_and_b32 v13, 0xffff0000, v87
    v_fma_f32 v12, v12, v14, -v15
    v_fma_f32 v13, v13, v14, -v15
    v_cvt_pk_bf16_f32 v87, v12, v13
    v_lshlrev_b32 v12, 16, v88
    v_and_b32 v13, 0xffff0000, v88
    v_fma_f32 v12, v12, v14, -v15
    v_fma_f32 v13, v13, v14, -v15
    v_cvt_pk_bf16_f32 v88, v12, v13
    v_lshlrev_b32 v12, 16, v89
    v_and_b32 v13, 0xffff0000, v89
    v_fma_f32 v12, v12, v14, -v15
    v_fma_f32 v13, v13, v14, -v15
    v_cvt_pk_bf16_f32 v89, v12, v13
    v_lshlrev_b32 v12, 16, v90
    v_and_b32 v13, 0xffff0000, v90
    v_fma_f32 v12, v12, v14, -v15
    v_fma_f32 v13, v13, v14, -v15
    v_cvt_pk_bf16_f32 v90, v12, v13
    v_lshlrev_b32 v12, 16, v91
    v_and_b32 v13, 0xffff0000, v91
    v_fma_f32 v12, v12, v14, -v15
    v_fma_f32 v13, v13, v14, -v15
    v_cvt_pk_bf16_f32 v91, v12, v13
    v_lshlrev_b32 v12, 16, v92
    v_and_b32 v13, 0xffff0000, v92
    v_fma_f32 v12, v12, v14, -v15
    v_fma_f32 v13, v13, v14, -v15
    v_cvt_pk_bf16_f32 v92, v12, v13
    v_lshlrev_b32 v12, 16, v93
    v_and_b32 v13, 0xffff0000, v93
    v_fma_f32 v12, v12, v14, -v15
    v_fma_f32 v13, v13, v14, -v15
    v_cvt_pk_bf16_f32 v93, v12, v13
    v_lshlrev_b32 v12, 16, v94
    v_and_b32 v13, 0xffff0000, v94
    v_fma_f32 v12, v12, v14, -v15
    v_fma_f32 v13, v13, v14, -v15
    v_cvt_pk_bf16_f32 v94, v12, v13
    v_lshlrev_b32 v12, 16, v95
    v_and_b32 v13, 0xffff0000, v95
    v_fma_f32 v12, v12, v14, -v15
    v_fma_f32 v13, v13, v14, -v15
    v_cvt_pk_bf16_f32 v95, v12, v13
    ds_write_b128 v9, v[16:19] offset:0
    ds_write_b128 v9, v[20:23] offset:64
    ds_write_b128 v9, v[24:27] offset:128
    ds_write_b128 v9, v[28:31] offset:192
    ds_write_b128 v9, v[32:35] offset:256
    ds_write_b128 v9, v[36:39] offset:320
    ds_write_b128 v9, v[40:43] offset:384
    ds_write_b128 v9, v[44:47] offset:448
    ds_write_b128 v9, v[48:51] offset:512
    ds_write_b128 v9, v[52:55] offset:576
    ds_write_b128 v9, v[56:59] offset:640
    ds_write_b128 v9, v[60:63] offset:704
    ds_write_b128 v9, v[64:67] offset:768
    ds_write_b128 v9, v[68:71] offset:832
    ds_write_b128 v9, v[72:75] offset:896
    ds_write_b128 v9, v[76:79] offset:960
    ds_write_b128 v9, v[80:83] offset:1024
    ds_write_b128 v9, v[84:87] offset:1088
    ds_write_b128 v9, v[88:91] offset:1152
    ds_write_b128 v9, v[92:95] offset:1216
    s_waitcnt lgkmcnt(0)
    s_barrier
    s_lshl_b32 s37, s35, 2
    s_add_u32 s37, s37, s32
    s_cmp_ge_u32 s37, 54
    s_cbranch_scc1 k3a_kernel_end
    s_mul_i32 s36, s37, 81920
    s_add_u32 s36, s36, 3440640
    v_mov_b32 v192, 0
    v_mov_b32 v193, 0
    v_mov_b32 v194, 0
    v_mov_b32 v195, 0
    v_mov_b32 v196, 0
    v_mov_b32 v197, 0
    v_mov_b32 v198, 0
    v_mov_b32 v199, 0
    v_mov_b32 v200, 0
    v_mov_b32 v201, 0
    v_mov_b32 v202, 0
    v_mov_b32 v203, 0
    v_mov_b32 v204, 0
    v_mov_b32 v205, 0
    v_mov_b32 v206, 0
    v_mov_b32 v207, 0
    v_mov_b32 v208, 0
    v_mov_b32 v209, 0
    v_mov_b32 v210, 0
    v_mov_b32 v211, 0
    v_mov_b32 v212, 0
    v_mov_b32 v213, 0
    v_mov_b32 v214, 0
    v_mov_b32 v215, 0
    v_mov_b32 v216, 0
    v_mov_b32 v217, 0
    v_mov_b32 v218, 0
    v_mov_b32 v219, 0
    v_mov_b32 v220, 0
    v_mov_b32 v221, 0
    v_mov_b32 v222, 0
    v_mov_b32 v223, 0
    v_mov_b32 v224, 0
    v_mov_b32 v225, 0
    v_mov_b32 v226, 0
    v_mov_b32 v227, 0
    v_mov_b32 v228, 0
    v_mov_b32 v229, 0
    v_mov_b32 v230, 0
    v_mov_b32 v231, 0
    v_mov_b32 v232, 0
    v_mov_b32 v233, 0
    v_mov_b32 v234, 0
    v_mov_b32 v235, 0
    v_mov_b32 v236, 0
    v_mov_b32 v237, 0
    v_mov_b32 v238, 0
    v_mov_b32 v239, 0
    v_mov_b32 v240, 0
    v_mov_b32 v241, 0
    v_mov_b32 v242, 0
    v_mov_b32 v243, 0
    v_mov_b32 v244, 0
    v_mov_b32 v245, 0
    v_mov_b32 v246, 0
    v_mov_b32 v247, 0
    v_mov_b32 v248, 0
    v_mov_b32 v249, 0
    v_mov_b32 v250, 0
    v_mov_b32 v251, 0
    v_mov_b32 v252, 0
    v_mov_b32 v253, 0
    v_mov_b32 v254, 0
    v_mov_b32 v255, 0
    v_add_u32 v44, 0, v5
    v_add_u32 v45, 40960, v5
    v_mul_u32_u24 v46, 1296, v2
    v_lshl_add_u32 v46, v3, 4, v46
    s_mov_b32 s40, s36
    s_add_u32 s41, s40, 4096
    s_add_u32 s42, s40, 8192
    buffer_load_dwordx4 v[64:67], v44, s[8:11], s40 offen offset:0
    buffer_load_dwordx4 v[68:71], v45, s[8:11], s40 offen offset:0
    buffer_load_dwordx4 v[72:75], v44, s[8:11], s40 offen offset:1024
    buffer_load_dwordx4 v[76:79], v45, s[8:11], s40 offen offset:1024
    buffer_load_dwordx4 v[80:83], v44, s[8:11], s40 offen offset:2048
    buffer_load_dwordx4 v[84:87], v45, s[8:11], s40 offen offset:2048
    buffer_load_dwordx4 v[88:91], v44, s[8:11], s40 offen offset:3072
    buffer_load_dwordx4 v[92:95], v45, s[8:11], s40 offen offset:3072
    buffer_load_dwordx4 v[96:99], v44, s[8:11], s41 offen offset:0
    buffer_load_dwordx4 v[100:103], v45, s[8:11], s41 offen offset:0
    buffer_load_dwordx4 v[104:107], v44, s[8:11], s41 offen offset:1024
    buffer_load_dwordx4 v[108:111], v45, s[8:11], s41 offen offset:1024
    buffer_load_dwordx4 v[112:115], v44, s[8:11], s41 offen offset:2048
    buffer_load_dwordx4 v[116:119], v45, s[8:11], s41 offen offset:2048
    buffer_load_dwordx4 v[120:123], v44, s[8:11], s41 offen offset:3072
    buffer_load_dwordx4 v[124:127], v45, s[8:11], s41 offen offset:3072
    buffer_load_dwordx4 v[128:131], v44, s[8:11], s42 offen offset:0
    buffer_load_dwordx4 v[132:135], v45, s[8:11], s42 offen offset:0
    buffer_load_dwordx4 v[136:139], v44, s[8:11], s42 offen offset:1024
    buffer_load_dwordx4 v[140:143], v45, s[8:11], s42 offen offset:1024
    s_add_u32 s40, s40, 10240
    s_add_u32 s41, s41, 10240
    s_add_u32 s42, s42, 10240
    ds_read_b128 v[48:51], v46 offset:0
    ds_read_b128 v[52:55], v46 offset:41472
    s_mov_b32 s48, 4
gl_k3a_kernel:
    ds_read_b128 v[56:59], v46 offset:32
    ds_read_b128 v[60:63], v46 offset:41504
    s_waitcnt vmcnt(18) lgkmcnt(2)
    v_mfma_f32_32x32x16_bf16 v[192:207], v[64:67], v[48:51], v[192:207]
    v_mfma_f32_32x32x16_bf16 v[208:223], v[68:71], v[48:51], v[208:223]
    v_mfma_f32_32x32x16_bf16 v[224:239], v[64:67], v[52:55], v[224:239]
    v_mfma_f32_32x32x16_bf16 v[240:255], v[68:71], v[52:55], v[240:255]
    buffer_load_dwordx4 v[64:67], v44, s[8:11], s40 offen offset:0
    buffer_load_dwordx4 v[68:71], v45, s[8:11], s40 offen offset:0
    ds_read_b128 v[48:51], v46 offset:64
    ds_read_b128 v[52:55], v46 offset:41536
    s_waitcnt vmcnt(18) lgkmcnt(2)
    v_mfma_f32_32x32x16_bf16 v[192:207], v[72:75], v[56:59], v[192:207]
    v_mfma_f32_32x32x16_bf16 v[208:223], v[76:79], v[56:59], v[208:223]
    v_mfma_f32_32x32x16_bf16 v[224:239], v[72:75], v[60:63], v[224:239]
    v_mfma_f32_32x32x16_bf16 v[240:255], v[76:79], v[60:63], v[240:255]
    buffer_load_dwordx4 v[72:75], v44, s[8:11], s40 offen offset:1024
    buffer_load_dwordx4 v[76:79], v45, s[8:11], s40 offen offset:1024
    ds_read_b128 v[56:59], v46 offset:96
    ds_read_b128 v[60:63], v46 offset:41568
    s_waitcnt vmcnt(18) lgkmcnt(2)
    v_mfma_f32_32x32x16_bf16 v[192:207], v[80:83], v[48:51], v[192:207]
    v_mfma_f32_32x32x16_bf16 v[208:223], v[84:87], v[48:51], v[208:223]
    v_mfma_f32_32x32x16_bf16 v[224:239], v[80:83], v[52:55], v[224:239]
    v_mfma_f32_32x32x16_bf16 v[240:255], v[84:87], v[52:55], v[240:255]
    buffer_load_dwordx4 v[80:83], v44, s[8:11], s40 offen offset:2048
    buffer_load_dwordx4 v[84:87], v45, s[8:11], s40 offen offset:2048
    ds_read_b128 v[48:51], v46 offset:128
    ds_read_b128 v[52:55], v46 offset:41600
    s_waitcnt vmcnt(18) lgkmcnt(2)
    v_mfma_f32_32x32x16_bf16 v[192:207], v[88:91], v[56:59], v[192:207]
    v_mfma_f32_32x32x16_bf16 v[208:223], v[92:95], v[56:59], v[208:223]
    v_mfma_f32_32x32x16_bf16 v[224:239], v[88:91], v[60:63], v[224:239]
    v_mfma_f32_32x32x16_bf16 v[240:255], v[92:95], v[60:63], v[240:255]
    buffer_load_dwordx4 v[88:91], v44, s[8:11], s40 offen offset:3072
    buffer_load_dwordx4 v[92:95], v45, s[8:11], s40 offen offset:3072
    ds_read_b128 v[56:59], v46 offset:160
    ds_read_b128 v[60:63], v46 offset:41632
    s_waitcnt vmcnt(18) lgkmcnt(2)
    v_mfma_f32_32x32x16_bf16 v[192:207], v[96:99], v[48:51], v[192:207]
    v_mfma_f32_32x32x16_bf16 v[208:223], v[100:103], v[48:51], v[208:223]
    v_mfma_f32_32x32x16_bf16 v[224:239], v[96:99], v[52:55], v[224:239]
    v_mfma_f32_32x32x16_bf16 v[240:255], v[100:103], v[52:55], v[240:255]
    buffer_load_dwordx4 v[96:99], v44, s[8:11], s41 offen offset:0
    buffer_load_dwordx4 v[100:103], v45, s[8:11], s41 offen offset:0
    ds_read_b128 v[48:51], v46 offset:192
    ds_read_b128 v[52:55], v46 offset:41664
    s_waitcnt vmcnt(18) lgkmcnt(2)
    v_mfma_f32_32x32x16_bf16 v[192:207], v[104:107], v[56:59], v[192:207]
    v_mfma_f32_32x32x16_bf16 v[208:223], v[108:111], v[56:59], v[208:223]
    v_mfma_f32_32x32x16_bf16 v[224:239], v[104:107], v[60:63], v[224:239]
    v_mfma_f32_32x32x16_bf16 v[240:255], v[108:111], v[60:63], v[240:255]
    buffer_load_dwordx4 v[104:107], v44, s[8:11], s41 offen offset:1024
    buffer_load_dwordx4 v[108:111], v45, s[8:11], s41 offen offset:1024
    ds_read_b128 v[56:59], v46 offset:224
    ds_read_b128 v[60:63], v46 offset:41696
    s_waitcnt vmcnt(18) lgkmcnt(2)
    v_mfma_f32_32x32x16_bf16 v[192:207], v[112:115], v[48:51], v[192:207]
    v_mfma_f32_32x32x16_bf16 v[208:223], v[116:119], v[48:51], v[208:223]
    v_mfma_f32_32x32x16_bf16 v[224:239], v[112:115], v[52:55], v[224:239]
    v_mfma_f32_32x32x16_bf16 v[240:255], v[116:119], v[52:55], v[240:255]
    buffer_load_dwordx4 v[112:115], v44, s[8:11], s41 offen offset:2048
    buffer_load_dwordx4 v[116:119], v45, s[8:11], s41 offen offset:2048
    ds_read_b128 v[48:51], v46 offset:256
    ds_read_b128 v[52:55], v46 offset:41728
    s_waitcnt vmcnt(18) lgkmcnt(2)
    v_mfma_f32_32x32x16_bf16 v[192:207], v[120:123], v[56:59], v[192:207]
    v_mfma_f32_32x32x16_bf16 v[208:223], v[124:127], v[56:59], v[208:223]
    v_mfma_f32_32x32x16_bf16 v[224:239], v[120:123], v[60:63], v[224:239]
    v_mfma_f32_32x32x16_bf16 v[240:255], v[124:127], v[60:63], v[240:255]
    buffer_load_dwordx4 v[120:123], v44, s[8:11], s41 offen offset:3072
    buffer_load_dwordx4 v[124:127], v45, s[8:11], s41 offen offset:3072
    ds_read_b128 v[56:59], v46 offset:288
    ds_read_b128 v[60:63], v46 offset:41760
    s_waitcnt vmcnt(18) lgkmcnt(2)
    v_mfma_f32_32x32x16_bf16 v[192:207], v[128:131], v[48:51], v[192:207]
    v_mfma_f32_32x32x16_bf16 v[208:223], v[132:135], v[48:51], v[208:223]
    v_mfma_f32_32x32x16_bf16 v[224:239], v[128:131], v[52:55], v[224:239]
    v_mfma_f32_32x32x16_bf16 v[240:255], v[132:135], v[52:55], v[240:255]
    buffer_load_dwordx4 v[128:131], v44, s[8:11], s42 offen offset:0
    buffer_load_dwordx4 v[132:135], v45, s[8:11], s42 offen offset:0
    ds_read_b128 v[48:51], v46 offset:320
    ds_read_b128 v[52:55], v46 offset:41792
    s_waitcnt vmcnt(18) lgkmcnt(2)
    v_mfma_f32_32x32x16_bf16 v[192:207], v[136:139], v[56:59], v[192:207]
    v_mfma_f32_32x32x16_bf16 v[208:223], v[140:143], v[56:59], v[208:223]
    v_mfma_f32_32x32x16_bf16 v[224:239], v[136:139], v[60:63], v[224:239]
    v_mfma_f32_32x32x16_bf16 v[240:255], v[140:143], v[60:63], v[240:255]
    buffer_load_dwordx4 v[136:139], v44, s[8:11], s42 offen offset:1024
    buffer_load_dwordx4 v[140:143], v45, s[8:11], s42 offen offset:1024
    s_add_u32 s40, s40, 10240
    s_add_u32 s41, s41, 10240
    s_add_u32 s42, s42, 10240
    v_add_u32 v46, 320, v46
    s_sub_u32 s48, s48, 1
    s_cmp_lg_u32 s48, 0
    s_cbranch_scc1 gl_k3a_kernel
    s_waitcnt vmcnt(0) lgkmcnt(0)
    s_nop 15
    s_mov_b32 s38, 0x4013547a
    s_mov_b32 s39, 0x3dd2d2ae
    s_mov_b32 s40, 28524544
    s_lshl_b32 s37, s37, 6
    v_add_u32 v6, s34, v2
    v_add_u32 v6, 0, v6
    v_mul_u32_u24 v6, 3456, v6
    v_lshl_add_u32 v6, v3, 3, v6
    v_add_u32 v6, s37, v6
    v_mul_f32 v7, v192, v192
    v_mul_f32 v7, s39, v7
    v_add_f32 v7, s38, v7
    v_mul_f32 v7, v7, v192
    v_exp_f32 v7, -v7
    s_nop 0
    v_add_f32 v7, 1.0, v7
    v_rcp_f32 v7, v7
    s_nop 0
    v_mul_f32 v7, v7, v192
    v_mul_f32 v192, v7, v208
    v_mul_f32 v7, v193, v193
    v_mul_f32 v7, s39, v7
    v_add_f32 v7, s38, v7
    v_mul_f32 v7, v7, v193
    v_exp_f32 v7, -v7
    s_nop 0
    v_add_f32 v7, 1.0, v7
    v_rcp_f32 v7, v7
    s_nop 0
    v_mul_f32 v7, v7, v193
    v_mul_f32 v193, v7, v209
    v_mul_f32 v7, v194, v194
    v_mul_f32 v7, s39, v7
    v_add_f32 v7, s38, v7
    v_mul_f32 v7, v7, v194
    v_exp_f32 v7, -v7
    s_nop 0
    v_add_f32 v7, 1.0, v7
    v_rcp_f32 v7, v7
    s_nop 0
    v_mul_f32 v7, v7, v194
    v_mul_f32 v194, v7, v210
    v_mul_f32 v7, v195, v195
    v_mul_f32 v7, s39, v7
    v_add_f32 v7, s38, v7
    v_mul_f32 v7, v7, v195
    v_exp_f32 v7, -v7
    s_nop 0
    v_add_f32 v7, 1.0, v7
    v_rcp_f32 v7, v7
    s_nop 0
    v_mul_f32 v7, v7, v195
    v_mul_f32 v195, v7, v211
    v_mul_f32 v7, v196, v196
    v_mul_f32 v7, s39, v7
    v_add_f32 v7, s38, v7
    v_mul_f32 v7, v7, v196
    v_exp_f32 v7, -v7
    s_nop 0
    v_add_f32 v7, 1.0, v7
    v_rcp_f32 v7, v7
    s_nop 0
    v_mul_f32 v7, v7, v196
    v_mul_f32 v196, v7, v212
    v_mul_f32 v7, v197, v197
    v_mul_f32 v7, s39, v7
    v_add_f32 v7, s38, v7
    v_mul_f32 v7, v7, v197
    v_exp_f32 v7, -v7
    s_nop 0
    v_add_f32 v7, 1.0, v7
    v_rcp_f32 v7, v7
    s_nop 0
    v_mul_f32 v7, v7, v197
    v_mul_f32 v197, v7, v213
    v_mul_f32 v7, v198, v198
    v_mul_f32 v7, s39, v7
    v_add_f32 v7, s38, v7
    v_mul_f32 v7, v7, v198
    v_exp_f32 v7, -v7
    s_nop 0
    v_add_f32 v7, 1.0, v7
    v_rcp_f32 v7, v7
    s_nop 0
    v_mul_f32 v7, v7, v198
    v_mul_f32 v198, v7, v214
    v_mul_f32 v7, v199, v199
    v_mul_f32 v7, s39, v7
    v_add_f32 v7, s38, v7
    v_mul_f32 v7, v7, v199
    v_exp_f32 v7, -v7
    s_nop 0
    v_add_f32 v7, 1.0, v7
    v_rcp_f32 v7, v7
    s_nop 0
    v_mul_f32 v7, v7, v199
    v_mul_f32 v199, v7, v215
    v_mul_f32 v7, v200, v200
    v_mul_f32 v7, s39, v7
    v_add_f32 v7, s38, v7
    v_mul_f32 v7, v7, v200
    v_exp_f32 v7, -v7
    s_nop 0
    v_add_f32 v7, 1.0, v7
    v_rcp_f32 v7, v7
    s_nop 0
    v_mul_f32 v7, v7, v200
    v_mul_f32 v200, v7, v216
    v_mul_f32 v7, v201, v201
    v_mul_f32 v7, s39, v7
    v_add_f32 v7, s38, v7
    v_mul_f32 v7, v7, v201
    v_exp_f32 v7, -v7
    s_nop 0
    v_add_f32 v7, 1.0, v7
    v_rcp_f32 v7, v7
    s_nop 0
    v_mul_f32 v7, v7, v201
    v_mul_f32 v201, v7, v217
    v_mul_f32 v7, v202, v202
    v_mul_f32 v7, s39, v7
    v_add_f32 v7, s38, v7
    v_mul_f32 v7, v7, v202
    v_exp_f32 v7, -v7
    s_nop 0
    v_add_f32 v7, 1.0, v7
    v_rcp_f32 v7, v7
    s_nop 0
    v_mul_f32 v7, v7, v202
    v_mul_f32 v202, v7, v218
    v_mul_f32 v7, v203, v203
    v_mul_f32 v7, s39, v7
    v_add_f32 v7, s38, v7
    v_mul_f32 v7, v7, v203
    v_exp_f32 v7, -v7
    s_nop 0
    v_add_f32 v7, 1.0, v7
    v_rcp_f32 v7, v7
    s_nop 0
    v_mul_f32 v7, v7, v203
    v_mul_f32 v203, v7, v219
    v_mul_f32 v7, v204, v204
    v_mul_f32 v7, s39, v7
    v_add_f32 v7, s38, v7
    v_mul_f32 v7, v7, v204
    v_exp_f32 v7, -v7
    s_nop 0
    v_add_f32 v7, 1.0, v7
    v_rcp_f32 v7, v7
    s_nop 0
    v_mul_f32 v7, v7, v204
    v_mul_f32 v204, v7, v220
    v_mul_f32 v7, v205, v205
    v_mul_f32 v7, s39, v7
    v_add_f32 v7, s38, v7
    v_mul_f32 v7, v7, v205
    v_exp_f32 v7, -v7
    s_nop 0
    v_add_f32 v7, 1.0, v7
    v_rcp_f32 v7, v7
    s_nop 0
    v_mul_f32 v7, v7, v205
    v_mul_f32 v205, v7, v221
    v_mul_f32 v7, v206, v206
    v_mul_f32 v7, s39, v7
    v_add_f32 v7, s38, v7
    v_mul_f32 v7, v7, v206
    v_exp_f32 v7, -v7
    s_nop 0
    v_add_f32 v7, 1.0, v7
    v_rcp_f32 v7, v7
    s_nop 0
    v_mul_f32 v7, v7, v206
    v_mul_f32 v206, v7, v222
    v_mul_f32 v7, v207, v207
    v_mul_f32 v7, s39, v7
    v_add_f32 v7, s38, v7
    v_mul_f32 v7, v7, v207
    v_exp_f32 v7, -v7
    s_nop 0
    v_add_f32 v7, 1.0, v7
    v_rcp_f32 v7, v7
    s_nop 0
    v_mul_f32 v7, v7, v207
    v_mul_f32 v207, v7, v223
    v_cvt_pk_bf16_f32 v8, v192, v193
    v_cvt_pk_bf16_f32 v9, v194, v195
    buffer_store_dwordx2 v[8:9], v6, s[8:11], s40 offen offset:0
    s_nop 1
    v_cvt_pk_bf16_f32 v8, v196, v197
    v_cvt_pk_bf16_f32 v9, v198, v199
    buffer_store_dwordx2 v[8:9], v6, s[8:11], s40 offen offset:16
    s_nop 1
    v_cvt_pk_bf16_f32 v8, v200, v201
    v_cvt_pk_bf16_f32 v9, v202, v203
    buffer_store_dwordx2 v[8:9], v6, s[8:11], s40 offen offset:32
    s_nop 1
    v_cvt_pk_bf16_f32 v8, v204, v205
    v_cvt_pk_bf16_f32 v9, v206, v207
    buffer_store_dwordx2 v[8:9], v6, s[8:11], s40 offen offset:48
    s_nop 1
    v_add_u32 v6, s34, v2
    v_add_u32 v6, 32, v6
    v_mul_u32_u24 v6, 3456, v6
    v_lshl_add_u32 v6, v3, 3, v6
    v_add_u32 v6, s37, v6
    v_mul_f32 v7, v224, v224
    v_mul_f32 v7, s39, v7
    v_add_f32 v7, s38, v7
    v_mul_f32 v7, v7, v224
    v_exp_f32 v7, -v7
    s_nop 0
    v_add_f32 v7, 1.0, v7
    v_rcp_f32 v7, v7
    s_nop 0
    v_mul_f32 v7, v7, v224
    v_mul_f32 v224, v7, v240
    v_mul_f32 v7, v225, v225
    v_mul_f32 v7, s39, v7
    v_add_f32 v7, s38, v7
    v_mul_f32 v7, v7, v225
    v_exp_f32 v7, -v7
    s_nop 0
    v_add_f32 v7, 1.0, v7
    v_rcp_f32 v7, v7
    s_nop 0
    v_mul_f32 v7, v7, v225
    v_mul_f32 v225, v7, v241
    v_mul_f32 v7, v226, v226
    v_mul_f32 v7, s39, v7
    v_add_f32 v7, s38, v7
    v_mul_f32 v7, v7, v226
    v_exp_f32 v7, -v7
    s_nop 0
    v_add_f32 v7, 1.0, v7
    v_rcp_f32 v7, v7
    s_nop 0
    v_mul_f32 v7, v7, v226
    v_mul_f32 v226, v7, v242
    v_mul_f32 v7, v227, v227
    v_mul_f32 v7, s39, v7
    v_add_f32 v7, s38, v7
    v_mul_f32 v7, v7, v227
    v_exp_f32 v7, -v7
    s_nop 0
    v_add_f32 v7, 1.0, v7
    v_rcp_f32 v7, v7
    s_nop 0
    v_mul_f32 v7, v7, v227
    v_mul_f32 v227, v7, v243
    v_mul_f32 v7, v228, v228
    v_mul_f32 v7, s39, v7
    v_add_f32 v7, s38, v7
    v_mul_f32 v7, v7, v228
    v_exp_f32 v7, -v7
    s_nop 0
    v_add_f32 v7, 1.0, v7
    v_rcp_f32 v7, v7
    s_nop 0
    v_mul_f32 v7, v7, v228
    v_mul_f32 v228, v7, v244
    v_mul_f32 v7, v229, v229
    v_mul_f32 v7, s39, v7
    v_add_f32 v7, s38, v7
    v_mul_f32 v7, v7, v229
    v_exp_f32 v7, -v7
    s_nop 0
    v_add_f32 v7, 1.0, v7
    v_rcp_f32 v7, v7
    s_nop 0
    v_mul_f32 v7, v7, v229
    v_mul_f32 v229, v7, v245
    v_mul_f32 v7, v230, v230
    v_mul_f32 v7, s39, v7
    v_add_f32 v7, s38, v7
    v_mul_f32 v7, v7, v230
    v_exp_f32 v7, -v7
    s_nop 0
    v_add_f32 v7, 1.0, v7
    v_rcp_f32 v7, v7
    s_nop 0
    v_mul_f32 v7, v7, v230
    v_mul_f32 v230, v7, v246
    v_mul_f32 v7, v231, v231
    v_mul_f32 v7, s39, v7
    v_add_f32 v7, s38, v7
    v_mul_f32 v7, v7, v231
    v_exp_f32 v7, -v7
    s_nop 0
    v_add_f32 v7, 1.0, v7
    v_rcp_f32 v7, v7
    s_nop 0
    v_mul_f32 v7, v7, v231
    v_mul_f32 v231, v7, v247
    v_mul_f32 v7, v232, v232
    v_mul_f32 v7, s39, v7
    v_add_f32 v7, s38, v7
    v_mul_f32 v7, v7, v232
    v_exp_f32 v7, -v7
    s_nop 0
    v_add_f32 v7, 1.0, v7
    v_rcp_f32 v7, v7
    s_nop 0
    v_mul_f32 v7, v7, v232
    v_mul_f32 v232, v7, v248
    v_mul_f32 v7, v233, v233
    v_mul_f32 v7, s39, v7
    v_add_f32 v7, s38, v7
    v_mul_f32 v7, v7, v233
    v_exp_f32 v7, -v7
    s_nop 0
    v_add_f32 v7, 1.0, v7
    v_rcp_f32 v7, v7
    s_nop 0
    v_mul_f32 v7, v7, v233
    v_mul_f32 v233, v7, v249
    v_mul_f32 v7, v234, v234
    v_mul_f32 v7, s39, v7
    v_add_f32 v7, s38, v7
    v_mul_f32 v7, v7, v234
    v_exp_f32 v7, -v7
    s_nop 0
    v_add_f32 v7, 1.0, v7
    v_rcp_f32 v7, v7
    s_nop 0
    v_mul_f32 v7, v7, v234
    v_mul_f32 v234, v7, v250
    v_mul_f32 v7, v235, v235
    v_mul_f32 v7, s39, v7
    v_add_f32 v7, s38, v7
    v_mul_f32 v7, v7, v235
    v_exp_f32 v7, -v7
    s_nop 0
    v_add_f32 v7, 1.0, v7
    v_rcp_f32 v7, v7
    s_nop 0
    v_mul_f32 v7, v7, v235
    v_mul_f32 v235, v7, v251
    v_mul_f32 v7, v236, v236
    v_mul_f32 v7, s39, v7
    v_add_f32 v7, s38, v7
    v_mul_f32 v7, v7, v236
    v_exp_f32 v7, -v7
    s_nop 0
    v_add_f32 v7, 1.0, v7
    v_rcp_f32 v7, v7
    s_nop 0
    v_mul_f32 v7, v7, v236
    v_mul_f32 v236, v7, v252
    v_mul_f32 v7, v237, v237
    v_mul_f32 v7, s39, v7
    v_add_f32 v7, s38, v7
    v_mul_f32 v7, v7, v237
    v_exp_f32 v7, -v7
    s_nop 0
    v_add_f32 v7, 1.0, v7
    v_rcp_f32 v7, v7
    s_nop 0
    v_mul_f32 v7, v7, v237
    v_mul_f32 v237, v7, v253
    v_mul_f32 v7, v238, v238
    v_mul_f32 v7, s39, v7
    v_add_f32 v7, s38, v7
    v_mul_f32 v7, v7, v238
    v_exp_f32 v7, -v7
    s_nop 0
    v_add_f32 v7, 1.0, v7
    v_rcp_f32 v7, v7
    s_nop 0
    v_mul_f32 v7, v7, v238
    v_mul_f32 v238, v7, v254
    v_mul_f32 v7, v239, v239
    v_mul_f32 v7, s39, v7
    v_add_f32 v7, s38, v7
    v_mul_f32 v7, v7, v239
    v_exp_f32 v7, -v7
    s_nop 0
    v_add_f32 v7, 1.0, v7
    v_rcp_f32 v7, v7
    s_nop 0
    v_mul_f32 v7, v7, v239
    v_mul_f32 v239, v7, v255
    v_cvt_pk_bf16_f32 v8, v224, v225
    v_cvt_pk_bf16_f32 v9, v226, v227
    buffer_store_dwordx2 v[8:9], v6, s[8:11], s40 offen offset:0
    s_nop 1
    v_cvt_pk_bf16_f32 v8, v228, v229
    v_cvt_pk_bf16_f32 v9, v230, v231
    buffer_store_dwordx2 v[8:9], v6, s[8:11], s40 offen offset:16
    s_nop 1
    v_cvt_pk_bf16_f32 v8, v232, v233
    v_cvt_pk_bf16_f32 v9, v234, v235
    buffer_store_dwordx2 v[8:9], v6, s[8:11], s40 offen offset:32
    s_nop 1
    v_cvt_pk_bf16_f32 v8, v236, v237
    v_cvt_pk_bf16_f32 v9, v238, v239
    buffer_store_dwordx2 v[8:9], v6, s[8:11], s40 offen offset:48
    s_nop 1
k3a_kernel_end:
    s_endpgm
.p2align 8
.globl k4a_kernel
.type k4a_kernel,@function
k4a_kernel:
    s_cmp_ge_u32 s2, 160
    s_cbranch_scc1 k4a_kernel_end
    s_load_dwordx2 s[4:5], s[0:1], 80
    s_load_dwordx2 s[6:7], s[0:1], 64
    s_load_dwordx2 s[20:21], s[0:1], 0
    s_waitcnt lgkmcnt(0)
    s_mov_b32 s8, s4
    s_and_b32 s9, s5, 0xffff
    s_mov_b32 s10, 268435456
    s_mov_b32 s11, 0x20000
    s_mov_b32 s12, s6
    s_and_b32 s13, s7, 0xffff
    s_mov_b32 s14, 2621440
    s_mov_b32 s15, 0x20000
    s_mov_b32 s16, s20
    s_and_b32 s17, s21, 0xffff
    s_mov_b32 s18, 2621440
    s_mov_b32 s19, 0x20000
    v_lshrrev_b32 v1, 6, v0
    s_nop 0
    v_readfirstlane_b32 s32, v1
    v_and_b32 v2, 31, v0
    v_bfe_u32 v3, v0, 5, 1
    v_and_b32 v4, 63, v0
    v_lshlrev_b32 v5, 4, v4
    s_mul_hi_u32 s33, s2, 0xcccccccd
    s_lshr_b32 s33, s33, 2
    s_mul_i32 s35, s33, 5
    s_sub_u32 s35, s2, s35
    s_lshl_b32 s34, s33, 6
    s_lshl_b32 s37, s35, 2
    s_add_u32 s37, s37, s32
    s_mul_i32 s36, s37, 110592
    s_add_u32 s36, s36, 7864320
    v_lshrrev_b32 v6, 2, v0
    v_and_b32 v7, 3, v0
    v_add_u32 v8, s34, v6
    v_mul_u32_u24 v8, 3456, v8
    v_lshl_add_u32 v8, v7, 4, v8
    v_mul_u32_u24 v9, 1744, v6
    v_lshl_add_u32 v9, v7, 4, v9
    s_mov_b32 s30, 28524544
    buffer_load_dwordx4 v[144:147], v8, s[8:11], s30 offen offset:0
    buffer_load_dwordx4 v[148:151], v8, s[8:11], s30 offen offset:64
    buffer_load_dwordx4 v[152:155], v8, s[8:11], s30 offen offset:128
    buffer_load_dwordx4 v[156:159], v8, s[8:11], s30 offen offset:192
    buffer_load_dwordx4 v[160:163], v8, s[8:11], s30 offen offset:256
    buffer_load_dwordx4 v[164:167], v8, s[8:11], s30 offen offset:320
    buffer_load_dwordx4 v[168:171], v8, s[8:11], s30 offen offset:384
    buffer_load_dwordx4 v[172:175], v8, s[8:11], s30 offen offset:448
    buffer_load_dwordx4 v[176:179], v8, s[8:11], s30 offen offset:512
    buffer_load_dwordx4 v[180:183], v8, s[8:11], s30 offen offset:576
    buffer_load_dwordx4 v[184:187], v8, s[8:11], s30 offen offset:640
    buffer_load_dwordx4 v[188:191], v8, s[8:11], s30 offen offset:704
    buffer_load_dwordx4 v[192:195], v8, s[8:11], s30 offen offset:768
    buffer_load_dwordx4 v[196:199], v8, s[8:11], s30 offen offset:832
    buffer_load_dwordx4 v[200:203], v8, s[8:11], s30 offen offset:896
    buffer_load_dwordx4 v[204:207], v8, s[8:11], s30 offen offset:960
    buffer_load_dwordx4 v[208:211], v8, s[8:11], s30 offen offset:1024
    buffer_load_dwordx4 v[212:215], v8, s[8:11], s30 offen offset:1088
    buffer_load_dwordx4 v[216:219], v8, s[8:11], s30 offen offset:1152
    buffer_load_dwordx4 v[220:223], v8, s[8:11], s30 offen offset:1216
    buffer_load_dwordx4 v[224:227], v8, s[8:11], s30 offen offset:1280
    buffer_load_dwordx4 v[228:231], v8, s[8:11], s30 offen offset:1344
    buffer_load_dwordx4 v[232:235], v8, s[8:11], s30 offen offset:1408
    buffer_load_dwordx4 v[236:239], v8, s[8:11], s30 offen offset:1472
    buffer_load_dwordx4 v[240:243], v8, s[8:11], s30 offen offset:1536
    buffer_load_dwordx4 v[244:247], v8, s[8:11], s30 offen offset:1600
    buffer_load_dwordx4 v[248:251], v8, s[8:11], s30 offen offset:1664
    s_waitcnt vmcnt(0)
    ds_write_b128 v9, v[144:147] offset:0
    ds_write_b128 v9, v[148:151] offset:64
    ds_write_b128 v9, v[152:155] offset:128
    ds_write_b128 v9, v[156:159] offset:192
    ds_write_b128 v9, v[160:163] offset:256
    ds_write_b128 v9, v[164:167] offset:320
    ds_write_b128 v9, v[168:171] offset:384
    ds_write_b128 v9, v[172:175] offset:448
    ds_write_b128 v9, v[176:179] offset:512
    ds_write_b128 v9, v[180:183] offset:576
    ds_write_b128 v9, v[184:187] offset:640
    ds_write_b128 v9, v[188:191] offset:704
    ds_write_b128 v9, v[192:195] offset:768
    ds_write_b128 v9, v[196:199] offset:832
    ds_write_b128 v9, v[200:203] offset:896
    ds_write_b128 v9, v[204:207] offset:960
    ds_write_b128 v9, v[208:211] offset:1024
    ds_write_b128 v9, v[212:215] offset:1088
    ds_write_b128 v9, v[216:219] offset:1152
    ds_write_b128 v9, v[220:223] offset:1216
    ds_write_b128 v9, v[224:227] offset:1280
    ds_write_b128 v9, v[228:231] offset:1344
    ds_write_b128 v9, v[232:235] offset:1408
    ds_write_b128 v9, v[236:239] offset:1472
    ds_write_b128 v9, v[240:243] offset:1536
    ds_write_b128 v9, v[244:247] offset:1600
    ds_write_b128 v9, v[248:251] offset:1664
    s_waitcnt lgkmcnt(0)
    s_mov_b32 s30, 28526272
    buffer_load_dwordx4 v[144:147], v8, s[8:11], s30 offen offset:0
    buffer_load_dwordx4 v[148:151], v8, s[8:11], s30 offen offset:64
    buffer_load_dwordx4 v[152:155], v8, s[8:11], s30 offen offset:128
    buffer_load_dwordx4 v[156:159], v8, s[8:11], s30 offen offset:192
    buffer_load_dwordx4 v[160:163], v8, s[8:11], s30 offen offset:256
    buffer_load_dwordx4 v[164:167], v8, s[8:11], s30 offen offset:320
    buffer_load_dwordx4 v[168:171], v8, s[8:11], s30 offen offset:384
    buffer_load_dwordx4 v[172:175], v8, s[8:11], s30 offen offset:448
    buffer_load_dwordx4 v[176:179], v8, s[8:11], s30 offen offset:512
    buffer_load_dwordx4 v[180:183], v8, s[8:11], s30 offen offset:576
    buffer_load_dwordx4 v[184:187], v8, s[8:11], s30 offen offset:640
    buffer_load_dwordx4 v[188:191], v8, s[8:11], s30 offen offset:704
    buffer_load_dwordx4 v[192:195], v8, s[8:11], s30 offen offset:768
    buffer_load_dwordx4 v[196:199], v8, s[8:11], s30 offen offset:832
    buffer_load_dwordx4 v[200:203], v8, s[8:11], s30 offen offset:896
    buffer_load_dwordx4 v[204:207], v8, s[8:11], s30 offen offset:960
    buffer_load_dwordx4 v[208:211], v8, s[8:11], s30 offen offset:1024
    buffer_load_dwordx4 v[212:215], v8, s[8:11], s30 offen offset:1088
    buffer_load_dwordx4 v[216:219], v8, s[8:11], s30 offen offset:1152
    buffer_load_dwordx4 v[220:223], v8, s[8:11], s30 offen offset:1216
    buffer_load_dwordx4 v[224:227], v8, s[8:11], s30 offen offset:1280
    buffer_load_dwordx4 v[228:231], v8, s[8:11], s30 offen offset:1344
    buffer_load_dwordx4 v[232:235], v8, s[8:11], s30 offen offset:1408
    buffer_load_dwordx4 v[236:239], v8, s[8:11], s30 offen offset:1472
    buffer_load_dwordx4 v[240:243], v8, s[8:11], s30 offen offset:1536
    buffer_load_dwordx4 v[244:247], v8, s[8:11], s30 offen offset:1600
    buffer_load_dwordx4 v[248:251], v8, s[8:11], s30 offen offset:1664
    s_barrier
    v_mov_b32 v100, 0
    v_mov_b32 v101, 0
    v_mov_b32 v102, 0
    v_mov_b32 v103, 0
    v_mov_b32 v104, 0
    v_mov_b32 v105, 0
    v_mov_b32 v106, 0
    v_mov_b32 v107, 0
    v_mov_b32 v108, 0
    v_mov_b32 v109, 0
    v_mov_b32 v110, 0
    v_mov_b32 v111, 0
    v_mov_b32 v112, 0
    v_mov_b32 v113, 0
    v_mov_b32 v114, 0
    v_mov_b32 v115, 0
    v_mov_b32 v116, 0
    v_mov_b32 v117, 0
    v_mov_b32 v118, 0
    v_mov_b32 v119, 0
    v_mov_b32 v120, 0
    v_mov_b32 v121, 0
    v_mov_b32 v122, 0
    v_mov_b32 v123, 0
    v_mov_b32 v124, 0
    v_mov_b32 v125, 0
    v_mov_b32 v126, 0
    v_mov_b32 v127, 0
    v_mov_b32 v128, 0
    v_mov_b32 v129, 0
    v_mov_b32 v130, 0
    v_mov_b32 v131, 0
    v_add_u32 v44, 0, v5
    v_mul_u32_u24 v46, 1744, v2
    v_lshl_add_u32 v46, v3, 4, v46
    s_mov_b32 s40, s36
    s_add_u32 s41, s40, 4096
    buffer_load_dwordx4 v[64:67], v44, s[8:11], s40 offen offset:0
    buffer_load_dwordx4 v[68:71], v44, s[8:11], s40 offen offset:1024
    buffer_load_dwordx4 v[72:75], v44, s[8:11], s40 offen offset:2048
    buffer_load_dwordx4 v[76:79], v44, s[8:11], s40 offen offset:3072
    buffer_load_dwordx4 v[80:83], v44, s[8:11], s41 offen offset:0
    buffer_load_dwordx4 v[84:87], v44, s[8:11], s41 offen offset:1024
    s_add_u32 s40, s40, 6144
    s_add_u32 s41, s41, 6144
    ds_read_b128 v[48:51], v46 offset:0
    ds_read_b128 v[52:55], v46 offset:55808
    s_mov_b32 s48, 9
gl_k4a_kernel_0:
    ds_read_b128 v[56:59], v46 offset:32
    ds_read_b128 v[60:63], v46 offset:55840
    s_waitcnt vmcnt(5) lgkmcnt(2)
    v_mfma_f32_32x32x16_bf16 v[100:115], v[64:67], v[48:51], v[100:115]
    v_mfma_f32_32x32x16_bf16 v[116:131], v[64:67], v[52:55], v[116:131]
    buffer_load_dwordx4 v[64:67], v44, s[8:11], s40 offen offset:0
    ds_read_b128 v[48:51], v46 offset:64
    ds_read_b128 v[52:55], v46 offset:55872
    s_waitcnt vmcnt(5) lgkmcnt(2)
    v_mfma_f32_32x32x16_bf16 v[100:115], v[68:71], v[56:59], v[100:115]
    v_mfma_f32_32x32x16_bf16 v[116:131], v[68:71], v[60:63], v[116:131]
    buffer_load_dwordx4 v[68:71], v44, s[8:11], s40 offen offset:1024
    ds_read_b128 v[56:59], v46 offset:96
    ds_read_b128 v[60:63], v46 offset:55904
    s_waitcnt vmcnt(5) lgkmcnt(2)
    v_mfma_f32_32x32x16_bf16 v[100:115], v[72:75], v[48:51], v[100:115]
    v_mfma_f32_32x32x16_bf16 v[116:131], v[72:75], v[52:55], v[116:131]
    buffer_load_dwordx4 v[72:75], v44, s[8:11], s40 offen offset:2048
    ds_read_b128 v[48:51], v46 offset:128
    ds_read_b128 v[52:55], v46 offset:55936
    s_waitcnt vmcnt(5) lgkmcnt(2)
    v_mfma_f32_32x32x16_bf16 v[100:115], v[76:79], v[56:59], v[100:115]
    v_mfma_f32_32x32x16_bf16 v[116:131], v[76:79], v[60:63], v[116:131]
    buffer_load_dwordx4 v[76:79], v44, s[8:11], s40 offen offset:3072
    ds_read_b128 v[56:59], v46 offset:160
    ds_read_b128 v[60:63], v46 offset:55968
    s_waitcnt vmcnt(5) lgkmcnt(2)
    v_mfma_f32_32x32x16_bf16 v[100:115], v[80:83], v[48:51], v[100:115]
    v_mfma_f32_32x32x16_bf16 v[116:131], v[80:83], v[52:55], v[116:131]
    buffer_load_dwordx4 v[80:83], v44, s[8:11], s41 offen offset:0
    ds_read_b128 v[48:51], v46 offset:192
    ds_read_b128 v[52:55], v46 offset:56000
    s_waitcnt vmcnt(5) lgkmcnt(2)
    v_mfma_f32_32x32x16_bf16 v[100:115], v[84:87], v[56:59], v[100:115]
    v_mfma_f32_32x32x16_bf16 v[116:131], v[84:87], v[60:63], v[116:131]
    buffer_load_dwordx4 v[84:87], v44, s[8:11], s41 offen offset:1024
    s_add_u32 s40, s40, 6144
    s_add_u32 s41, s41, 6144
    v_add_u32 v46, 192, v46
    s_sub_u32 s48, s48, 1
    s_cmp_lg_u32 s48, 0
    s_cbranch_scc1 gl_k4a_kernel_0
    s_waitcnt vmcnt(0) lgkmcnt(0)
    s_nop 15
    s_add_u32 s36, s36, 55296
    s_barrier
    s_waitcnt vmcnt(0)
    ds_write_b128 v9, v[144:147] offset:0
    ds_write_b128 v9, v[148:151] offset:64
    ds_write_b128 v9, v[152:155] offset:128
    ds_write_b128 v9, v[156:159] offset:192
    ds_write_b128 v9, v[160:163] offset:256
    ds_write_b128 v9, v[164:167] offset:320
    ds_write_b128 v9, v[168:171] offset:384
    ds_write_b128 v9, v[172:175] offset:448
    ds_write_b128 v9, v[176:179] offset:512
    ds_write_b128 v9, v[180:183] offset:576
    ds_write_b128 v9, v[184:187] offset:640
    ds_write_b128 v9, v[188:191] offset:704
    ds_write_b128 v9, v[192:195] offset:768
    ds_write_b128 v9, v[196:199] offset:832
    ds_write_b128 v9, v[200:203] offset:896
    ds_write_b128 v9, v[204:207] offset:960
    ds_write_b128 v9, v[208:211] offset:1024
    ds_write_b128 v9, v[212:215] offset:1088
    ds_write_b128 v9, v[216:219] offset:1152
    ds_write_b128 v9, v[220:223] offset:1216
    ds_write_b128 v9, v[224:227] offset:1280
    ds_write_b128 v9, v[228:231] offset:1344
    ds_write_b128 v9, v[232:235] offset:1408
    ds_write_b128 v9, v[236:239] offset:1472
    ds_write_b128 v9, v[240:243] offset:1536
    ds_write_b128 v9, v[244:247] offset:1600
    ds_write_b128 v9, v[248:251] offset:1664
    s_waitcnt lgkmcnt(0)
    s_barrier
    v_add_u32 v44, 0, v5
    v_mul_u32_u24 v46, 1744, v2
    v_lshl_add_u32 v46, v3, 4, v46
    s_mov_b32 s40, s36
    s_add_u32 s41, s40, 4096
    buffer_load_dwordx4 v[64:67], v44, s[8:11], s40 offen offset:0
    buffer_load_dwordx4 v[68:71], v44, s[8:11], s40 offen offset:1024
    buffer_load_dwordx4 v[72:75], v44, s[8:11], s40 offen offset:2048
    buffer_load_dwordx4 v[76:79], v44, s[8:11], s40 offen offset:3072
    buffer_load_dwordx4 v[80:83], v44, s[8:11], s41 offen offset:0
    buffer_load_dwordx4 v[84:87], v44, s[8:11], s41 offen offset:1024
    s_add_u32 s40, s40, 6144
    s_add_u32 s41, s41, 6144
    ds_read_b128 v[48:51], v46 offset:0
    ds_read_b128 v[52:55], v46 offset:55808
    s_mov_b32 s48, 9
gl_k4a_kernel_1:
    ds_read_b128 v[56:59], v46 offset:32
    ds_read_b128 v[60:63], v46 offset:55840
    s_waitcnt vmcnt(5) lgkmcnt(2)
    v_mfma_f32_32x32x16_bf16 v[100:115], v[64:67], v[48:51], v[100:115]
    v_mfma_f32_32x32x16_bf16 v[116:131], v[64:67], v[52:55], v[116:131]
    buffer_load_dwordx4 v[64:67], v44, s[8:11], s40 offen offset:0
    ds_read_b128 v[48:51], v46 offset:64
    ds_read_b128 v[52:55], v46 offset:55872
    s_waitcnt vmcnt(5) lgkmcnt(2)
    v_mfma_f32_32x32x16_bf16 v[100:115], v[68:71], v[56:59], v[100:115]
    v_mfma_f32_32x32x16_bf16 v[116:131], v[68:71], v[60:63], v[116:131]
    buffer_load_dwordx4 v[68:71], v44, s[8:11], s40 offen offset:1024
    ds_read_b128 v[56:59], v46 offset:96
    ds_read_b128 v[60:63], v46 offset:55904
    s_waitcnt vmcnt(5) lgkmcnt(2)
    v_mfma_f32_32x32x16_bf16 v[100:115], v[72:75], v[48:51], v[100:115]
    v_mfma_f32_32x32x16_bf16 v[116:131], v[72:75], v[52:55], v[116:131]
    buffer_load_dwordx4 v[72:75], v44, s[8:11], s40 offen offset:2048
    ds_read_b128 v[48:51], v46 offset:128
    ds_read_b128 v[52:55], v46 offset:55936
    s_waitcnt vmcnt(5) lgkmcnt(2)
    v_mfma_f32_32x32x16_bf16 v[100:115], v[76:79], v[56:59], v[100:115]
    v_mfma_f32_32x32x16_bf16 v[116:131], v[76:79], v[60:63], v[116:131]
    buffer_load_dwordx4 v[76:79], v44, s[8:11], s40 offen offset:3072
    ds_read_b128 v[56:59], v46 offset:160
    ds_read_b128 v[60:63], v46 offset:55968
    s_waitcnt vmcnt(5) lgkmcnt(2)
    v_mfma_f32_32x32x16_bf16 v[100:115], v[80:83], v[48:51], v[100:115]
    v_mfma_f32_32x32x16_bf16 v[116:131], v[80:83], v[52:55], v[116:131]
    buffer_load_dwordx4 v[80:83], v44, s[8:11], s41 offen offset:0
    ds_read_b128 v[48:51], v46 offset:192
    ds_read_b128 v[52:55], v46 offset:56000
    s_waitcnt vmcnt(5) lgkmcnt(2)
    v_mfma_f32_32x32x16_bf16 v[100:115], v[84:87], v[56:59], v[100:115]
    v_mfma_f32_32x32x16_bf16 v[116:131], v[84:87], v[60:63], v[116:131]
    buffer_load_dwordx4 v[84:87], v44, s[8:11], s41 offen offset:1024
    s_add_u32 s40, s40, 6144
    s_add_u32 s41, s41, 6144
    v_add_u32 v46, 192, v46
    s_sub_u32 s48, s48, 1
    s_cmp_lg_u32 s48, 0
    s_cbranch_scc1 gl_k4a_kernel_1
    s_waitcnt vmcnt(0) lgkmcnt(0)
    s_nop 15
    s_add_u32 s36, s36, 55296
    s_lshl_b32 s37, s37, 5
    s_mov_b32 s30, 20660224
    s_mov_b32 s31, 23281664
    v_add_u32 v6, s34, v2
    v_add_u32 v6, 0, v6
    v_mul_u32_u24 v6, 1280, v6
    v_lshl_add_u32 v6, v3, 3, v6
    v_mov_b32 v7, s37
    v_lshl_add_u32 v6, v7, 1, v6
    buffer_load_dwordx2 v[8:9], v6, s[8:11], s30 offen offset:0
    buffer_load_dwordx2 v[10:11], v6, s[8:11], s30 offen offset:16
    buffer_load_dwordx2 v[12:13], v6, s[8:11], s30 offen offset:32
    buffer_load_dwordx2 v[14:15], v6, s[8:11], s30 offen offset:48
    s_waitcnt vmcnt(0)
    v_lshlrev_b32 v7, 16, v8
    v_add_f32 v100, v100, v7
    v_and_b32 v7, 0xffff0000, v8
    v_add_f32 v101, v101, v7
    v_cvt_pk_bf16_f32 v8, v100, v101
    v_lshlrev_b32 v7, 16, v9
    v_add_f32 v102, v102, v7
    v_and_b32 v7, 0xffff0000, v9
    v_add_f32 v103, v103, v7
    v_cvt_pk_bf16_f32 v9, v102, v103
    buffer_store_dwordx2 v[8:9], v6, s[8:11], s31 offen offset:0
    v_lshlrev_b32 v7, 16, v10
    v_add_f32 v104, v104, v7
    v_and_b32 v7, 0xffff0000, v10
    v_add_f32 v105, v105, v7
    v_cvt_pk_bf16_f32 v10, v104, v105
    v_lshlrev_b32 v7, 16, v11
    v_add_f32 v106, v106, v7
    v_and_b32 v7, 0xffff0000, v11
    v_add_f32 v107, v107, v7
    v_cvt_pk_bf16_f32 v11, v106, v107
    buffer_store_dwordx2 v[10:11], v6, s[8:11], s31 offen offset:16
    v_lshlrev_b32 v7, 16, v12
    v_add_f32 v108, v108, v7
    v_and_b32 v7, 0xffff0000, v12
    v_add_f32 v109, v109, v7
    v_cvt_pk_bf16_f32 v12, v108, v109
    v_lshlrev_b32 v7, 16, v13
    v_add_f32 v110, v110, v7
    v_and_b32 v7, 0xffff0000, v13
    v_add_f32 v111, v111, v7
    v_cvt_pk_bf16_f32 v13, v110, v111
    buffer_store_dwordx2 v[12:13], v6, s[8:11], s31 offen offset:32
    v_lshlrev_b32 v7, 16, v14
    v_add_f32 v112, v112, v7
    v_and_b32 v7, 0xffff0000, v14
    v_add_f32 v113, v113, v7
    v_cvt_pk_bf16_f32 v14, v112, v113
    v_lshlrev_b32 v7, 16, v15
    v_add_f32 v114, v114, v7
    v_and_b32 v7, 0xffff0000, v15
    v_add_f32 v115, v115, v7
    v_cvt_pk_bf16_f32 v15, v114, v115
    buffer_store_dwordx2 v[14:15], v6, s[8:11], s31 offen offset:48
    v_add_u32 v6, s34, v2
    v_add_u32 v6, 32, v6
    v_mul_u32_u24 v6, 1280, v6
    v_lshl_add_u32 v6, v3, 3, v6
    v_mov_b32 v7, s37
    v_lshl_add_u32 v6, v7, 1, v6
    buffer_load_dwordx2 v[8:9], v6, s[8:11], s30 offen offset:0
    buffer_load_dwordx2 v[10:11], v6, s[8:11], s30 offen offset:16
    buffer_load_dwordx2 v[12:13], v6, s[8:11], s30 offen offset:32
    buffer_load_dwordx2 v[14:15], v6, s[8:11], s30 offen offset:48
    s_waitcnt vmcnt(0)
    v_lshlrev_b32 v7, 16, v8
    v_add_f32 v116, v116, v7
    v_and_b32 v7, 0xffff0000, v8
    v_add_f32 v117, v117, v7
    v_cvt_pk_bf16_f32 v8, v116, v117
    v_lshlrev_b32 v7, 16, v9
    v_add_f32 v118, v118, v7
    v_and_b32 v7, 0xffff0000, v9
    v_add_f32 v119, v119, v7
    v_cvt_pk_bf16_f32 v9, v118, v119
    buffer_store_dwordx2 v[8:9], v6, s[8:11], s31 offen offset:0
    v_lshlrev_b32 v7, 16, v10
    v_add_f32 v120, v120, v7
    v_and_b32 v7, 0xffff0000, v10
    v_add_f32 v121, v121, v7
    v_cvt_pk_bf16_f32 v10, v120, v121
    v_lshlrev_b32 v7, 16, v11
    v_add_f32 v122, v122, v7
    v_and_b32 v7, 0xffff0000, v11
    v_add_f32 v123, v123, v7
    v_cvt_pk_bf16_f32 v11, v122, v123
    buffer_store_dwordx2 v[10:11], v6, s[8:11], s31 offen offset:16
    v_lshlrev_b32 v7, 16, v12
    v_add_f32 v124, v124, v7
    v_and_b32 v7, 0xffff0000, v12
    v_add_f32 v125, v125, v7
    v_cvt_pk_bf16_f32 v12, v124, v125
    v_lshlrev_b32 v7, 16, v13
    v_add_f32 v126, v126, v7
    v_and_b32 v7, 0xffff0000, v13
    v_add_f32 v127, v127, v7
    v_cvt_pk_bf16_f32 v13, v126, v127
    buffer_store_dwordx2 v[12:13], v6, s[8:11], s31 offen offset:32
    v_lshlrev_b32 v7, 16, v14
    v_add_f32 v128, v128, v7
    v_and_b32 v7, 0xffff0000, v14
    v_add_f32 v129, v129, v7
    v_cvt_pk_bf16_f32 v14, v128, v129
    v_lshlrev_b32 v7, 16, v15
    v_add_f32 v130, v130, v7
    v_and_b32 v7, 0xffff0000, v15
    v_add_f32 v131, v131, v7
    v_cvt_pk_bf16_f32 v15, v130, v131
    buffer_store_dwordx2 v[14:15], v6, s[8:11], s31 offen offset:48
k4a_kernel_end:
    s_endpgm
.p2align 8
.globl k1b_kernel
.type k1b_kernel,@function
k1b_kernel:
    s_cmp_ge_u32 s2, 256
    s_cbranch_scc1 k1b_kernel_end
    s_load_dwordx2 s[4:5], s[0:1], 80
    s_load_dwordx2 s[6:7], s[0:1], 64
    s_load_dwordx2 s[20:21], s[0:1], 0
    s_waitcnt lgkmcnt(0)
    s_mov_b32 s8, s4
    s_and_b32 s9, s5, 0xffff
    s_mov_b32 s10, 268435456
    s_mov_b32 s11, 0x20000
    s_mov_b32 s12, s6
    s_and_b32 s13, s7, 0xffff
    s_mov_b32 s14, 2621440
    s_mov_b32 s15, 0x20000
    s_mov_b32 s16, s20
    s_and_b32 s17, s21, 0xffff
    s_mov_b32 s18, 2621440
    s_mov_b32 s19, 0x20000
    v_lshrrev_b32 v1, 6, v0
    s_nop 0
    v_readfirstlane_b32 s32, v1
    v_and_b32 v2, 31, v0
    v_bfe_u32 v3, v0, 5, 1
    v_and_b32 v4, 63, v0
    v_lshlrev_b32 v5, 4, v4
    s_lshr_b32 s33, s2, 3
    s_lshl_b32 s34, s33, 6
    s_and_b32 s35, s2, 7
    s_lshl_b32 s35, s35, 2
    s_add_u32 s35, s35, s32
    v_lshrrev_b32 v6, 2, v0
    v_and_b32 v7, 3, v0
    v_add_u32 v8, s34, v6
    v_mul_u32_u24 v8, 1280, v8
    v_lshl_add_u32 v8, v7, 4, v8
    s_mov_b32 s30, 23281664
    buffer_load_dwordx4 v[16:19], v8, s[8:11], s30 offen offset:0
    buffer_load_dwordx4 v[20:23], v8, s[8:11], s30 offen offset:64
    buffer_load_dwordx4 v[24:27], v8, s[8:11], s30 offen offset:128
    buffer_load_dwordx4 v[28:31], v8, s[8:11], s30 offen offset:192
    buffer_load_dwordx4 v[32:35], v8, s[8:11], s30 offen offset:256
    buffer_load_dwordx4 v[36:39], v8, s[8:11], s30 offen offset:320
    buffer_load_dwordx4 v[40:43], v8, s[8:11], s30 offen offset:384
    buffer_load_dwordx4 v[44:47], v8, s[8:11], s30 offen offset:448
    buffer_load_dwordx4 v[48:51], v8, s[8:11], s30 offen offset:512
    buffer_load_dwordx4 v[52:55], v8, s[8:11], s30 offen offset:576
    buffer_load_dwordx4 v[56:59], v8, s[8:11], s30 offen offset:640
    buffer_load_dwordx4 v[60:63], v8, s[8:11], s30 offen offset:704
    buffer_load_dwordx4 v[64:67], v8, s[8:11], s30 offen offset:768
    buffer_load_dwordx4 v[68:71], v8, s[8:11], s30 offen offset:832
    buffer_load_dwordx4 v[72:75], v8, s[8:11], s30 offen offset:896
    buffer_load_dwordx4 v[76:79], v8, s[8:11], s30 offen offset:960
    buffer_load_dwordx4 v[80:83], v8, s[8:11], s30 offen offset:1024
    buffer_load_dwordx4 v[84:87], v8, s[8:11], s30 offen offset:1088
    buffer_load_dwordx4 v[88:91], v8, s[8:11], s30 offen offset:1152
    buffer_load_dwordx4 v[92:95], v8, s[8:11], s30 offen offset:1216
    v_mul_u32_u24 v9, 1296, v6
    v_lshl_add_u32 v9, v7, 4, v9
    v_mov_b32 v10, 0
    v_mov_b32 v11, 0
    v_mov_b32 v12, 0x3f803f80
    s_waitcnt vmcnt(0)
    v_dot2c_f32_bf16 v10, v16, v12
    v_dot2c_f32_bf16 v11, v16, v16
    v_dot2c_f32_bf16 v10, v17, v12
    v_dot2c_f32_bf16 v11, v17, v17
    v_dot2c_f32_bf16 v10, v18, v12
    v_dot2c_f32_bf16 v11, v18, v18
    v_dot2c_f32_bf16 v10, v19, v12
    v_dot2c_f32_bf16 v11, v19, v19
    v_dot2c_f32_bf16 v10, v20, v12
    v_dot2c_f32_bf16 v11, v20, v20
    v_dot2c_f32_bf16 v10, v21, v12
    v_dot2c_f32_bf16 v11, v21, v21
    v_dot2c_f32_bf16 v10, v22, v12
    v_dot2c_f32_bf16 v11, v22, v22
    v_dot2c_f32_bf16 v10, v23, v12
    v_dot2c_f32_bf16 v11, v23, v23
    v_dot2c_f32_bf16 v10, v24, v12
    v_dot2c_f32_bf16 v11, v24, v24
    v_dot2c_f32_bf16 v10, v25, v12
    v_dot2c_f32_bf16 v11, v25, v25
    v_dot2c_f32_bf16 v10, v26, v12
    v_dot2c_f32_bf16 v11, v26, v26
    v_dot2c_f32_bf16 v10, v27, v12
    v_dot2c_f32_bf16 v11, v27, v27
    v_dot2c_f32_bf16 v10, v28, v12
    v_dot2c_f32_bf16 v11, v28, v28
    v_dot2c_f32_bf16 v10, v29, v12
    v_dot2c_f32_bf16 v11, v29, v29
    v_dot2c_f32_bf16 v10, v30, v12
    v_dot2c_f32_bf16 v11, v30, v30
    v_dot2c_f32_bf16 v10, v31, v12
    v_dot2c_f32_bf16 v11, v31, v31
    v_dot2c_f32_bf16 v10, v32, v12
    v_dot2c_f32_bf16 v11, v32, v32
    v_dot2c_f32_bf16 v10, v33, v12
    v_dot2c_f32_bf16 v11, v33, v33
    v_dot2c_f32_bf16 v10, v34, v12
    v_dot2c_f32_bf16 v11, v34, v34
    v_dot2c_f32_bf16 v10, v35, v12
    v_dot2c_f32_bf16 v11, v35, v35
    v_dot2c_f32_bf16 v10, v36, v12
    v_dot2c_f32_bf16 v11, v36, v36
    v_dot2c_f32_bf16 v10, v37, v12
    v_dot2c_f32_bf16 v11, v37, v37
    v_dot2c_f32_bf16 v10, v38, v12
    v_dot2c_f32_bf16 v11, v38, v38
    v_dot2c_f32_bf16 v10, v39, v12
    v_dot2c_f32_bf16 v11, v39, v39
    v_dot2c_f32_bf16 v10, v40, v12
    v_dot2c_f32_bf16 v11, v40, v40
    v_dot2c_f32_bf16 v10, v41, v12
    v_dot2c_f32_bf16 v11, v41, v41
    v_dot2c_f32_bf16 v10, v42, v12
    v_dot2c_f32_bf16 v11, v42, v42
    v_dot2c_f32_bf16 v10, v43, v12
    v_dot2c_f32_bf16 v11, v43, v43
    v_dot2c_f32_bf16 v10, v44, v12
    v_dot2c_f32_bf16 v11, v44, v44
    v_dot2c_f32_bf16 v10, v45, v12
    v_dot2c_f32_bf16 v11, v45, v45
    v_dot2c_f32_bf16 v10, v46, v12
    v_dot2c_f32_bf16 v11, v46, v46
    v_dot2c_f32_bf16 v10, v47, v12
    v_dot2c_f32_bf16 v11, v47, v47
    v_dot2c_f32_bf16 v10, v48, v12
    v_dot2c_f32_bf16 v11, v48, v48
    v_dot2c_f32_bf16 v10, v49, v12
    v_dot2c_f32_bf16 v11, v49, v49
    v_dot2c_f32_bf16 v10, v50, v12
    v_dot2c_f32_bf16 v11, v50, v50
    v_dot2c_f32_bf16 v10, v51, v12
    v_dot2c_f32_bf16 v11, v51, v51
    v_dot2c_f32_bf16 v10, v52, v12
    v_dot2c_f32_bf16 v11, v52, v52
    v_dot2c_f32_bf16 v10, v53, v12
    v_dot2c_f32_bf16 v11, v53, v53
    v_dot2c_f32_bf16 v10, v54, v12
    v_dot2c_f32_bf16 v11, v54, v54
    v_dot2c_f32_bf16 v10, v55, v12
    v_dot2c_f32_bf16 v11, v55, v55
    v_dot2c_f32_bf16 v10, v56, v12
    v_dot2c_f32_bf16 v11, v56, v56
    v_dot2c_f32_bf16 v10, v57, v12
    v_dot2c_f32_bf16 v11, v57, v57
    v_dot2c_f32_bf16 v10, v58, v12
    v_dot2c_f32_bf16 v11, v58, v58
    v_dot2c_f32_bf16 v10, v59, v12
    v_dot2c_f32_bf16 v11, v59, v59
    v_dot2c_f32_bf16 v10, v60, v12
    v_dot2c_f32_bf16 v11, v60, v60
    v_dot2c_f32_bf16 v10, v61, v12
    v_dot2c_f32_bf16 v11, v61, v61
    v_dot2c_f32_bf16 v10, v62, v12
    v_dot2c_f32_bf16 v11, v62, v62
    v_dot2c_f32_bf16 v10, v63, v12
    v_dot2c_f32_bf16 v11, v63, v63
    v_dot2c_f32_bf16 v10, v64, v12
    v_dot2c_f32_bf16 v11, v64, v64
    v_dot2c_f32_bf16 v10, v65, v12
    v_dot2c_f32_bf16 v11, v65, v65
    v_dot2c_f32_bf16 v10, v66, v12
    v_dot2c_f32_bf16 v11, v66, v66
    v_dot2c_f32_bf16 v10, v67, v12
    v_dot2c_f32_bf16 v11, v67, v67
    v_dot2c_f32_bf16 v10, v68, v12
    v_dot2c_f32_bf16 v11, v68, v68
    v_dot2c_f32_bf16 v10, v69, v12
    v_dot2c_f32_bf16 v11, v69, v69
    v_dot2c_f32_bf16 v10, v70, v12
    v_dot2c_f32_bf16 v11, v70, v70
    v_dot2c_f32_bf16 v10, v71, v12
    v_dot2c_f32_bf16 v11, v71, v71
    v_dot2c_f32_bf16 v10, v72, v12
    v_dot2c_f32_bf16 v11, v72, v72
    v_dot2c_f32_bf16 v10, v73, v12
    v_dot2c_f32_bf16 v11, v73, v73
    v_dot2c_f32_bf16 v10, v74, v12
    v_dot2c_f32_bf16 v11, v74, v74
    v_dot2c_f32_bf16 v10, v75, v12
    v_dot2c_f32_bf16 v11, v75, v75
    v_dot2c_f32_bf16 v10, v76, v12
    v_dot2c_f32_bf16 v11, v76, v76
    v_dot2c_f32_bf16 v10, v77, v12
    v_dot2c_f32_bf16 v11, v77, v77
    v_dot2c_f32_bf16 v10, v78, v12
    v_dot2c_f32_bf16 v11, v78, v78
    v_dot2c_f32_bf16 v10, v79, v12
    v_dot2c_f32_bf16 v11, v79, v79
    v_dot2c_f32_bf16 v10, v80, v12
    v_dot2c_f32_bf16 v11, v80, v80
    v_dot2c_f32_bf16 v10, v81, v12
    v_dot2c_f32_bf16 v11, v81, v81
    v_dot2c_f32_bf16 v10, v82, v12
    v_dot2c_f32_bf16 v11, v82, v82
    v_dot2c_f32_bf16 v10, v83, v12
    v_dot2c_f32_bf16 v11, v83, v83
    v_dot2c_f32_bf16 v10, v84, v12
    v_dot2c_f32_bf16 v11, v84, v84
    v_dot2c_f32_bf16 v10, v85, v12
    v_dot2c_f32_bf16 v11, v85, v85
    v_dot2c_f32_bf16 v10, v86, v12
    v_dot2c_f32_bf16 v11, v86, v86
    v_dot2c_f32_bf16 v10, v87, v12
    v_dot2c_f32_bf16 v11, v87, v87
    v_dot2c_f32_bf16 v10, v88, v12
    v_dot2c_f32_bf16 v11, v88, v88
    v_dot2c_f32_bf16 v10, v89, v12
    v_dot2c_f32_bf16 v11, v89, v89
    v_dot2c_f32_bf16 v10, v90, v12
    v_dot2c_f32_bf16 v11, v90, v90
    v_dot2c_f32_bf16 v10, v91, v12
    v_dot2c_f32_bf16 v11, v91, v91
    v_dot2c_f32_bf16 v10, v92, v12
    v_dot2c_f32_bf16 v11, v92, v92
    v_dot2c_f32_bf16 v10, v93, v12
    v_dot2c_f32_bf16 v11, v93, v93
    v_dot2c_f32_bf16 v10, v94, v12
    v_dot2c_f32_bf16 v11, v94, v94
    v_dot2c_f32_bf16 v10, v95, v12
    v_dot2c_f32_bf16 v11, v95, v95
    s_nop 3
    v_add_f32_dpp v10, v10, v10 quad_perm:[1,0,3,2] row_mask:0xf bank_mask:0xf
    v_add_f32_dpp v11, v11, v11 quad_perm:[1,0,3,2] row_mask:0xf bank_mask:0xf
    s_nop 1
    v_add_f32_dpp v10, v10, v10 quad_perm:[2,3,0,1] row_mask:0xf bank_mask:0xf
    v_add_f32_dpp v11, v11, v11 quad_perm:[2,3,0,1] row_mask:0xf bank_mask:0xf
    s_nop 1
    v_mul_f32 v10, 0x3acccccd, v10
    v_mul_f32 v11, 0x3acccccd, v11
    v_fma_f32 v11, -v10, v10, v11
    v_max_f32 v11, 0, v11
    v_mov_b32 v14, 0x3727c5ac
    v_add_f32 v14, v14, v11
    v_rsq_f32 v14, v14
    s_nop 0
    v_mul_f32 v15, v10, v14
    v_lshlrev_b32 v12, 16, v16
    v_and_b32 v13, 0xffff0000, v16
    v_fma_f32 v12, v12, v14, -v15
    v_fma_f32 v13, v13, v14, -v15
    v_cvt_pk_bf16_f32 v16, v12, v13
    v_lshlrev_b32 v12, 16, v17
    v_and_b32 v13, 0xffff0000, v17
    v_fma_f32 v12, v12, v14, -v15
    v_fma_f32 v13, v13, v14, -v15
    v_cvt_pk_bf16_f32 v17, v12, v13
    v_lshlrev_b32 v12, 16, v18
    v_and_b32 v13, 0xffff0000, v18
    v_fma_f32 v12, v12, v14, -v15
    v_fma_f32 v13, v13, v14, -v15
    v_cvt_pk_bf16_f32 v18, v12, v13
    v_lshlrev_b32 v12, 16, v19
    v_and_b32 v13, 0xffff0000, v19
    v_fma_f32 v12, v12, v14, -v15
    v_fma_f32 v13, v13, v14, -v15
    v_cvt_pk_bf16_f32 v19, v12, v13
    v_lshlrev_b32 v12, 16, v20
    v_and_b32 v13, 0xffff0000, v20
    v_fma_f32 v12, v12, v14, -v15
    v_fma_f32 v13, v13, v14, -v15
    v_cvt_pk_bf16_f32 v20, v12, v13
    v_lshlrev_b32 v12, 16, v21
    v_and_b32 v13, 0xffff0000, v21
    v_fma_f32 v12, v12, v14, -v15
    v_fma_f32 v13, v13, v14, -v15
    v_cvt_pk_bf16_f32 v21, v12, v13
    v_lshlrev_b32 v12, 16, v22
    v_and_b32 v13, 0xffff0000, v22
    v_fma_f32 v12, v12, v14, -v15
    v_fma_f32 v13, v13, v14, -v15
    v_cvt_pk_bf16_f32 v22, v12, v13
    v_lshlrev_b32 v12, 16, v23
    v_and_b32 v13, 0xffff0000, v23
    v_fma_f32 v12, v12, v14, -v15
    v_fma_f32 v13, v13, v14, -v15
    v_cvt_pk_bf16_f32 v23, v12, v13
    v_lshlrev_b32 v12, 16, v24
    v_and_b32 v13, 0xffff0000, v24
    v_fma_f32 v12, v12, v14, -v15
    v_fma_f32 v13, v13, v14, -v15
    v_cvt_pk_bf16_f32 v24, v12, v13
    v_lshlrev_b32 v12, 16, v25
    v_and_b32 v13, 0xffff0000, v25
    v_fma_f32 v12, v12, v14, -v15
    v_fma_f32 v13, v13, v14, -v15
    v_cvt_pk_bf16_f32 v25, v12, v13
    v_lshlrev_b32 v12, 16, v26
    v_and_b32 v13, 0xffff0000, v26
    v_fma_f32 v12, v12, v14, -v15
    v_fma_f32 v13, v13, v14, -v15
    v_cvt_pk_bf16_f32 v26, v12, v13
    v_lshlrev_b32 v12, 16, v27
    v_and_b32 v13, 0xffff0000, v27
    v_fma_f32 v12, v12, v14, -v15
    v_fma_f32 v13, v13, v14, -v15
    v_cvt_pk_bf16_f32 v27, v12, v13
    v_lshlrev_b32 v12, 16, v28
    v_and_b32 v13, 0xffff0000, v28
    v_fma_f32 v12, v12, v14, -v15
    v_fma_f32 v13, v13, v14, -v15
    v_cvt_pk_bf16_f32 v28, v12, v13
    v_lshlrev_b32 v12, 16, v29
    v_and_b32 v13, 0xffff0000, v29
    v_fma_f32 v12, v12, v14, -v15
    v_fma_f32 v13, v13, v14, -v15
    v_cvt_pk_bf16_f32 v29, v12, v13
    v_lshlrev_b32 v12, 16, v30
    v_and_b32 v13, 0xffff0000, v30
    v_fma_f32 v12, v12, v14, -v15
    v_fma_f32 v13, v13, v14, -v15
    v_cvt_pk_bf16_f32 v30, v12, v13
    v_lshlrev_b32 v12, 16, v31
    v_and_b32 v13, 0xffff0000, v31
    v_fma_f32 v12, v12, v14, -v15
    v_fma_f32 v13, v13, v14, -v15
    v_cvt_pk_bf16_f32 v31, v12, v13
    v_lshlrev_b32 v12, 16, v32
    v_and_b32 v13, 0xffff0000, v32
    v_fma_f32 v12, v12, v14, -v15
    v_fma_f32 v13, v13, v14, -v15
    v_cvt_pk_bf16_f32 v32, v12, v13
    v_lshlrev_b32 v12, 16, v33
    v_and_b32 v13, 0xffff0000, v33
    v_fma_f32 v12, v12, v14, -v15
    v_fma_f32 v13, v13, v14, -v15
    v_cvt_pk_bf16_f32 v33, v12, v13
    v_lshlrev_b32 v12, 16, v34
    v_and_b32 v13, 0xffff0000, v34
    v_fma_f32 v12, v12, v14, -v15
    v_fma_f32 v13, v13, v14, -v15
    v_cvt_pk_bf16_f32 v34, v12, v13
    v_lshlrev_b32 v12, 16, v35
    v_and_b32 v13, 0xffff0000, v35
    v_fma_f32 v12, v12, v14, -v15
    v_fma_f32 v13, v13, v14, -v15
    v_cvt_pk_bf16_f32 v35, v12, v13
    v_lshlrev_b32 v12, 16, v36
    v_and_b32 v13, 0xffff0000, v36
    v_fma_f32 v12, v12, v14, -v15
    v_fma_f32 v13, v13, v14, -v15
    v_cvt_pk_bf16_f32 v36, v12, v13
    v_lshlrev_b32 v12, 16, v37
    v_and_b32 v13, 0xffff0000, v37
    v_fma_f32 v12, v12, v14, -v15
    v_fma_f32 v13, v13, v14, -v15
    v_cvt_pk_bf16_f32 v37, v12, v13
    v_lshlrev_b32 v12, 16, v38
    v_and_b32 v13, 0xffff0000, v38
    v_fma_f32 v12, v12, v14, -v15
    v_fma_f32 v13, v13, v14, -v15
    v_cvt_pk_bf16_f32 v38, v12, v13
    v_lshlrev_b32 v12, 16, v39
    v_and_b32 v13, 0xffff0000, v39
    v_fma_f32 v12, v12, v14, -v15
    v_fma_f32 v13, v13, v14, -v15
    v_cvt_pk_bf16_f32 v39, v12, v13
    v_lshlrev_b32 v12, 16, v40
    v_and_b32 v13, 0xffff0000, v40
    v_fma_f32 v12, v12, v14, -v15
    v_fma_f32 v13, v13, v14, -v15
    v_cvt_pk_bf16_f32 v40, v12, v13
    v_lshlrev_b32 v12, 16, v41
    v_and_b32 v13, 0xffff0000, v41
    v_fma_f32 v12, v12, v14, -v15
    v_fma_f32 v13, v13, v14, -v15
    v_cvt_pk_bf16_f32 v41, v12, v13
    v_lshlrev_b32 v12, 16, v42
    v_and_b32 v13, 0xffff0000, v42
    v_fma_f32 v12, v12, v14, -v15
    v_fma_f32 v13, v13, v14, -v15
    v_cvt_pk_bf16_f32 v42, v12, v13
    v_lshlrev_b32 v12, 16, v43
    v_and_b32 v13, 0xffff0000, v43
    v_fma_f32 v12, v12, v14, -v15
    v_fma_f32 v13, v13, v14, -v15
    v_cvt_pk_bf16_f32 v43, v12, v13
    v_lshlrev_b32 v12, 16, v44
    v_and_b32 v13, 0xffff0000, v44
    v_fma_f32 v12, v12, v14, -v15
    v_fma_f32 v13, v13, v14, -v15
    v_cvt_pk_bf16_f32 v44, v12, v13
    v_lshlrev_b32 v12, 16, v45
    v_and_b32 v13, 0xffff0000, v45
    v_fma_f32 v12, v12, v14, -v15
    v_fma_f32 v13, v13, v14, -v15
    v_cvt_pk_bf16_f32 v45, v12, v13
    v_lshlrev_b32 v12, 16, v46
    v_and_b32 v13, 0xffff0000, v46
    v_fma_f32 v12, v12, v14, -v15
    v_fma_f32 v13, v13, v14, -v15
    v_cvt_pk_bf16_f32 v46, v12, v13
    v_lshlrev_b32 v12, 16, v47
    v_and_b32 v13, 0xffff0000, v47
    v_fma_f32 v12, v12, v14, -v15
    v_fma_f32 v13, v13, v14, -v15
    v_cvt_pk_bf16_f32 v47, v12, v13
    v_lshlrev_b32 v12, 16, v48
    v_and_b32 v13, 0xffff0000, v48
    v_fma_f32 v12, v12, v14, -v15
    v_fma_f32 v13, v13, v14, -v15
    v_cvt_pk_bf16_f32 v48, v12, v13
    v_lshlrev_b32 v12, 16, v49
    v_and_b32 v13, 0xffff0000, v49
    v_fma_f32 v12, v12, v14, -v15
    v_fma_f32 v13, v13, v14, -v15
    v_cvt_pk_bf16_f32 v49, v12, v13
    v_lshlrev_b32 v12, 16, v50
    v_and_b32 v13, 0xffff0000, v50
    v_fma_f32 v12, v12, v14, -v15
    v_fma_f32 v13, v13, v14, -v15
    v_cvt_pk_bf16_f32 v50, v12, v13
    v_lshlrev_b32 v12, 16, v51
    v_and_b32 v13, 0xffff0000, v51
    v_fma_f32 v12, v12, v14, -v15
    v_fma_f32 v13, v13, v14, -v15
    v_cvt_pk_bf16_f32 v51, v12, v13
    v_lshlrev_b32 v12, 16, v52
    v_and_b32 v13, 0xffff0000, v52
    v_fma_f32 v12, v12, v14, -v15
    v_fma_f32 v13, v13, v14, -v15
    v_cvt_pk_bf16_f32 v52, v12, v13
    v_lshlrev_b32 v12, 16, v53
    v_and_b32 v13, 0xffff0000, v53
    v_fma_f32 v12, v12, v14, -v15
    v_fma_f32 v13, v13, v14, -v15
    v_cvt_pk_bf16_f32 v53, v12, v13
    v_lshlrev_b32 v12, 16, v54
    v_and_b32 v13, 0xffff0000, v54
    v_fma_f32 v12, v12, v14, -v15
    v_fma_f32 v13, v13, v14, -v15
    v_cvt_pk_bf16_f32 v54, v12, v13
    v_lshlrev_b32 v12, 16, v55
    v_and_b32 v13, 0xffff0000, v55
    v_fma_f32 v12, v12, v14, -v15
    v_fma_f32 v13, v13, v14, -v15
    v_cvt_pk_bf16_f32 v55, v12, v13
    v_lshlrev_b32 v12, 16, v56
    v_and_b32 v13, 0xffff0000, v56
    v_fma_f32 v12, v12, v14, -v15
    v_fma_f32 v13, v13, v14, -v15
    v_cvt_pk_bf16_f32 v56, v12, v13
    v_lshlrev_b32 v12, 16, v57
    v_and_b32 v13, 0xffff0000, v57
    v_fma_f32 v12, v12, v14, -v15
    v_fma_f32 v13, v13, v14, -v15
    v_cvt_pk_bf16_f32 v57, v12, v13
    v_lshlrev_b32 v12, 16, v58
    v_and_b32 v13, 0xffff0000, v58
    v_fma_f32 v12, v12, v14, -v15
    v_fma_f32 v13, v13, v14, -v15
    v_cvt_pk_bf16_f32 v58, v12, v13
    v_lshlrev_b32 v12, 16, v59
    v_and_b32 v13, 0xffff0000, v59
    v_fma_f32 v12, v12, v14, -v15
    v_fma_f32 v13, v13, v14, -v15
    v_cvt_pk_bf16_f32 v59, v12, v13
    v_lshlrev_b32 v12, 16, v60
    v_and_b32 v13, 0xffff0000, v60
    v_fma_f32 v12, v12, v14, -v15
    v_fma_f32 v13, v13, v14, -v15
    v_cvt_pk_bf16_f32 v60, v12, v13
    v_lshlrev_b32 v12, 16, v61
    v_and_b32 v13, 0xffff0000, v61
    v_fma_f32 v12, v12, v14, -v15
    v_fma_f32 v13, v13, v14, -v15
    v_cvt_pk_bf16_f32 v61, v12, v13
    v_lshlrev_b32 v12, 16, v62
    v_and_b32 v13, 0xffff0000, v62
    v_fma_f32 v12, v12, v14, -v15
    v_fma_f32 v13, v13, v14, -v15
    v_cvt_pk_bf16_f32 v62, v12, v13
    v_lshlrev_b32 v12, 16, v63
    v_and_b32 v13, 0xffff0000, v63
    v_fma_f32 v12, v12, v14, -v15
    v_fma_f32 v13, v13, v14, -v15
    v_cvt_pk_bf16_f32 v63, v12, v13
    v_lshlrev_b32 v12, 16, v64
    v_and_b32 v13, 0xffff0000, v64
    v_fma_f32 v12, v12, v14, -v15
    v_fma_f32 v13, v13, v14, -v15
    v_cvt_pk_bf16_f32 v64, v12, v13
    v_lshlrev_b32 v12, 16, v65
    v_and_b32 v13, 0xffff0000, v65
    v_fma_f32 v12, v12, v14, -v15
    v_fma_f32 v13, v13, v14, -v15
    v_cvt_pk_bf16_f32 v65, v12, v13
    v_lshlrev_b32 v12, 16, v66
    v_and_b32 v13, 0xffff0000, v66
    v_fma_f32 v12, v12, v14, -v15
    v_fma_f32 v13, v13, v14, -v15
    v_cvt_pk_bf16_f32 v66, v12, v13
    v_lshlrev_b32 v12, 16, v67
    v_and_b32 v13, 0xffff0000, v67
    v_fma_f32 v12, v12, v14, -v15
    v_fma_f32 v13, v13, v14, -v15
    v_cvt_pk_bf16_f32 v67, v12, v13
    v_lshlrev_b32 v12, 16, v68
    v_and_b32 v13, 0xffff0000, v68
    v_fma_f32 v12, v12, v14, -v15
    v_fma_f32 v13, v13, v14, -v15
    v_cvt_pk_bf16_f32 v68, v12, v13
    v_lshlrev_b32 v12, 16, v69
    v_and_b32 v13, 0xffff0000, v69
    v_fma_f32 v12, v12, v14, -v15
    v_fma_f32 v13, v13, v14, -v15
    v_cvt_pk_bf16_f32 v69, v12, v13
    v_lshlrev_b32 v12, 16, v70
    v_and_b32 v13, 0xffff0000, v70
    v_fma_f32 v12, v12, v14, -v15
    v_fma_f32 v13, v13, v14, -v15
    v_cvt_pk_bf16_f32 v70, v12, v13
    v_lshlrev_b32 v12, 16, v71
    v_and_b32 v13, 0xffff0000, v71
    v_fma_f32 v12, v12, v14, -v15
    v_fma_f32 v13, v13, v14, -v15
    v_cvt_pk_bf16_f32 v71, v12, v13
    v_lshlrev_b32 v12, 16, v72
    v_and_b32 v13, 0xffff0000, v72
    v_fma_f32 v12, v12, v14, -v15
    v_fma_f32 v13, v13, v14, -v15
    v_cvt_pk_bf16_f32 v72, v12, v13
    v_lshlrev_b32 v12, 16, v73
    v_and_b32 v13, 0xffff0000, v73
    v_fma_f32 v12, v12, v14, -v15
    v_fma_f32 v13, v13, v14, -v15
    v_cvt_pk_bf16_f32 v73, v12, v13
    v_lshlrev_b32 v12, 16, v74
    v_and_b32 v13, 0xffff0000, v74
    v_fma_f32 v12, v12, v14, -v15
    v_fma_f32 v13, v13, v14, -v15
    v_cvt_pk_bf16_f32 v74, v12, v13
    v_lshlrev_b32 v12, 16, v75
    v_and_b32 v13, 0xffff0000, v75
    v_fma_f32 v12, v12, v14, -v15
    v_fma_f32 v13, v13, v14, -v15
    v_cvt_pk_bf16_f32 v75, v12, v13
    v_lshlrev_b32 v12, 16, v76
    v_and_b32 v13, 0xffff0000, v76
    v_fma_f32 v12, v12, v14, -v15
    v_fma_f32 v13, v13, v14, -v15
    v_cvt_pk_bf16_f32 v76, v12, v13
    v_lshlrev_b32 v12, 16, v77
    v_and_b32 v13, 0xffff0000, v77
    v_fma_f32 v12, v12, v14, -v15
    v_fma_f32 v13, v13, v14, -v15
    v_cvt_pk_bf16_f32 v77, v12, v13
    v_lshlrev_b32 v12, 16, v78
    v_and_b32 v13, 0xffff0000, v78
    v_fma_f32 v12, v12, v14, -v15
    v_fma_f32 v13, v13, v14, -v15
    v_cvt_pk_bf16_f32 v78, v12, v13
    v_lshlrev_b32 v12, 16, v79
    v_and_b32 v13, 0xffff0000, v79
    v_fma_f32 v12, v12, v14, -v15
    v_fma_f32 v13, v13, v14, -v15
    v_cvt_pk_bf16_f32 v79, v12, v13
    v_lshlrev_b32 v12, 16, v80
    v_and_b32 v13, 0xffff0000, v80
    v_fma_f32 v12, v12, v14, -v15
    v_fma_f32 v13, v13, v14, -v15
    v_cvt_pk_bf16_f32 v80, v12, v13
    v_lshlrev_b32 v12, 16, v81
    v_and_b32 v13, 0xffff0000, v81
    v_fma_f32 v12, v12, v14, -v15
    v_fma_f32 v13, v13, v14, -v15
    v_cvt_pk_bf16_f32 v81, v12, v13
    v_lshlrev_b32 v12, 16, v82
    v_and_b32 v13, 0xffff0000, v82
    v_fma_f32 v12, v12, v14, -v15
    v_fma_f32 v13, v13, v14, -v15
    v_cvt_pk_bf16_f32 v82, v12, v13
    v_lshlrev_b32 v12, 16, v83
    v_and_b32 v13, 0xffff0000, v83
    v_fma_f32 v12, v12, v14, -v15
    v_fma_f32 v13, v13, v14, -v15
    v_cvt_pk_bf16_f32 v83, v12, v13
    v_lshlrev_b32 v12, 16, v84
    v_and_b32 v13, 0xffff0000, v84
    v_fma_f32 v12, v12, v14, -v15
    v_fma_f32 v13, v13, v14, -v15
    v_cvt_pk_bf16_f32 v84, v12, v13
    v_lshlrev_b32 v12, 16, v85
    v_and_b32 v13, 0xffff0000, v85
    v_fma_f32 v12, v12, v14, -v15
    v_fma_f32 v13, v13, v14, -v15
    v_cvt_pk_bf16_f32 v85, v12, v13
    v_lshlrev_b32 v12, 16, v86
    v_and_b32 v13, 0xffff0000, v86
    v_fma_f32 v12, v12, v14, -v15
    v_fma_f32 v13, v13, v14, -v15
    v_cvt_pk_bf16_f32 v86, v12, v13
    v_lshlrev_b32 v12, 16, v87
    v_and_b32 v13, 0xffff0000, v87
    v_fma_f32 v12, v12, v14, -v15
    v_fma_f32 v13, v13, v14, -v15
    v_cvt_pk_bf16_f32 v87, v12, v13
    v_lshlrev_b32 v12, 16, v88
    v_and_b32 v13, 0xffff0000, v88
    v_fma_f32 v12, v12, v14, -v15
    v_fma_f32 v13, v13, v14, -v15
    v_cvt_pk_bf16_f32 v88, v12, v13
    v_lshlrev_b32 v12, 16, v89
    v_and_b32 v13, 0xffff0000, v89
    v_fma_f32 v12, v12, v14, -v15
    v_fma_f32 v13, v13, v14, -v15
    v_cvt_pk_bf16_f32 v89, v12, v13
    v_lshlrev_b32 v12, 16, v90
    v_and_b32 v13, 0xffff0000, v90
    v_fma_f32 v12, v12, v14, -v15
    v_fma_f32 v13, v13, v14, -v15
    v_cvt_pk_bf16_f32 v90, v12, v13
    v_lshlrev_b32 v12, 16, v91
    v_and_b32 v13, 0xffff0000, v91
    v_fma_f32 v12, v12, v14, -v15
    v_fma_f32 v13, v13, v14, -v15
    v_cvt_pk_bf16_f32 v91, v12, v13
    v_lshlrev_b32 v12, 16, v92
    v_and_b32 v13, 0xffff0000, v92
    v_fma_f32 v12, v12, v14, -v15
    v_fma_f32 v13, v13, v14, -v15
    v_cvt_pk_bf16_f32 v92, v12, v13
    v_lshlrev_b32 v12, 16, v93
    v_and_b32 v13, 0xffff0000, v93
    v_fma_f32 v12, v12, v14, -v15
    v_fma_f32 v13, v13, v14, -v15
    v_cvt_pk_bf16_f32 v93, v12, v13
    v_lshlrev_b32 v12, 16, v94
    v_and_b32 v13, 0xffff0000, v94
    v_fma_f32 v12, v12, v14, -v15
    v_fma_f32 v13, v13, v14, -v15
    v_cvt_pk_bf16_f32 v94, v12, v13
    v_lshlrev_b32 v12, 16, v95
    v_and_b32 v13, 0xffff0000, v95
    v_fma_f32 v12, v12, v14, -v15
    v_fma_f32 v13, v13, v14, -v15
    v_cvt_pk_bf16_f32 v95, v12, v13
    ds_write_b128 v9, v[16:19] offset:0
    ds_write_b128 v9, v[20:23] offset:64
    ds_write_b128 v9, v[24:27] offset:128
    ds_write_b128 v9, v[28:31] offset:192
    ds_write_b128 v9, v[32:35] offset:256
    ds_write_b128 v9, v[36:39] offset:320
    ds_write_b128 v9, v[40:43] offset:384
    ds_write_b128 v9, v[44:47] offset:448
    ds_write_b128 v9, v[48:51] offset:512
    ds_write_b128 v9, v[52:55] offset:576
    ds_write_b128 v9, v[56:59] offset:640
    ds_write_b128 v9, v[60:63] offset:704
    ds_write_b128 v9, v[64:67] offset:768
    ds_write_b128 v9, v[68:71] offset:832
    ds_write_b128 v9, v[72:75] offset:896
    ds_write_b128 v9, v[76:79] offset:960
    ds_write_b128 v9, v[80:83] offset:1024
    ds_write_b128 v9, v[84:87] offset:1088
    ds_write_b128 v9, v[88:91] offset:1152
    ds_write_b128 v9, v[92:95] offset:1216
    s_waitcnt lgkmcnt(0)
    s_barrier
    s_mul_i32 s36, s35, 81920
    v_mov_b32 v192, 0
    v_mov_b32 v193, 0
    v_mov_b32 v194, 0
    v_mov_b32 v195, 0
    v_mov_b32 v196, 0
    v_mov_b32 v197, 0
    v_mov_b32 v198, 0
    v_mov_b32 v199, 0
    v_mov_b32 v200, 0
    v_mov_b32 v201, 0
    v_mov_b32 v202, 0
    v_mov_b32 v203, 0
    v_mov_b32 v204, 0
    v_mov_b32 v205, 0
    v_mov_b32 v206, 0
    v_mov_b32 v207, 0
    v_mov_b32 v208, 0
    v_mov_b32 v209, 0
    v_mov_b32 v210, 0
    v_mov_b32 v211, 0
    v_mov_b32 v212, 0
    v_mov_b32 v213, 0
    v_mov_b32 v214, 0
    v_mov_b32 v215, 0
    v_mov_b32 v216, 0
    v_mov_b32 v217, 0
    v_mov_b32 v218, 0
    v_mov_b32 v219, 0
    v_mov_b32 v220, 0
    v_mov_b32 v221, 0
    v_mov_b32 v222, 0
    v_mov_b32 v223, 0
    v_mov_b32 v224, 0
    v_mov_b32 v225, 0
    v_mov_b32 v226, 0
    v_mov_b32 v227, 0
    v_mov_b32 v228, 0
    v_mov_b32 v229, 0
    v_mov_b32 v230, 0
    v_mov_b32 v231, 0
    v_mov_b32 v232, 0
    v_mov_b32 v233, 0
    v_mov_b32 v234, 0
    v_mov_b32 v235, 0
    v_mov_b32 v236, 0
    v_mov_b32 v237, 0
    v_mov_b32 v238, 0
    v_mov_b32 v239, 0
    v_mov_b32 v240, 0
    v_mov_b32 v241, 0
    v_mov_b32 v242, 0
    v_mov_b32 v243, 0
    v_mov_b32 v244, 0
    v_mov_b32 v245, 0
    v_mov_b32 v246, 0
    v_mov_b32 v247, 0
    v_mov_b32 v248, 0
    v_mov_b32 v249, 0
    v_mov_b32 v250, 0
    v_mov_b32 v251, 0
    v_mov_b32 v252, 0
    v_mov_b32 v253, 0
    v_mov_b32 v254, 0
    v_mov_b32 v255, 0
    v_add_u32 v44, 0, v5
    v_add_u32 v45, 40960, v5
    v_mul_u32_u24 v46, 1296, v2
    v_lshl_add_u32 v46, v3, 4, v46
    s_mov_b32 s40, s36
    s_add_u32 s41, s40, 4096
    s_add_u32 s42, s40, 8192
    buffer_load_dwordx4 v[64:67], v44, s[8:11], s40 offen offset:0
    buffer_load_dwordx4 v[68:71], v45, s[8:11], s40 offen offset:0
    buffer_load_dwordx4 v[72:75], v44, s[8:11], s40 offen offset:1024
    buffer_load_dwordx4 v[76:79], v45, s[8:11], s40 offen offset:1024
    buffer_load_dwordx4 v[80:83], v44, s[8:11], s40 offen offset:2048
    buffer_load_dwordx4 v[84:87], v45, s[8:11], s40 offen offset:2048
    buffer_load_dwordx4 v[88:91], v44, s[8:11], s40 offen offset:3072
    buffer_load_dwordx4 v[92:95], v45, s[8:11], s40 offen offset:3072
    buffer_load_dwordx4 v[96:99], v44, s[8:11], s41 offen offset:0
    buffer_load_dwordx4 v[100:103], v45, s[8:11], s41 offen offset:0
    buffer_load_dwordx4 v[104:107], v44, s[8:11], s41 offen offset:1024
    buffer_load_dwordx4 v[108:111], v45, s[8:11], s41 offen offset:1024
    buffer_load_dwordx4 v[112:115], v44, s[8:11], s41 offen offset:2048
    buffer_load_dwordx4 v[116:119], v45, s[8:11], s41 offen offset:2048
    buffer_load_dwordx4 v[120:123], v44, s[8:11], s41 offen offset:3072
    buffer_load_dwordx4 v[124:127], v45, s[8:11], s41 offen offset:3072
    buffer_load_dwordx4 v[128:131], v44, s[8:11], s42 offen offset:0
    buffer_load_dwordx4 v[132:135], v45, s[8:11], s42 offen offset:0
    buffer_load_dwordx4 v[136:139], v44, s[8:11], s42 offen offset:1024
    buffer_load_dwordx4 v[140:143], v45, s[8:11], s42 offen offset:1024
    s_add_u32 s40, s40, 10240
    s_add_u32 s41, s41, 10240
    s_add_u32 s42, s42, 10240
    ds_read_b128 v[48:51], v46 offset:0
    ds_read_b128 v[52:55], v46 offset:41472
    s_mov_b32 s48, 4
gl_k1b_kernel:
    ds_read_b128 v[56:59], v46 offset:32
    ds_read_b128 v[60:63], v46 offset:41504
    s_waitcnt vmcnt(18) lgkmcnt(2)
    v_mfma_f32_32x32x16_bf16 v[192:207], v[64:67], v[48:51], v[192:207]
    v_mfma_f32_32x32x16_bf16 v[208:223], v[68:71], v[48:51], v[208:223]
    v_mfma_f32_32x32x16_bf16 v[224:239], v[64:67], v[52:55], v[224:239]
    v_mfma_f32_32x32x16_bf16 v[240:255], v[68:71], v[52:55], v[240:255]
    buffer_load_dwordx4 v[64:67], v44, s[8:11], s40 offen offset:0
    buffer_load_dwordx4 v[68:71], v45, s[8:11], s40 offen offset:0
    ds_read_b128 v[48:51], v46 offset:64
    ds_read_b128 v[52:55], v46 offset:41536
    s_waitcnt vmcnt(18) lgkmcnt(2)
    v_mfma_f32_32x32x16_bf16 v[192:207], v[72:75], v[56:59], v[192:207]
    v_mfma_f32_32x32x16_bf16 v[208:223], v[76:79], v[56:59], v[208:223]
    v_mfma_f32_32x32x16_bf16 v[224:239], v[72:75], v[60:63], v[224:239]
    v_mfma_f32_32x32x16_bf16 v[240:255], v[76:79], v[60:63], v[240:255]
    buffer_load_dwordx4 v[72:75], v44, s[8:11], s40 offen offset:1024
    buffer_load_dwordx4 v[76:79], v45, s[8:11], s40 offen offset:1024
    ds_read_b128 v[56:59], v46 offset:96
    ds_read_b128 v[60:63], v46 offset:41568
    s_waitcnt vmcnt(18) lgkmcnt(2)
    v_mfma_f32_32x32x16_bf16 v[192:207], v[80:83], v[48:51], v[192:207]
    v_mfma_f32_32x32x16_bf16 v[208:223], v[84:87], v[48:51], v[208:223]
    v_mfma_f32_32x32x16_bf16 v[224:239], v[80:83], v[52:55], v[224:239]
    v_mfma_f32_32x32x16_bf16 v[240:255], v[84:87], v[52:55], v[240:255]
    buffer_load_dwordx4 v[80:83], v44, s[8:11], s40 offen offset:2048
    buffer_load_dwordx4 v[84:87], v45, s[8:11], s40 offen offset:2048
    ds_read_b128 v[48:51], v46 offset:128
    ds_read_b128 v[52:55], v46 offset:41600
    s_waitcnt vmcnt(18) lgkmcnt(2)
    v_mfma_f32_32x32x16_bf16 v[192:207], v[88:91], v[56:59], v[192:207]
    v_mfma_f32_32x32x16_bf16 v[208:223], v[92:95], v[56:59], v[208:223]
    v_mfma_f32_32x32x16_bf16 v[224:239], v[88:91], v[60:63], v[224:239]
    v_mfma_f32_32x32x16_bf16 v[240:255], v[92:95], v[60:63], v[240:255]
    buffer_load_dwordx4 v[88:91], v44, s[8:11], s40 offen offset:3072
    buffer_load_dwordx4 v[92:95], v45, s[8:11], s40 offen offset:3072
    ds_read_b128 v[56:59], v46 offset:160
    ds_read_b128 v[60:63], v46 offset:41632
    s_waitcnt vmcnt(18) lgkmcnt(2)
    v_mfma_f32_32x32x16_bf16 v[192:207], v[96:99], v[48:51], v[192:207]
    v_mfma_f32_32x32x16_bf16 v[208:223], v[100:103], v[48:51], v[208:223]
    v_mfma_f32_32x32x16_bf16 v[224:239], v[96:99], v[52:55], v[224:239]
    v_mfma_f32_32x32x16_bf16 v[240:255], v[100:103], v[52:55], v[240:255]
    buffer_load_dwordx4 v[96:99], v44, s[8:11], s41 offen offset:0
    buffer_load_dwordx4 v[100:103], v45, s[8:11], s41 offen offset:0
    ds_read_b128 v[48:51], v46 offset:192
    ds_read_b128 v[52:55], v46 offset:41664
    s_waitcnt vmcnt(18) lgkmcnt(2)
    v_mfma_f32_32x32x16_bf16 v[192:207], v[104:107], v[56:59], v[192:207]
    v_mfma_f32_32x32x16_bf16 v[208:223], v[108:111], v[56:59], v[208:223]
    v_mfma_f32_32x32x16_bf16 v[224:239], v[104:107], v[60:63], v[224:239]
    v_mfma_f32_32x32x16_bf16 v[240:255], v[108:111], v[60:63], v[240:255]
    buffer_load_dwordx4 v[104:107], v44, s[8:11], s41 offen offset:1024
    buffer_load_dwordx4 v[108:111], v45, s[8:11], s41 offen offset:1024
    ds_read_b128 v[56:59], v46 offset:224
    ds_read_b128 v[60:63], v46 offset:41696
    s_waitcnt vmcnt(18) lgkmcnt(2)
    v_mfma_f32_32x32x16_bf16 v[192:207], v[112:115], v[48:51], v[192:207]
    v_mfma_f32_32x32x16_bf16 v[208:223], v[116:119], v[48:51], v[208:223]
    v_mfma_f32_32x32x16_bf16 v[224:239], v[112:115], v[52:55], v[224:239]
    v_mfma_f32_32x32x16_bf16 v[240:255], v[116:119], v[52:55], v[240:255]
    buffer_load_dwordx4 v[112:115], v44, s[8:11], s41 offen offset:2048
    buffer_load_dwordx4 v[116:119], v45, s[8:11], s41 offen offset:2048
    ds_read_b128 v[48:51], v46 offset:256
    ds_read_b128 v[52:55], v46 offset:41728
    s_waitcnt vmcnt(18) lgkmcnt(2)
    v_mfma_f32_32x32x16_bf16 v[192:207], v[120:123], v[56:59], v[192:207]
    v_mfma_f32_32x32x16_bf16 v[208:223], v[124:127], v[56:59], v[208:223]
    v_mfma_f32_32x32x16_bf16 v[224:239], v[120:123], v[60:63], v[224:239]
    v_mfma_f32_32x32x16_bf16 v[240:255], v[124:127], v[60:63], v[240:255]
    buffer_load_dwordx4 v[120:123], v44, s[8:11], s41 offen offset:3072
    buffer_load_dwordx4 v[124:127], v45, s[8:11], s41 offen offset:3072
    ds_read_b128 v[56:59], v46 offset:288
    ds_read_b128 v[60:63], v46 offset:41760
    s_waitcnt vmcnt(18) lgkmcnt(2)
    v_mfma_f32_32x32x16_bf16 v[192:207], v[128:131], v[48:51], v[192:207]
    v_mfma_f32_32x32x16_bf16 v[208:223], v[132:135], v[48:51], v[208:223]
    v_mfma_f32_32x32x16_bf16 v[224:239], v[128:131], v[52:55], v[224:239]
    v_mfma_f32_32x32x16_bf16 v[240:255], v[132:135], v[52:55], v[240:255]
    buffer_load_dwordx4 v[128:131], v44, s[8:11], s42 offen offset:0
    buffer_load_dwordx4 v[132:135], v45, s[8:11], s42 offen offset:0
    ds_read_b128 v[48:51], v46 offset:320
    ds_read_b128 v[52:55], v46 offset:41792
    s_waitcnt vmcnt(18) lgkmcnt(2)
    v_mfma_f32_32x32x16_bf16 v[192:207], v[136:139], v[56:59], v[192:207]
    v_mfma_f32_32x32x16_bf16 v[208:223], v[140:143], v[56:59], v[208:223]
    v_mfma_f32_32x32x16_bf16 v[224:239], v[136:139], v[60:63], v[224:239]
    v_mfma_f32_32x32x16_bf16 v[240:255], v[140:143], v[60:63], v[240:255]
    buffer_load_dwordx4 v[136:139], v44, s[8:11], s42 offen offset:1024
    buffer_load_dwordx4 v[140:143], v45, s[8:11], s42 offen offset:1024
    s_add_u32 s40, s40, 10240
    s_add_u32 s41, s41, 10240
    s_add_u32 s42, s42, 10240
    v_add_u32 v46, 320, v46
    s_sub_u32 s48, s48, 1
    s_cmp_lg_u32 s48, 0
    s_cbranch_scc1 gl_k1b_kernel
    s_waitcnt vmcnt(0) lgkmcnt(0)
    s_nop 15
    s_mov_b32 s37, 1069066811
    s_mul_i32 s38, s32, 13824
    s_add_u32 s38, s38, 82944
    s_mov_b32 s44, -1
    s_mov_b32 s45, 0
    s_mov_b32 s46, 0
    s_mov_b32 s47, -1
    s_mul_i32 s39, s35, 80
    s_add_u32 s39, s39, 10076160
    v_max3_f32 v6, v192, v193, v194
    v_min3_f32 v7, v192, v193, v194
    v_max3_f32 v6, v6, v195, v196
    v_min3_f32 v7, v7, v195, v196
    v_max3_f32 v6, v6, v197, v198
    v_min3_f32 v7, v7, v197, v198
    v_max3_f32 v6, v6, v199, v200
    v_min3_f32 v7, v7, v199, v200
    v_max3_f32 v6, v6, v201, v202
    v_min3_f32 v7, v7, v201, v202
    v_max3_f32 v6, v6, v203, v204
    v_min3_f32 v7, v7, v203, v204
    v_max3_f32 v6, v6, v205, v206
    v_min3_f32 v7, v7, v205, v206
    v_max3_f32 v6, v6, v207, v208
    v_min3_f32 v7, v7, v207, v208
    v_max3_f32 v6, v6, v209, v210
    v_min3_f32 v7, v7, v209, v210
    v_max_f32 v6, v6, v211
    v_min_f32 v7, v7, v211
    v_mul_f32 v6, s37, v6
    v_mul_f32 v7, s37, v7
    v_fma_f32 v64, v192, s37, -v6
    v_fma_f32 v84, -v192, s37, v7
    v_fma_f32 v65, v193, s37, -v6
    v_fma_f32 v85, -v193, s37, v7
    v_fma_f32 v66, v194, s37, -v6
    v_fma_f32 v86, -v194, s37, v7
    v_fma_f32 v67, v195, s37, -v6
    v_fma_f32 v87, -v195, s37, v7
    v_fma_f32 v68, v196, s37, -v6
    v_fma_f32 v88, -v196, s37, v7
    v_fma_f32 v69, v197, s37, -v6
    v_fma_f32 v89, -v197, s37, v7
    v_fma_f32 v70, v198, s37, -v6
    v_fma_f32 v90, -v198, s37, v7
    v_fma_f32 v71, v199, s37, -v6
    v_fma_f32 v91, -v199, s37, v7
    v_fma_f32 v72, v200, s37, -v6
    v_fma_f32 v92, -v200, s37, v7
    v_fma_f32 v73, v201, s37, -v6
    v_fma_f32 v93, -v201, s37, v7
    v_fma_f32 v74, v202, s37, -v6
    v_fma_f32 v94, -v202, s37, v7
    v_fma_f32 v75, v203, s37, -v6
    v_fma_f32 v95, -v203, s37, v7
    v_fma_f32 v76, v204, s37, -v6
    v_fma_f32 v96, -v204, s37, v7
    v_fma_f32 v77, v205, s37, -v6
    v_fma_f32 v97, -v205, s37, v7
    v_fma_f32 v78, v206, s37, -v6
    v_fma_f32 v98, -v206, s37, v7
    v_fma_f32 v79, v207, s37, -v6
    v_fma_f32 v99, -v207, s37, v7
    v_fma_f32 v80, v208, s37, -v6
    v_fma_f32 v100, -v208, s37, v7
    v_fma_f32 v81, v209, s37, -v6
    v_fma_f32 v101, -v209, s37, v7
    v_fma_f32 v82, v210, s37, -v6
    v_fma_f32 v102, -v210, s37, v7
    v_fma_f32 v83, v211, s37, -v6
    v_fma_f32 v103, -v211, s37, v7
    v_exp_f32 v64, v64
    v_exp_f32 v65, v65
    v_exp_f32 v66, v66
    v_exp_f32 v67, v67
    v_exp_f32 v68, v68
    v_exp_f32 v69, v69
    v_exp_f32 v70, v70
    v_exp_f32 v71, v71
    v_exp_f32 v72, v72
    v_exp_f32 v73, v73
    v_exp_f32 v74, v74
    v_exp_f32 v75, v75
    v_exp_f32 v76, v76
    v_exp_f32 v77, v77
    v_exp_f32 v78, v78
    v_exp_f32 v79, v79
    v_exp_f32 v80, v80
    v_exp_f32 v81, v81
    v_exp_f32 v82, v82
    v_exp_f32 v83, v83
    v_exp_f32 v84, v84
    v_exp_f32 v85, v85
    v_exp_f32 v86, v86
    v_exp_f32 v87, v87
    v_exp_f32 v88, v88
    v_exp_f32 v89, v89
    v_exp_f32 v90, v90
    v_exp_f32 v91, v91
    v_exp_f32 v92, v92
    v_exp_f32 v93, v93
    v_exp_f32 v94, v94
    v_exp_f32 v95, v95
    v_exp_f32 v96, v96
    v_exp_f32 v97, v97
    v_exp_f32 v98, v98
    v_exp_f32 v99, v99
    v_exp_f32 v100, v100
    v_exp_f32 v101, v101
    v_exp_f32 v102, v102
    v_exp_f32 v103, v103
    s_nop 0
    v_add_f32 v6, v64, v65
    v_add_f32 v6, v6, v66
    v_add_f32 v6, v6, v67
    v_add_f32 v6, v6, v68
    v_add_f32 v6, v6, v69
    v_add_f32 v6, v6, v70
    v_add_f32 v6, v6, v71
    v_add_f32 v6, v6, v72
    v_add_f32 v6, v6, v73
    v_add_f32 v6, v6, v74
    v_add_f32 v6, v6, v75
    v_add_f32 v6, v6, v76
    v_add_f32 v6, v6, v77
    v_add_f32 v6, v6, v78
    v_add_f32 v6, v6, v79
    v_add_f32 v6, v6, v80
    v_add_f32 v6, v6, v81
    v_add_f32 v6, v6, v82
    v_add_f32 v6, v6, v83
    v_rcp_f32 v6, v6
    s_nop 0
    v_mul_f32 v64, v64, v6
    v_mul_f32 v65, v65, v6
    v_mul_f32 v66, v66, v6
    v_mul_f32 v67, v67, v6
    v_mul_f32 v68, v68, v6
    v_mul_f32 v69, v69, v6
    v_mul_f32 v70, v70, v6
    v_mul_f32 v71, v71, v6
    v_mul_f32 v72, v72, v6
    v_mul_f32 v73, v73, v6
    v_mul_f32 v74, v74, v6
    v_mul_f32 v75, v75, v6
    v_mul_f32 v76, v76, v6
    v_mul_f32 v77, v77, v6
    v_mul_f32 v78, v78, v6
    v_mul_f32 v79, v79, v6
    v_mul_f32 v80, v80, v6
    v_mul_f32 v81, v81, v6
    v_mul_f32 v82, v82, v6
    v_mul_f32 v83, v83, v6
    v_add_f32 v6, v84, v85
    v_add_f32 v6, v6, v86
    v_add_f32 v6, v6, v87
    v_add_f32 v6, v6, v88
    v_add_f32 v6, v6, v89
    v_add_f32 v6, v6, v90
    v_add_f32 v6, v6, v91
    v_add_f32 v6, v6, v92
    v_add_f32 v6, v6, v93
    v_add_f32 v6, v6, v94
    v_add_f32 v6, v6, v95
    v_add_f32 v6, v6, v96
    v_add_f32 v6, v6, v97
    v_add_f32 v6, v6, v98
    v_add_f32 v6, v6, v99
    v_add_f32 v6, v6, v100
    v_add_f32 v6, v6, v101
    v_add_f32 v6, v6, v102
    v_add_f32 v6, v6, v103
    v_rcp_f32 v6, v6
    s_nop 0
    v_mul_f32 v84, v84, v6
    v_mul_f32 v85, v85, v6
    v_mul_f32 v86, v86, v6
    v_mul_f32 v87, v87, v6
    v_mul_f32 v88, v88, v6
    v_mul_f32 v89, v89, v6
    v_mul_f32 v90, v90, v6
    v_mul_f32 v91, v91, v6
    v_mul_f32 v92, v92, v6
    v_mul_f32 v93, v93, v6
    v_mul_f32 v94, v94, v6
    v_mul_f32 v95, v95, v6
    v_mul_f32 v96, v96, v6
    v_mul_f32 v97, v97, v6
    v_mul_f32 v98, v98, v6
    v_mul_f32 v99, v99, v6
    v_mul_f32 v100, v100, v6
    v_mul_f32 v101, v101, v6
    v_mul_f32 v102, v102, v6
    v_mul_f32 v103, v103, v6
    v_cvt_pk_bf16_f32 v104, v64, v65
    v_cvt_pk_bf16_f32 v105, v66, v67
    v_cvt_pk_bf16_f32 v106, v68, v69
    v_cvt_pk_bf16_f32 v107, v70, v71
    v_cvt_pk_bf16_f32 v108, v72, v73
    v_cvt_pk_bf16_f32 v109, v74, v75
    v_cvt_pk_bf16_f32 v110, v76, v77
    v_cvt_pk_bf16_f32 v111, v78, v79
    v_cvt_pk_bf16_f32 v112, v80, v81
    v_cvt_pk_bf16_f32 v113, v82, v83
    v_cvt_pk_bf16_f32 v114, v84, v85
    v_cvt_pk_bf16_f32 v115, v86, v87
    v_cvt_pk_bf16_f32 v116, v88, v89
    v_cvt_pk_bf16_f32 v117, v90, v91
    v_cvt_pk_bf16_f32 v118, v92, v93
    v_cvt_pk_bf16_f32 v119, v94, v95
    v_cvt_pk_bf16_f32 v120, v96, v97
    v_cvt_pk_bf16_f32 v121, v98, v99
    v_cvt_pk_bf16_f32 v122, v100, v101
    v_cvt_pk_bf16_f32 v123, v102, v103
    v_cvt_pk_bf16_f32 v24, v212, v213
    v_cvt_pk_bf16_f32 v25, v214, v215
    v_cvt_pk_bf16_f32 v26, v216, v217
    v_cvt_pk_bf16_f32 v27, v218, v219
    v_cvt_pk_bf16_f32 v28, v220, v221
    v_add_u32 v8, s34, v2
    v_add_u32 v8, 0, v8
    v_mul_u32_u24 v8, 2560, v8
    v_add_u32 v9, 0, v2
    v_lshl_add_u32 v9, v9, 1, s38
    v_mul_u32_u24 v10, 1440, v3
    v_add_u32 v10, v10, v9
    v_mov_b32 v11, 0x3f80
    s_mov_b64 exec, s[44:45]
    buffer_store_dwordx4 v[104:107], v8, s[8:11], s39 offen offset:0
    buffer_store_dwordx4 v[108:111], v8, s[8:11], s39 offen offset:16
    buffer_store_dwordx4 v[112:115], v8, s[8:11], s39 offen offset:32
    buffer_store_dwordx4 v[116:119], v8, s[8:11], s39 offen offset:48
    buffer_store_dwordx4 v[120:123], v8, s[8:11], s39 offen offset:64
    ds_write_b16 v9, v11 offset:12096
    s_mov_b64 exec, s[46:47]
    ds_write_b16 v9, v104 offset:0
    ds_write_b16_d16_hi v9, v104 offset:144
    ds_write_b16 v9, v105 offset:288
    ds_write_b16_d16_hi v9, v105 offset:432
    ds_write_b16 v9, v106 offset:576
    ds_write_b16_d16_hi v9, v106 offset:720
    ds_write_b16 v9, v107 offset:864
    ds_write_b16_d16_hi v9, v107 offset:1008
    ds_write_b16 v9, v108 offset:1152
    ds_write_b16_d16_hi v9, v108 offset:1296
    ds_write_b16 v9, v109 offset:1440
    ds_write_b16_d16_hi v9, v109 offset:1584
    ds_write_b16 v9, v110 offset:1728
    ds_write_b16_d16_hi v9, v110 offset:1872
    ds_write_b16 v9, v111 offset:2016
    ds_write_b16_d16_hi v9, v111 offset:2160
    ds_write_b16 v9, v112 offset:2304
    ds_write_b16_d16_hi v9, v112 offset:2448
    ds_write_b16 v9, v113 offset:2592
    ds_write_b16_d16_hi v9, v113 offset:2736
    ds_write_b16 v9, v114 offset:2880
    ds_write_b16_d16_hi v9, v114 offset:3024
    ds_write_b16 v9, v115 offset:3168
    ds_write_b16_d16_hi v9, v115 offset:3312
    ds_write_b16 v9, v116 offset:3456
    ds_write_b16_d16_hi v9, v116 offset:3600
    ds_write_b16 v9, v117 offset:3744
    ds_write_b16_d16_hi v9, v117 offset:3888
    ds_write_b16 v9, v118 offset:4032
    ds_write_b16_d16_hi v9, v118 offset:4176
    ds_write_b16 v9, v119 offset:4320
    ds_write_b16_d16_hi v9, v119 offset:4464
    ds_write_b16 v9, v120 offset:4608
    ds_write_b16_d16_hi v9, v120 offset:4752
    ds_write_b16 v9, v121 offset:4896
    ds_write_b16_d16_hi v9, v121 offset:5040
    ds_write_b16 v9, v122 offset:5184
    ds_write_b16_d16_hi v9, v122 offset:5328
    ds_write_b16 v9, v123 offset:5472
    ds_write_b16_d16_hi v9, v123 offset:5616
    s_mov_b64 exec, -1
    ds_write_b16 v10, v24 offset:9216
    ds_write_b16_d16_hi v10, v24 offset:9360
    ds_write_b16 v10, v25 offset:9504
    ds_write_b16_d16_hi v10, v25 offset:9648
    ds_write_b16 v10, v26 offset:9792
    ds_write_b16_d16_hi v10, v26 offset:9936
    ds_write_b16 v10, v27 offset:10080
    ds_write_b16_d16_hi v10, v27 offset:10224
    ds_write_b16 v10, v28 offset:10368
    ds_write_b16_d16_hi v10, v28 offset:10512
    v_max3_f32 v6, v224, v225, v226
    v_min3_f32 v7, v224, v225, v226
    v_max3_f32 v6, v6, v227, v228
    v_min3_f32 v7, v7, v227, v228
    v_max3_f32 v6, v6, v229, v230
    v_min3_f32 v7, v7, v229, v230
    v_max3_f32 v6, v6, v231, v232
    v_min3_f32 v7, v7, v231, v232
    v_max3_f32 v6, v6, v233, v234
    v_min3_f32 v7, v7, v233, v234
    v_max3_f32 v6, v6, v235, v236
    v_min3_f32 v7, v7, v235, v236
    v_max3_f32 v6, v6, v237, v238
    v_min3_f32 v7, v7, v237, v238
    v_max3_f32 v6, v6, v239, v240
    v_min3_f32 v7, v7, v239, v240
    v_max3_f32 v6, v6, v241, v242
    v_min3_f32 v7, v7, v241, v242
    v_max_f32 v6, v6, v243
    v_min_f32 v7, v7, v243
    v_mul_f32 v6, s37, v6
    v_mul_f32 v7, s37, v7
    v_fma_f32 v64, v224, s37, -v6
    v_fma_f32 v84, -v224, s37, v7
    v_fma_f32 v65, v225, s37, -v6
    v_fma_f32 v85, -v225, s37, v7
    v_fma_f32 v66, v226, s37, -v6
    v_fma_f32 v86, -v226, s37, v7
    v_fma_f32 v67, v227, s37, -v6
    v_fma_f32 v87, -v227, s37, v7
    v_fma_f32 v68, v228, s37, -v6
    v_fma_f32 v88, -v228, s37, v7
    v_fma_f32 v69, v229, s37, -v6
    v_fma_f32 v89, -v229, s37, v7
    v_fma_f32 v70, v230, s37, -v6
    v_fma_f32 v90, -v230, s37, v7
    v_fma_f32 v71, v231, s37, -v6
    v_fma_f32 v91, -v231, s37, v7
    v_fma_f32 v72, v232, s37, -v6
    v_fma_f32 v92, -v232, s37, v7
    v_fma_f32 v73, v233, s37, -v6
    v_fma_f32 v93, -v233, s37, v7
    v_fma_f32 v74, v234, s37, -v6
    v_fma_f32 v94, -v234, s37, v7
    v_fma_f32 v75, v235, s37, -v6
    v_fma_f32 v95, -v235, s37, v7
    v_fma_f32 v76, v236, s37, -v6
    v_fma_f32 v96, -v236, s37, v7
    v_fma_f32 v77, v237, s37, -v6
    v_fma_f32 v97, -v237, s37, v7
    v_fma_f32 v78, v238, s37, -v6
    v_fma_f32 v98, -v238, s37, v7
    v_fma_f32 v79, v239, s37, -v6
    v_fma_f32 v99, -v239, s37, v7
    v_fma_f32 v80, v240, s37, -v6
    v_fma_f32 v100, -v240, s37, v7
    v_fma_f32 v81, v241, s37, -v6
    v_fma_f32 v101, -v241, s37, v7
    v_fma_f32 v82, v242, s37, -v6
    v_fma_f32 v102, -v242, s37, v7
    v_fma_f32 v83, v243, s37, -v6
    v_fma_f32 v103, -v243, s37, v7
    v_exp_f32 v64, v64
    v_exp_f32 v65, v65
    v_exp_f32 v66, v66
    v_exp_f32 v67, v67
    v_exp_f32 v68, v68
    v_exp_f32 v69, v69
    v_exp_f32 v70, v70
    v_exp_f32 v71, v71
    v_exp_f32 v72, v72
    v_exp_f32 v73, v73
    v_exp_f32 v74, v74
    v_exp_f32 v75, v75
    v_exp_f32 v76, v76
    v_exp_f32 v77, v77
    v_exp_f32 v78, v78
    v_exp_f32 v79, v79
    v_exp_f32 v80, v80
    v_exp_f32 v81, v81
    v_exp_f32 v82, v82
    v_exp_f32 v83, v83
    v_exp_f32 v84, v84
    v_exp_f32 v85, v85
    v_exp_f32 v86, v86
    v_exp_f32 v87, v87
    v_exp_f32 v88, v88
    v_exp_f32 v89, v89
    v_exp_f32 v90, v90
    v_exp_f32 v91, v91
    v_exp_f32 v92, v92
    v_exp_f32 v93, v93
    v_exp_f32 v94, v94
    v_exp_f32 v95, v95
    v_exp_f32 v96, v96
    v_exp_f32 v97, v97
    v_exp_f32 v98, v98
    v_exp_f32 v99, v99
    v_exp_f32 v100, v100
    v_exp_f32 v101, v101
    v_exp_f32 v102, v102
    v_exp_f32 v103, v103
    s_nop 0
    v_add_f32 v6, v64, v65
    v_add_f32 v6, v6, v66
    v_add_f32 v6, v6, v67
    v_add_f32 v6, v6, v68
    v_add_f32 v6, v6, v69
    v_add_f32 v6, v6, v70
    v_add_f32 v6, v6, v71
    v_add_f32 v6, v6, v72
    v_add_f32 v6, v6, v73
    v_add_f32 v6, v6, v74
    v_add_f32 v6, v6, v75
    v_add_f32 v6, v6, v76
    v_add_f32 v6, v6, v77
    v_add_f32 v6, v6, v78
    v_add_f32 v6, v6, v79
    v_add_f32 v6, v6, v80
    v_add_f32 v6, v6, v81
    v_add_f32 v6, v6, v82
    v_add_f32 v6, v6, v83
    v_rcp_f32 v6, v6
    s_nop 0
    v_mul_f32 v64, v64, v6
    v_mul_f32 v65, v65, v6
    v_mul_f32 v66, v66, v6
    v_mul_f32 v67, v67, v6
    v_mul_f32 v68, v68, v6
    v_mul_f32 v69, v69, v6
    v_mul_f32 v70, v70, v6
    v_mul_f32 v71, v71, v6
    v_mul_f32 v72, v72, v6
    v_mul_f32 v73, v73, v6
    v_mul_f32 v74, v74, v6
    v_mul_f32 v75, v75, v6
    v_mul_f32 v76, v76, v6
    v_mul_f32 v77, v77, v6
    v_mul_f32 v78, v78, v6
    v_mul_f32 v79, v79, v6
    v_mul_f32 v80, v80, v6
    v_mul_f32 v81, v81, v6
    v_mul_f32 v82, v82, v6
    v_mul_f32 v83, v83, v6
    v_add_f32 v6, v84, v85
    v_add_f32 v6, v6, v86
    v_add_f32 v6, v6, v87
    v_add_f32 v6, v6, v88
    v_add_f32 v6, v6, v89
    v_add_f32 v6, v6, v90
    v_add_f32 v6, v6, v91
    v_add_f32 v6, v6, v92
    v_add_f32 v6, v6, v93
    v_add_f32 v6, v6, v94
    v_add_f32 v6, v6, v95
    v_add_f32 v6, v6, v96
    v_add_f32 v6, v6, v97
    v_add_f32 v6, v6, v98
    v_add_f32 v6, v6, v99
    v_add_f32 v6, v6, v100
    v_add_f32 v6, v6, v101
    v_add_f32 v6, v6, v102
    v_add_f32 v6, v6, v103
    v_rcp_f32 v6, v6
    s_nop 0
    v_mul_f32 v84, v84, v6
    v_mul_f32 v85, v85, v6
    v_mul_f32 v86, v86, v6
    v_mul_f32 v87, v87, v6
    v_mul_f32 v88, v88, v6
    v_mul_f32 v89, v89, v6
    v_mul_f32 v90, v90, v6
    v_mul_f32 v91, v91, v6
    v_mul_f32 v92, v92, v6
    v_mul_f32 v93, v93, v6
    v_mul_f32 v94, v94, v6
    v_mul_f32 v95, v95, v6
    v_mul_f32 v96, v96, v6
    v_mul_f32 v97, v97, v6
    v_mul_f32 v98, v98, v6
    v_mul_f32 v99, v99, v6
    v_mul_f32 v100, v100, v6
    v_mul_f32 v101, v101, v6
    v_mul_f32 v102, v102, v6
    v_mul_f32 v103, v103, v6
    v_cvt_pk_bf16_f32 v104, v64, v65
    v_cvt_pk_bf16_f32 v105, v66, v67
    v_cvt_pk_bf16_f32 v106, v68, v69
    v_cvt_pk_bf16_f32 v107, v70, v71
    v_cvt_pk_bf16_f32 v108, v72, v73
    v_cvt_pk_bf16_f32 v109, v74, v75
    v_cvt_pk_bf16_f32 v110, v76, v77
    v_cvt_pk_bf16_f32 v111, v78, v79
    v_cvt_pk_bf16_f32 v112, v80, v81
    v_cvt_pk_bf16_f32 v113, v82, v83
    v_cvt_pk_bf16_f32 v114, v84, v85
    v_cvt_pk_bf16_f32 v115, v86, v87
    v_cvt_pk_bf16_f32 v116, v88, v89
    v_cvt_pk_bf16_f32 v117, v90, v91
    v_cvt_pk_bf16_f32 v118, v92, v93
    v_cvt_pk_bf16_f32 v119, v94, v95
    v_cvt_pk_bf16_f32 v120, v96, v97
    v_cvt_pk_bf16_f32 v121, v98, v99
    v_cvt_pk_bf16_f32 v122, v100, v101
    v_cvt_pk_bf16_f32 v123, v102, v103
    v_cvt_pk_bf16_f32 v24, v244, v245
    v_cvt_pk_bf16_f32 v25, v246, v247
    v_cvt_pk_bf16_f32 v26, v248, v249
    v_cvt_pk_bf16_f32 v27, v250, v251
    v_cvt_pk_bf16_f32 v28, v252, v253
    v_add_u32 v8, s34, v2
    v_add_u32 v8, 32, v8
    v_mul_u32_u24 v8, 2560, v8
    v_add_u32 v9, 32, v2
    v_lshl_add_u32 v9, v9, 1, s38
    v_mul_u32_u24 v10, 1440, v3
    v_add_u32 v10, v10, v9
    v_mov_b32 v11, 0x3f80
    s_mov_b64 exec, s[44:45]
    buffer_store_dwordx4 v[104:107], v8, s[8:11], s39 offen offset:0
    buffer_store_dwordx4 v[108:111], v8, s[8:11], s39 offen offset:16
    buffer_store_dwordx4 v[112:115], v8, s[8:11], s39 offen offset:32
    buffer_store_dwordx4 v[116:119], v8, s[8:11], s39 offen offset:48
    buffer_store_dwordx4 v[120:123], v8, s[8:11], s39 offen offset:64
    ds_write_b16 v9, v11 offset:12096
    s_mov_b64 exec, s[46:47]
    ds_write_b16 v9, v104 offset:0
    ds_write_b16_d16_hi v9, v104 offset:144
    ds_write_b16 v9, v105 offset:288
    ds_write_b16_d16_hi v9, v105 offset:432
    ds_write_b16 v9, v106 offset:576
    ds_write_b16_d16_hi v9, v106 offset:720
    ds_write_b16 v9, v107 offset:864
    ds_write_b16_d16_hi v9, v107 offset:1008
    ds_write_b16 v9, v108 offset:1152
    ds_write_b16_d16_hi v9, v108 offset:1296
    ds_write_b16 v9, v109 offset:1440
    ds_write_b16_d16_hi v9, v109 offset:1584
    ds_write_b16 v9, v110 offset:1728
    ds_write_b16_d16_hi v9, v110 offset:1872
    ds_write_b16 v9, v111 offset:2016
    ds_write_b16_d16_hi v9, v111 offset:2160
    ds_write_b16 v9, v112 offset:2304
    ds_write_b16_d16_hi v9, v112 offset:2448
    ds_write_b16 v9, v113 offset:2592
    ds_write_b16_d16_hi v9, v113 offset:2736
    ds_write_b16 v9, v114 offset:2880
    ds_write_b16_d16_hi v9, v114 offset:3024
    ds_write_b16 v9, v115 offset:3168
    ds_write_b16_d16_hi v9, v115 offset:3312
    ds_write_b16 v9, v116 offset:3456
    ds_write_b16_d16_hi v9, v116 offset:3600
    ds_write_b16 v9, v117 offset:3744
    ds_write_b16_d16_hi v9, v117 offset:3888
    ds_write_b16 v9, v118 offset:4032
    ds_write_b16_d16_hi v9, v118 offset:4176
    ds_write_b16 v9, v119 offset:4320
    ds_write_b16_d16_hi v9, v119 offset:4464
    ds_write_b16 v9, v120 offset:4608
    ds_write_b16_d16_hi v9, v120 offset:4752
    ds_write_b16 v9, v121 offset:4896
    ds_write_b16_d16_hi v9, v121 offset:5040
    ds_write_b16 v9, v122 offset:5184
    ds_write_b16_d16_hi v9, v122 offset:5328
    ds_write_b16 v9, v123 offset:5472
    ds_write_b16_d16_hi v9, v123 offset:5616
    s_mov_b64 exec, -1
    ds_write_b16 v10, v24 offset:9216
    ds_write_b16_d16_hi v10, v24 offset:9360
    ds_write_b16 v10, v25 offset:9504
    ds_write_b16_d16_hi v10, v25 offset:9648
    ds_write_b16 v10, v26 offset:9792
    ds_write_b16_d16_hi v10, v26 offset:9936
    ds_write_b16 v10, v27 offset:10080
    ds_write_b16_d16_hi v10, v27 offset:10224
    ds_write_b16 v10, v28 offset:10368
    ds_write_b16_d16_hi v10, v28 offset:10512
    v_mul_u32_u24 v9, 144, v2
    v_lshl_add_u32 v9, v3, 4, v9
    v_add_u32 v9, s38, v9
    s_waitcnt lgkmcnt(0)
    ds_read_b128 v[64:67], v9 offset:9216
    ds_read_b128 v[80:83], v9 offset:0
    ds_read_b128 v[96:99], v9 offset:4608
    ds_read_b128 v[68:71], v9 offset:9248
    ds_read_b128 v[84:87], v9 offset:32
    ds_read_b128 v[100:103], v9 offset:4640
    ds_read_b128 v[72:75], v9 offset:9280
    ds_read_b128 v[88:91], v9 offset:64
    ds_read_b128 v[104:107], v9 offset:4672
    ds_read_b128 v[76:79], v9 offset:9312
    ds_read_b128 v[92:95], v9 offset:96
    ds_read_b128 v[108:111], v9 offset:4704
    v_mov_b32 v128, 0
    v_mov_b32 v129, 0
    v_mov_b32 v130, 0
    v_mov_b32 v131, 0
    v_mov_b32 v132, 0
    v_mov_b32 v133, 0
    v_mov_b32 v134, 0
    v_mov_b32 v135, 0
    v_mov_b32 v136, 0
    v_mov_b32 v137, 0
    v_mov_b32 v138, 0
    v_mov_b32 v139, 0
    v_mov_b32 v140, 0
    v_mov_b32 v141, 0
    v_mov_b32 v142, 0
    v_mov_b32 v143, 0
    v_mov_b32 v144, 0
    v_mov_b32 v145, 0
    v_mov_b32 v146, 0
    v_mov_b32 v147, 0
    v_mov_b32 v148, 0
    v_mov_b32 v149, 0
    v_mov_b32 v150, 0
    v_mov_b32 v151, 0
    v_mov_b32 v152, 0
    v_mov_b32 v153, 0
    v_mov_b32 v154, 0
    v_mov_b32 v155, 0
    v_mov_b32 v156, 0
    v_mov_b32 v157, 0
    v_mov_b32 v158, 0
    v_mov_b32 v159, 0
    s_waitcnt lgkmcnt(0)
    v_mfma_f32_32x32x16_bf16 v[128:143], v[80:83], v[64:67], v[128:143]
    v_mfma_f32_32x32x16_bf16 v[144:159], v[96:99], v[64:67], v[144:159]
    v_mfma_f32_32x32x16_bf16 v[128:143], v[84:87], v[68:71], v[128:143]
    v_mfma_f32_32x32x16_bf16 v[144:159], v[100:103], v[68:71], v[144:159]
    v_mfma_f32_32x32x16_bf16 v[128:143], v[88:91], v[72:75], v[128:143]
    v_mfma_f32_32x32x16_bf16 v[144:159], v[104:107], v[72:75], v[144:159]
    v_mfma_f32_32x32x16_bf16 v[128:143], v[92:95], v[76:79], v[128:143]
    v_mfma_f32_32x32x16_bf16 v[144:159], v[108:111], v[76:79], v[144:159]
    s_lshl_b32 s39, s33, 5
    s_add_u32 s39, s39, s35
    s_mul_i32 s39, s39, 5120
    s_add_u32 s39, s39, 15319040
    v_lshlrev_b32 v8, 9, v3
    v_lshl_add_u32 v8, v2, 2, v8
    v_add_u32 v7, 4096, v8
    v_cmp_gt_u32 vcc, 21, v2
    s_nop 1
    s_nop 15
    s_mov_b64 exec, vcc
    buffer_store_dword v128, v8, s[8:11], s39 offen offset:0
    buffer_store_dword v129, v8, s[8:11], s39 offen offset:128
    buffer_store_dword v130, v8, s[8:11], s39 offen offset:256
    buffer_store_dword v131, v8, s[8:11], s39 offen offset:384
    buffer_store_dword v132, v8, s[8:11], s39 offen offset:1024
    buffer_store_dword v133, v8, s[8:11], s39 offen offset:1152
    buffer_store_dword v134, v8, s[8:11], s39 offen offset:1280
    buffer_store_dword v135, v8, s[8:11], s39 offen offset:1408
    buffer_store_dword v136, v8, s[8:11], s39 offen offset:2048
    buffer_store_dword v137, v8, s[8:11], s39 offen offset:2176
    buffer_store_dword v138, v8, s[8:11], s39 offen offset:2304
    buffer_store_dword v139, v8, s[8:11], s39 offen offset:2432
    buffer_store_dword v140, v8, s[8:11], s39 offen offset:3072
    buffer_store_dword v141, v8, s[8:11], s39 offen offset:3200
    buffer_store_dword v142, v8, s[8:11], s39 offen offset:3328
    buffer_store_dword v143, v8, s[8:11], s39 offen offset:3456
    buffer_store_dword v144, v7, s[8:11], s39 offen offset:0
    buffer_store_dword v145, v7, s[8:11], s39 offen offset:128
    buffer_store_dword v146, v7, s[8:11], s39 offen offset:256
    buffer_store_dword v147, v7, s[8:11], s39 offen offset:384
k1b_kernel_end:
    s_endpgm
.p2align 8
.globl krb_kernel
.type krb_kernel,@function
krb_kernel:
    s_cmp_ge_u32 s2, 192
    s_cbranch_scc1 krb_kernel_end
    s_load_dwordx2 s[4:5], s[0:1], 80
    s_load_dwordx2 s[6:7], s[0:1], 64
    s_load_dwordx2 s[20:21], s[0:1], 0
    s_waitcnt lgkmcnt(0)
    s_mov_b32 s8, s4
    s_and_b32 s9, s5, 0xffff
    s_mov_b32 s10, 268435456
    s_mov_b32 s11, 0x20000
    s_mov_b32 s12, s6
    s_and_b32 s13, s7, 0xffff
    s_mov_b32 s14, 2621440
    s_mov_b32 s15, 0x20000
    s_mov_b32 s16, s20
    s_and_b32 s17, s21, 0xffff
    s_mov_b32 s18, 2621440
    s_mov_b32 s19, 0x20000
    s_mul_hi_u32 s33, s2, 0xaaaaaaab
    s_lshr_b32 s33, s33, 2
    s_mul_i32 s34, s33, 6
    s_sub_u32 s34, s2, s34
    s_lshl_b32 s34, s34, 8
    v_add_u32 v1, s34, v0
    v_lshrrev_b32 v2, 9, v1
    v_bfe_u32 v3, v1, 3, 5
    v_bfe_u32 v4, v1, 8, 1
    v_and_b32 v5, 7, v1
    v_lshlrev_b32 v6, 4, v2
    v_lshl_add_u32 v6, v4, 3, v6
    v_add_u32 v6, v6, v5
    v_cmp_eq_u32 vcc, 24, v3
    s_nop 1
    v_cndmask_b32 v7, v3, 20, vcc
    v_cmp_gt_u32 vcc, 21, v7
    s_nop 1
    v_cmp_gt_u32 s[40:41], 40, v6
    s_nop 1
    s_and_b64 vcc, vcc, s[40:41]
    v_lshlrev_b32 v8, 7, v6
    v_lshl_add_u32 v8, v7, 2, v8
    v_mov_b32 v9, 0x10000000
    v_cndmask_b32 v8, v9, v8, vcc
    s_mul_i32 s35, s33, 5120
    s_add_u32 s35, s35, 15319040
    buffer_load_dword v16, v8, s[8:11], s35 offen
    s_add_u32 s35, s35, 163840
    buffer_load_dword v17, v8, s[8:11], s35 offen
    s_add_u32 s35, s35, 163840
    buffer_load_dword v18, v8, s[8:11], s35 offen
    s_add_u32 s35, s35, 163840
    buffer_load_dword v19, v8, s[8:11], s35 offen
    s_add_u32 s35, s35, 163840
    buffer_load_dword v20, v8, s[8:11], s35 offen
    s_add_u32 s35, s35, 163840
    buffer_load_dword v21, v8, s[8:11], s35 offen
    s_add_u32 s35, s35, 163840
    buffer_load_dword v22, v8, s[8:11], s35 offen
    s_add_u32 s35, s35, 163840
    buffer_load_dword v23, v8, s[8:11], s35 offen
    s_add_u32 s35, s35, 163840
    buffer_load_dword v24, v8, s[8:11], s35 offen
    s_add_u32 s35, s35, 163840
    buffer_load_dword v25, v8, s[8:11], s35 offen
    s_add_u32 s35, s35, 163840
    buffer_load_dword v26, v8, s[8:11], s35 offen
    s_add_u32 s35, s35, 163840
    buffer_load_dword v27, v8, s[8:11], s35 offen
    s_add_u32 s35, s35, 163840
    buffer_load_dword v28, v8, s[8:11], s35 offen
    s_add_u32 s35, s35, 163840
    buffer_load_dword v29, v8, s[8:11], s35 offen
    s_add_u32 s35, s35, 163840
    buffer_load_dword v30, v8, s[8:11], s35 offen
    s_add_u32 s35, s35, 163840
    buffer_load_dword v31, v8, s[8:11], s35 offen
    s_add_u32 s35, s35, 163840
    buffer_load_dword v32, v8, s[8:11], s35 offen
    s_add_u32 s35, s35, 163840
    buffer_load_dword v33, v8, s[8:11], s35 offen
    s_add_u32 s35, s35, 163840
    buffer_load_dword v34, v8, s[8:11], s35 offen
    s_add_u32 s35, s35, 163840
    buffer_load_dword v35, v8, s[8:11], s35 offen
    s_add_u32 s35, s35, 163840
    buffer_load_dword v36, v8, s[8:11], s35 offen
    s_add_u32 s35, s35, 163840
    buffer_load_dword v37, v8, s[8:11], s35 offen
    s_add_u32 s35, s35, 163840
    buffer_load_dword v38, v8, s[8:11], s35 offen
    s_add_u32 s35, s35, 163840
    buffer_load_dword v39, v8, s[8:11], s35 offen
    s_add_u32 s35, s35, 163840
    buffer_load_dword v40, v8, s[8:11], s35 offen
    s_add_u32 s35, s35, 163840
    buffer_load_dword v41, v8, s[8:11], s35 offen
    s_add_u32 s35, s35, 163840
    buffer_load_dword v42, v8, s[8:11], s35 offen
    s_add_u32 s35, s35, 163840
    buffer_load_dword v43, v8, s[8:11], s35 offen
    s_add_u32 s35, s35, 163840
    buffer_load_dword v44, v8, s[8:11], s35 offen
    s_add_u32 s35, s35, 163840
    buffer_load_dword v45, v8, s[8:11], s35 offen
    s_add_u32 s35, s35, 163840
    buffer_load_dword v46, v8, s[8:11], s35 offen
    s_add_u32 s35, s35, 163840
    buffer_load_dword v47, v8, s[8:11], s35 offen
    s_add_u32 s35, s35, 163840
    s_waitcnt vmcnt(0)
    v_add_f32 v16, v16, v17
    v_add_f32 v16, v16, v18
    v_add_f32 v16, v16, v19
    v_add_f32 v16, v16, v20
    v_add_f32 v16, v16, v21
    v_add_f32 v16, v16, v22
    v_add_f32 v16, v16, v23
    v_add_f32 v16, v16, v24
    v_add_f32 v16, v16, v25
    v_add_f32 v16, v16, v26
    v_add_f32 v16, v16, v27
    v_add_f32 v16, v16, v28
    v_add_f32 v16, v16, v29
    v_add_f32 v16, v16, v30
    v_add_f32 v16, v16, v31
    v_add_f32 v16, v16, v32
    v_add_f32 v16, v16, v33
    v_add_f32 v16, v16, v34
    v_add_f32 v16, v16, v35
    v_add_f32 v16, v16, v36
    v_add_f32 v16, v16, v37
    v_add_f32 v16, v16, v38
    v_add_f32 v16, v16, v39
    v_add_f32 v16, v16, v40
    v_add_f32 v16, v16, v41
    v_add_f32 v16, v16, v42
    v_add_f32 v16, v16, v43
    v_add_f32 v16, v16, v44
    v_add_f32 v16, v16, v45
    v_add_f32 v16, v16, v46
    v_add_f32 v16, v16, v47
    v_cvt_pk_bf16_f32 v16, v16, v16
    v_lshlrev_b32 v1, 1, v1
    s_mul_i32 s35, s33, 3072
    s_add_u32 s35, s35, 20561920
    buffer_store_short v16, v1, s[8:11], s35 offen
krb_kernel_end:
    s_endpgm
.p2align 8
.globl k2b_kernel
.type k2b_kernel,@function
k2b_kernel:
    s_cmp_ge_u32 s2, 160
    s_cbranch_scc1 k2b_kernel_end
    s_load_dwordx2 s[4:5], s[0:1], 80
    s_load_dwordx2 s[6:7], s[0:1], 64
    s_load_dwordx2 s[20:21], s[0:1], 0
    s_waitcnt lgkmcnt(0)
    s_mov_b32 s8, s4
    s_and_b32 s9, s5, 0xffff
    s_mov_b32 s10, 268435456
    s_mov_b32 s11, 0x20000
    s_mov_b32 s12, s6
    s_and_b32 s13, s7, 0xffff
    s_mov_b32 s14, 2621440
    s_mov_b32 s15, 0x20000
    s_mov_b32 s16, s20
    s_and_b32 s17, s21, 0xffff
    s_mov_b32 s18, 2621440
    s_mov_b32 s19, 0x20000
    v_lshrrev_b32 v1, 6, v0
    s_nop 0
    v_readfirstlane_b32 s32, v1
    v_and_b32 v2, 31, v0
    v_bfe_u32 v3, v0, 5, 1
    v_and_b32 v4, 63, v0
    v_lshlrev_b32 v5, 4, v4
    s_mul_hi_u32 s33, s2, 0xcccccccd
    s_lshr_b32 s33, s33, 2
    s_mul_i32 s35, s33, 5
    s_sub_u32 s35, s2, s35
    s_lshl_b32 s34, s33, 6
    s_mov_b32 s44, -1
    s_mov_b32 s45, 0
    s_mov_b32 s46, 0
    s_mov_b32 s47, -1
    v_add_u32 v6, s34, v2
    v_add_u32 v6, 0, v6
    v_mul_u32_u24 v6, 2560, v6
    v_lshl_add_u32 v6, v3, 4, v6
    v_add_u32 v7, s34, v2
    v_add_u32 v7, 32, v7
    v_mul_u32_u24 v7, 2560, v7
    v_lshl_add_u32 v7, v3, 4, v7
    v_mov_b32 v20, 0x7ff00000
    v_cndmask_b32 v21, v6, v20, s[46:47]
    v_cndmask_b32 v22, v7, v20, s[46:47]
    v_add_u32 v8, 0, v2
    v_mul_u32_u24 v8, 1296, v8
    v_lshl_add_u32 v8, v3, 3, v8
    v_add_u32 v9, 32, v2
    v_mul_u32_u24 v9, 1296, v9
    v_lshl_add_u32 v9, v3, 3, v9
    s_lshl_b32 s36, s32, 3
    s_add_u32 s37, s36, 0
    s_mul_i32 s38, s37, 3072
    s_add_u32 s38, s38, 20561920
    s_mul_i32 s39, s37, 80
    s_add_u32 s39, s39, 10076160
    buffer_load_dwordx4 v[64:67], v5, s[8:11], s38 offen offset:0
    buffer_load_dwordx4 v[68:71], v5, s[8:11], s38 offen offset:1024
    buffer_load_dwordx4 v[72:75], v5, s[8:11], s38 offen offset:2048
    buffer_load_dwordx4 v[76:79], v6, s[8:11], s39 offen offset:0
    buffer_load_dwordx4 v[80:83], v6, s[8:11], s39 offen offset:32
    buffer_load_dwordx4 v[84:87], v21, s[8:11], s39 offen offset:64
    buffer_load_dwordx4 v[88:91], v7, s[8:11], s39 offen offset:0
    buffer_load_dwordx4 v[92:95], v7, s[8:11], s39 offen offset:32
    buffer_load_dwordx4 v[96:99], v22, s[8:11], s39 offen offset:64
    s_add_u32 s37, s36, 1
    s_mul_i32 s38, s37, 3072
    s_add_u32 s38, s38, 20561920
    s_mul_i32 s39, s37, 80
    s_add_u32 s39, s39, 10076160
    buffer_load_dwordx4 v[100:103], v5, s[8:11], s38 offen offset:0
    buffer_load_dwordx4 v[104:107], v5, s[8:11], s38 offen offset:1024
    buffer_load_dwordx4 v[108:111], v5, s[8:11], s38 offen offset:2048
    buffer_load_dwordx4 v[112:115], v6, s[8:11], s39 offen offset:0
    buffer_load_dwordx4 v[116:119], v6, s[8:11], s39 offen offset:32
    buffer_load_dwordx4 v[120:123], v21, s[8:11], s39 offen offset:64
    buffer_load_dwordx4 v[124:127], v7, s[8:11], s39 offen offset:0
    buffer_load_dwordx4 v[128:131], v7, s[8:11], s39 offen offset:32
    buffer_load_dwordx4 v[132:135], v22, s[8:11], s39 offen offset:64
    s_waitcnt vmcnt(9)
    v_mov_b32 v144, 0
    v_mov_b32 v145, 0
    v_mov_b32 v146, 0
    v_mov_b32 v147, 0
    v_mov_b32 v148, 0
    v_mov_b32 v149, 0
    v_mov_b32 v150, 0
    v_mov_b32 v151, 0
    v_mov_b32 v152, 0
    v_mov_b32 v153, 0
    v_mov_b32 v154, 0
    v_mov_b32 v155, 0
    v_mov_b32 v156, 0
    v_mov_b32 v157, 0
    v_mov_b32 v158, 0
    v_mov_b32 v159, 0
    v_mov_b32 v160, 0
    v_mov_b32 v161, 0
    v_mov_b32 v162, 0
    v_mov_b32 v163, 0
    v_mov_b32 v164, 0
    v_mov_b32 v165, 0
    v_mov_b32 v166, 0
    v_mov_b32 v167, 0
    v_mov_b32 v168, 0
    v_mov_b32 v169, 0
    v_mov_b32 v170, 0
    v_mov_b32 v171, 0
    v_mov_b32 v172, 0
    v_mov_b32 v173, 0
    v_mov_b32 v174, 0
    v_mov_b32 v175, 0
    s_nop 1
    v_mfma_f32_32x32x16_bf16 v[144:159], v[64:67], v[76:79], v[144:159]
    v_mfma_f32_32x32x16_bf16 v[160:175], v[64:67], v[88:91], v[160:175]
    v_mfma_f32_32x32x16_bf16 v[144:159], v[68:71], v[80:83], v[144:159]
    v_mfma_f32_32x32x16_bf16 v[160:175], v[68:71], v[92:95], v[160:175]
    v_mfma_f32_32x32x16_bf16 v[144:159], v[72:75], v[84:87], v[144:159]
    v_mfma_f32_32x32x16_bf16 v[160:175], v[72:75], v[96:99], v[160:175]
    s_nop 15
    s_add_u32 s37, s36, 0
    s_mul_i32 s37, s37, 40
    v_cndmask_b32 v10, v156, v152, s[46:47]
    v_add_f32 v10, 0x358637bd, v10
    v_rcp_f32 v10, v10
    s_nop 0
    v_mul_f32 v144, v144, v10
    v_mul_f32 v145, v145, v10
    v_mul_f32 v146, v146, v10
    v_mul_f32 v147, v147, v10
    v_mul_f32 v148, v148, v10
    v_mul_f32 v149, v149, v10
    v_mul_f32 v150, v150, v10
    v_mul_f32 v151, v151, v10
    v_mul_f32 v152, v152, v10
    v_mul_f32 v153, v153, v10
    v_mul_f32 v154, v154, v10
    v_mul_f32 v155, v155, v10
    v_cvt_pk_bf16_f32 v12, v144, v145
    v_cvt_pk_bf16_f32 v13, v146, v147
    v_cvt_pk_bf16_f32 v14, v148, v149
    v_cvt_pk_bf16_f32 v15, v150, v151
    v_cvt_pk_bf16_f32 v16, v152, v153
    v_cvt_pk_bf16_f32 v17, v154, v155
    v_add_u32 v11, s37, v8
    ds_write_b64 v11, v[12:13]
    ds_write_b64 v11, v[14:15] offset:16
    s_mov_b64 exec, s[44:45]
    ds_write_b64 v11, v[16:17] offset:32
    s_mov_b64 exec, -1
    v_cndmask_b32 v10, v172, v168, s[46:47]
    v_add_f32 v10, 0x358637bd, v10
    v_rcp_f32 v10, v10
    s_nop 0
    v_mul_f32 v160, v160, v10
    v_mul_f32 v161, v161, v10
    v_mul_f32 v162, v162, v10
    v_mul_f32 v163, v163, v10
    v_mul_f32 v164, v164, v10
    v_mul_f32 v165, v165, v10
    v_mul_f32 v166, v166, v10
    v_mul_f32 v167, v167, v10
    v_mul_f32 v168, v168, v10
    v_mul_f32 v169, v169, v10
    v_mul_f32 v170, v170, v10
    v_mul_f32 v171, v171, v10
    v_cvt_pk_bf16_f32 v12, v160, v161
    v_cvt_pk_bf16_f32 v13, v162, v163
    v_cvt_pk_bf16_f32 v14, v164, v165
    v_cvt_pk_bf16_f32 v15, v166, v167
    v_cvt_pk_bf16_f32 v16, v168, v169
    v_cvt_pk_bf16_f32 v17, v170, v171
    v_add_u32 v11, s37, v9
    ds_write_b64 v11, v[12:13]
    ds_write_b64 v11, v[14:15] offset:16
    s_mov_b64 exec, s[44:45]
    ds_write_b64 v11, v[16:17] offset:32
    s_mov_b64 exec, -1
    s_add_u32 s37, s36, 2
    s_mul_i32 s38, s37, 3072
    s_add_u32 s38, s38, 20561920
    s_mul_i32 s39, s37, 80
    s_add_u32 s39, s39, 10076160
    buffer_load_dwordx4 v[64:67], v5, s[8:11], s38 offen offset:0
    buffer_load_dwordx4 v[68:71], v5, s[8:11], s38 offen offset:1024
    buffer_load_dwordx4 v[72:75], v5, s[8:11], s38 offen offset:2048
    buffer_load_dwordx4 v[76:79], v6, s[8:11], s39 offen offset:0
    buffer_load_dwordx4 v[80:83], v6, s[8:11], s39 offen offset:32
    buffer_load_dwordx4 v[84:87], v21, s[8:11], s39 offen offset:64
    buffer_load_dwordx4 v[88:91], v7, s[8:11], s39 offen offset:0
    buffer_load_dwordx4 v[92:95], v7, s[8:11], s39 offen offset:32
    buffer_load_dwordx4 v[96:99], v22, s[8:11], s39 offen offset:64
    s_waitcnt vmcnt(9)
    v_mov_b32 v144, 0
    v_mov_b32 v145, 0
    v_mov_b32 v146, 0
    v_mov_b32 v147, 0
    v_mov_b32 v148, 0
    v_mov_b32 v149, 0
    v_mov_b32 v150, 0
    v_mov_b32 v151, 0
    v_mov_b32 v152, 0
    v_mov_b32 v153, 0
    v_mov_b32 v154, 0
    v_mov_b32 v155, 0
    v_mov_b32 v156, 0
    v_mov_b32 v157, 0
    v_mov_b32 v158, 0
    v_mov_b32 v159, 0
    v_mov_b32 v160, 0
    v_mov_b32 v161, 0
    v_mov_b32 v162, 0
    v_mov_b32 v163, 0
    v_mov_b32 v164, 0
    v_mov_b32 v165, 0
    v_mov_b32 v166, 0
    v_mov_b32 v167, 0
    v_mov_b32 v168, 0
    v_mov_b32 v169, 0
    v_mov_b32 v170, 0
    v_mov_b32 v171, 0
    v_mov_b32 v172, 0
    v_mov_b32 v173, 0
    v_mov_b32 v174, 0
    v_mov_b32 v175, 0
    s_nop 1
    v_mfma_f32_32x32x16_bf16 v[144:159], v[100:103], v[112:115], v[144:159]
    v_mfma_f32_32x32x16_bf16 v[160:175], v[100:103], v[124:127], v[160:175]
    v_mfma_f32_32x32x16_bf16 v[144:159], v[104:107], v[116:119], v[144:159]
    v_mfma_f32_32x32x16_bf16 v[160:175], v[104:107], v[128:131], v[160:175]
    v_mfma_f32_32x32x16_bf16 v[144:159], v[108:111], v[120:123], v[144:159]
    v_mfma_f32_32x32x16_bf16 v[160:175], v[108:111], v[132:135], v[160:175]
    s_nop 15
    s_add_u32 s37, s36, 1
    s_mul_i32 s37, s37, 40
    v_cndmask_b32 v10, v156, v152, s[46:47]
    v_add_f32 v10, 0x358637bd, v10
    v_rcp_f32 v10, v10
    s_nop 0
    v_mul_f32 v144, v144, v10
    v_mul_f32 v145, v145, v10
    v_mul_f32 v146, v146, v10
    v_mul_f32 v147, v147, v10
    v_mul_f32 v148, v148, v10
    v_mul_f32 v149, v149, v10
    v_mul_f32 v150, v150, v10
    v_mul_f32 v151, v151, v10
    v_mul_f32 v152, v152, v10
    v_mul_f32 v153, v153, v10
    v_mul_f32 v154, v154, v10
    v_mul_f32 v155, v155, v10
    v_cvt_pk_bf16_f32 v12, v144, v145
    v_cvt_pk_bf16_f32 v13, v146, v147
    v_cvt_pk_bf16_f32 v14, v148, v149
    v_cvt_pk_bf16_f32 v15, v150, v151
    v_cvt_pk_bf16_f32 v16, v152, v153
    v_cvt_pk_bf16_f32 v17, v154, v155
    v_add_u32 v11, s37, v8
    ds_write_b64 v11, v[12:13]
    ds_write_b64 v11, v[14:15] offset:16
    s_mov_b64 exec, s[44:45]
    ds_write_b64 v11, v[16:17] offset:32
    s_mov_b64 exec, -1
    v_cndmask_b32 v10, v172, v168, s[46:47]
    v_add_f32 v10, 0x358637bd, v10
    v_rcp_f32 v10, v10
    s_nop 0
    v_mul_f32 v160, v160, v10
    v_mul_f32 v161, v161, v10
    v_mul_f32 v162, v162, v10
    v_mul_f32 v163, v163, v10
    v_mul_f32 v164, v164, v10
    v_mul_f32 v165, v165, v10
    v_mul_f32 v166, v166, v10
    v_mul_f32 v167, v167, v10
    v_mul_f32 v168, v168, v10
    v_mul_f32 v169, v169, v10
    v_mul_f32 v170, v170, v10
    v_mul_f32 v171, v171, v10
    v_cvt_pk_bf16_f32 v12, v160, v161
    v_cvt_pk_bf16_f32 v13, v162, v163
    v_cvt_pk_bf16_f32 v14, v164, v165
    v_cvt_pk_bf16_f32 v15, v166, v167
    v_cvt_pk_bf16_f32 v16, v168, v169
    v_cvt_pk_bf16_f32 v17, v170, v171
    v_add_u32 v11, s37, v9
    ds_write_b64 v11, v[12:13]
    ds_write_b64 v11, v[14:15] offset:16
    s_mov_b64 exec, s[44:45]
    ds_write_b64 v11, v[16:17] offset:32
    s_mov_b64 exec, -1
    s_add_u32 s37, s36, 3
    s_mul_i32 s38, s37, 3072
    s_add_u32 s38, s38, 20561920
    s_mul_i32 s39, s37, 80
    s_add_u32 s39, s39, 10076160
    buffer_load_dwordx4 v[100:103], v5, s[8:11], s38 offen offset:0
    buffer_load_dwordx4 v[104:107], v5, s[8:11], s38 offen offset:1024
    buffer_load_dwordx4 v[108:111], v5, s[8:11], s38 offen offset:2048
    buffer_load_dwordx4 v[112:115], v6, s[8:11], s39 offen offset:0
    buffer_load_dwordx4 v[116:119], v6, s[8:11], s39 offen offset:32
    buffer_load_dwordx4 v[120:123], v21, s[8:11], s39 offen offset:64
    buffer_load_dwordx4 v[124:127], v7, s[8:11], s39 offen offset:0
    buffer_load_dwordx4 v[128:131], v7, s[8:11], s39 offen offset:32
    buffer_load_dwordx4 v[132:135], v22, s[8:11], s39 offen offset:64
    s_waitcnt vmcnt(9)
    v_mov_b32 v144, 0
    v_mov_b32 v145, 0
    v_mov_b32 v146, 0
    v_mov_b32 v147, 0
    v_mov_b32 v148, 0
    v_mov_b32 v149, 0
    v_mov_b32 v150, 0
    v_mov_b32 v151, 0
    v_mov_b32 v152, 0
    v_mov_b32 v153, 0
    v_mov_b32 v154, 0
    v_mov_b32 v155, 0
    v_mov_b32 v156, 0
    v_mov_b32 v157, 0
    v_mov_b32 v158, 0
    v_mov_b32 v159, 0
    v_mov_b32 v160, 0
    v_mov_b32 v161, 0
    v_mov_b32 v162, 0
    v_mov_b32 v163, 0
    v_mov_b32 v164, 0
    v_mov_b32 v165, 0
    v_mov_b32 v166, 0
    v_mov_b32 v167, 0
    v_mov_b32 v168, 0
    v_mov_b32 v169, 0
    v_mov_b32 v170, 0
    v_mov_b32 v171, 0
    v_mov_b32 v172, 0
    v_mov_b32 v173, 0
    v_mov_b32 v174, 0
    v_mov_b32 v175, 0
    s_nop 1
    v_mfma_f32_32x32x16_bf16 v[144:159], v[64:67], v[76:79], v[144:159]
    v_mfma_f32_32x32x16_bf16 v[160:175], v[64:67], v[88:91], v[160:175]
    v_mfma_f32_32x32x16_bf16 v[144:159], v[68:71], v[80:83], v[144:159]
    v_mfma_f32_32x32x16_bf16 v[160:175], v[68:71], v[92:95], v[160:175]
    v_mfma_f32_32x32x16_bf16 v[144:159], v[72:75], v[84:87], v[144:159]
    v_mfma_f32_32x32x16_bf16 v[160:175], v[72:75], v[96:99], v[160:175]
    s_nop 15
    s_add_u32 s37, s36, 2
    s_mul_i32 s37, s37, 40
    v_cndmask_b32 v10, v156, v152, s[46:47]
    v_add_f32 v10, 0x358637bd, v10
    v_rcp_f32 v10, v10
    s_nop 0
    v_mul_f32 v144, v144, v10
    v_mul_f32 v145, v145, v10
    v_mul_f32 v146, v146, v10
    v_mul_f32 v147, v147, v10
    v_mul_f32 v148, v148, v10
    v_mul_f32 v149, v149, v10
    v_mul_f32 v150, v150, v10
    v_mul_f32 v151, v151, v10
    v_mul_f32 v152, v152, v10
    v_mul_f32 v153, v153, v10
    v_mul_f32 v154, v154, v10
    v_mul_f32 v155, v155, v10
    v_cvt_pk_bf16_f32 v12, v144, v145
    v_cvt_pk_bf16_f32 v13, v146, v147
    v_cvt_pk_bf16_f32 v14, v148, v149
    v_cvt_pk_bf16_f32 v15, v150, v151
    v_cvt_pk_bf16_f32 v16, v152, v153
    v_cvt_pk_bf16_f32 v17, v154, v155
    v_add_u32 v11, s37, v8
    ds_write_b64 v11, v[12:13]
    ds_write_b64 v11, v[14:15] offset:16
    s_mov_b64 exec, s[44:45]
    ds_write_b64 v11, v[16:17] offset:32
    s_mov_b64 exec, -1
    v_cndmask_b32 v10, v172, v168, s[46:47]
    v_add_f32 v10, 0x358637bd, v10
    v_rcp_f32 v10, v10
    s_nop 0
    v_mul_f32 v160, v160, v10
    v_mul_f32 v161, v161, v10
    v_mul_f32 v162, v162, v10
    v_mul_f32 v163, v163, v10
    v_mul_f32 v164, v164, v10
    v_mul_f32 v165, v165, v10
    v_mul_f32 v166, v166, v10
    v_mul_f32 v167, v167, v10
    v_mul_f32 v168, v168, v10
    v_mul_f32 v169, v169, v10
    v_mul_f32 v170, v170, v10
    v_mul_f32 v171, v171, v10
    v_cvt_pk_bf16_f32 v12, v160, v161
    v_cvt_pk_bf16_f32 v13, v162, v163
    v_cvt_pk_bf16_f32 v14, v164, v165
    v_cvt_pk_bf16_f32 v15, v166, v167
    v_cvt_pk_bf16_f32 v16, v168, v169
    v_cvt_pk_bf16_f32 v17, v170, v171
    v_add_u32 v11, s37, v9
    ds_write_b64 v11, v[12:13]
    ds_write_b64 v11, v[14:15] offset:16
    s_mov_b64 exec, s[44:45]
    ds_write_b64 v11, v[16:17] offset:32
    s_mov_b64 exec, -1
    s_add_u32 s37, s36, 4
    s_mul_i32 s38, s37, 3072
    s_add_u32 s38, s38, 20561920
    s_mul_i32 s39, s37, 80
    s_add_u32 s39, s39, 10076160
    buffer_load_dwordx4 v[64:67], v5, s[8:11], s38 offen offset:0
    buffer_load_dwordx4 v[68:71], v5, s[8:11], s38 offen offset:1024
    buffer_load_dwordx4 v[72:75], v5, s[8:11], s38 offen offset:2048
    buffer_load_dwordx4 v[76:79], v6, s[8:11], s39 offen offset:0
    buffer_load_dwordx4 v[80:83], v6, s[8:11], s39 offen offset:32
    buffer_load_dwordx4 v[84:87], v21, s[8:11], s39 offen offset:64
    buffer_load_dwordx4 v[88:91], v7, s[8:11], s39 offen offset:0
    buffer_load_dwordx4 v[92:95], v7, s[8:11], s39 offen offset:32
    buffer_load_dwordx4 v[96:99], v22, s[8:11], s39 offen offset:64
    s_waitcnt vmcnt(9)
    v_mov_b32 v144, 0
    v_mov_b32 v145, 0
    v_mov_b32 v146, 0
    v_mov_b32 v147, 0
    v_mov_b32 v148, 0
    v_mov_b32 v149, 0
    v_mov_b32 v150, 0
    v_mov_b32 v151, 0
    v_mov_b32 v152, 0
    v_mov_b32 v153, 0
    v_mov_b32 v154, 0
    v_mov_b32 v155, 0
    v_mov_b32 v156, 0
    v_mov_b32 v157, 0
    v_mov_b32 v158, 0
    v_mov_b32 v159, 0
    v_mov_b32 v160, 0
    v_mov_b32 v161, 0
    v_mov_b32 v162, 0
    v_mov_b32 v163, 0
    v_mov_b32 v164, 0
    v_mov_b32 v165, 0
    v_mov_b32 v166, 0
    v_mov_b32 v167, 0
    v_mov_b32 v168, 0
    v_mov_b32 v169, 0
    v_mov_b32 v170, 0
    v_mov_b32 v171, 0
    v_mov_b32 v172, 0
    v_mov_b32 v173, 0
    v_mov_b32 v174, 0
    v_mov_b32 v175, 0
    s_nop 1
    v_mfma_f32_32x32x16_bf16 v[144:159], v[100:103], v[112:115], v[144:159]
    v_mfma_f32_32x32x16_bf16 v[160:175], v[100:103], v[124:127], v[160:175]
    v_mfma_f32_32x32x16_bf16 v[144:159], v[104:107], v[116:119], v[144:159]
    v_mfma_f32_32x32x16_bf16 v[160:175], v[104:107], v[128:131], v[160:175]
    v_mfma_f32_32x32x16_bf16 v[144:159], v[108:111], v[120:123], v[144:159]
    v_mfma_f32_32x32x16_bf16 v[160:175], v[108:111], v[132:135], v[160:175]
    s_nop 15
    s_add_u32 s37, s36, 3
    s_mul_i32 s37, s37, 40
    v_cndmask_b32 v10, v156, v152, s[46:47]
    v_add_f32 v10, 0x358637bd, v10
    v_rcp_f32 v10, v10
    s_nop 0
    v_mul_f32 v144, v144, v10
    v_mul_f32 v145, v145, v10
    v_mul_f32 v146, v146, v10
    v_mul_f32 v147, v147, v10
    v_mul_f32 v148, v148, v10
    v_mul_f32 v149, v149, v10
    v_mul_f32 v150, v150, v10
    v_mul_f32 v151, v151, v10
    v_mul_f32 v152, v152, v10
    v_mul_f32 v153, v153, v10
    v_mul_f32 v154, v154, v10
    v_mul_f32 v155, v155, v10
    v_cvt_pk_bf16_f32 v12, v144, v145
    v_cvt_pk_bf16_f32 v13, v146, v147
    v_cvt_pk_bf16_f32 v14, v148, v149
    v_cvt_pk_bf16_f32 v15, v150, v151
    v_cvt_pk_bf16_f32 v16, v152, v153
    v_cvt_pk_bf16_f32 v17, v154, v155
    v_add_u32 v11, s37, v8
    ds_write_b64 v11, v[12:13]
    ds_write_b64 v11, v[14:15] offset:16
    s_mov_b64 exec, s[44:45]
    ds_write_b64 v11, v[16:17] offset:32
    s_mov_b64 exec, -1
    v_cndmask_b32 v10, v172, v168, s[46:47]
    v_add_f32 v10, 0x358637bd, v10
    v_rcp_f32 v10, v10
    s_nop 0
    v_mul_f32 v160, v160, v10
    v_mul_f32 v161, v161, v10
    v_mul_f32 v162, v162, v10
    v_mul_f32 v163, v163, v10
    v_mul_f32 v164, v164, v10
    v_mul_f32 v165, v165, v10
    v_mul_f32 v166, v166, v10
    v_mul_f32 v167, v167, v10
    v_mul_f32 v168, v168, v10
    v_mul_f32 v169, v169, v10
    v_mul_f32 v170, v170, v10
    v_mul_f32 v171, v171, v10
    v_cvt_pk_bf16_f32 v12, v160, v161
    v_cvt_pk_bf16_f32 v13, v162, v163
    v_cvt_pk_bf16_f32 v14, v164, v165
    v_cvt_pk_bf16_f32 v15, v166, v167
    v_cvt_pk_bf16_f32 v16, v168, v169
    v_cvt_pk_bf16_f32 v17, v170, v171
    v_add_u32 v11, s37, v9
    ds_write_b64 v11, v[12:13]
    ds_write_b64 v11, v[14:15] offset:16
    s_mov_b64 exec, s[44:45]
    ds_write_b64 v11, v[16:17] offset:32
    s_mov_b64 exec, -1
    s_add_u32 s37, s36, 5
    s_mul_i32 s38, s37, 3072
    s_add_u32 s38, s38, 20561920
    s_mul_i32 s39, s37, 80
    s_add_u32 s39, s39, 10076160
    buffer_load_dwordx4 v[100:103], v5, s[8:11], s38 offen offset:0
    buffer_load_dwordx4 v[104:107], v5, s[8:11], s38 offen offset:1024
    buffer_load_dwordx4 v[108:111], v5, s[8:11], s38 offen offset:2048
    buffer_load_dwordx4 v[112:115], v6, s[8:11], s39 offen offset:0
    buffer_load_dwordx4 v[116:119], v6, s[8:11], s39 offen offset:32
    buffer_load_dwordx4 v[120:123], v21, s[8:11], s39 offen offset:64
    buffer_load_dwordx4 v[124:127], v7, s[8:11], s39 offen offset:0
    buffer_load_dwordx4 v[128:131], v7, s[8:11], s39 offen offset:32
    buffer_load_dwordx4 v[132:135], v22, s[8:11], s39 offen offset:64
    s_waitcnt vmcnt(9)
    v_mov_b32 v144, 0
    v_mov_b32 v145, 0
    v_mov_b32 v146, 0
    v_mov_b32 v147, 0
    v_mov_b32 v148, 0
    v_mov_b32 v149, 0
    v_mov_b32 v150, 0
    v_mov_b32 v151, 0
    v_mov_b32 v152, 0
    v_mov_b32 v153, 0
    v_mov_b32 v154, 0
    v_mov_b32 v155, 0
    v_mov_b32 v156, 0
    v_mov_b32 v157, 0
    v_mov_b32 v158, 0
    v_mov_b32 v159, 0
    v_mov_b32 v160, 0
    v_mov_b32 v161, 0
    v_mov_b32 v162, 0
    v_mov_b32 v163, 0
    v_mov_b32 v164, 0
    v_mov_b32 v165, 0
    v_mov_b32 v166, 0
    v_mov_b32 v167, 0
    v_mov_b32 v168, 0
    v_mov_b32 v169, 0
    v_mov_b32 v170, 0
    v_mov_b32 v171, 0
    v_mov_b32 v172, 0
    v_mov_b32 v173, 0
    v_mov_b32 v174, 0
    v_mov_b32 v175, 0
    s_nop 1
    v_mfma_f32_32x32x16_bf16 v[144:159], v[64:67], v[76:79], v[144:159]
    v_mfma_f32_32x32x16_bf16 v[160:175], v[64:67], v[88:91], v[160:175]
    v_mfma_f32_32x32x16_bf16 v[144:159], v[68:71], v[80:83], v[144:159]
    v_mfma_f32_32x32x16_bf16 v[160:175], v[68:71], v[92:95], v[160:175]
    v_mfma_f32_32x32x16_bf16 v[144:159], v[72:75], v[84:87], v[144:159]
    v_mfma_f32_32x32x16_bf16 v[160:175], v[72:75], v[96:99], v[160:175]
    s_nop 15
    s_add_u32 s37, s36, 4
    s_mul_i32 s37, s37, 40
    v_cndmask_b32 v10, v156, v152, s[46:47]
    v_add_f32 v10, 0x358637bd, v10
    v_rcp_f32 v10, v10
    s_nop 0
    v_mul_f32 v144, v144, v10
    v_mul_f32 v145, v145, v10
    v_mul_f32 v146, v146, v10
    v_mul_f32 v147, v147, v10
    v_mul_f32 v148, v148, v10
    v_mul_f32 v149, v149, v10
    v_mul_f32 v150, v150, v10
    v_mul_f32 v151, v151, v10
    v_mul_f32 v152, v152, v10
    v_mul_f32 v153, v153, v10
    v_mul_f32 v154, v154, v10
    v_mul_f32 v155, v155, v10
    v_cvt_pk_bf16_f32 v12, v144, v145
    v_cvt_pk_bf16_f32 v13, v146, v147
    v_cvt_pk_bf16_f32 v14, v148, v149
    v_cvt_pk_bf16_f32 v15, v150, v151
    v_cvt_pk_bf16_f32 v16, v152, v153
    v_cvt_pk_bf16_f32 v17, v154, v155
    v_add_u32 v11, s37, v8
    ds_write_b64 v11, v[12:13]
    ds_write_b64 v11, v[14:15] offset:16
    s_mov_b64 exec, s[44:45]
    ds_write_b64 v11, v[16:17] offset:32
    s_mov_b64 exec, -1
    v_cndmask_b32 v10, v172, v168, s[46:47]
    v_add_f32 v10, 0x358637bd, v10
    v_rcp_f32 v10, v10
    s_nop 0
    v_mul_f32 v160, v160, v10
    v_mul_f32 v161, v161, v10
    v_mul_f32 v162, v162, v10
    v_mul_f32 v163, v163, v10
    v_mul_f32 v164, v164, v10
    v_mul_f32 v165, v165, v10
    v_mul_f32 v166, v166, v10
    v_mul_f32 v167, v167, v10
    v_mul_f32 v168, v168, v10
    v_mul_f32 v169, v169, v10
    v_mul_f32 v170, v170, v10
    v_mul_f32 v171, v171, v10
    v_cvt_pk_bf16_f32 v12, v160, v161
    v_cvt_pk_bf16_f32 v13, v162, v163
    v_cvt_pk_bf16_f32 v14, v164, v165
    v_cvt_pk_bf16_f32 v15, v166, v167
    v_cvt_pk_bf16_f32 v16, v168, v169
    v_cvt_pk_bf16_f32 v17, v170, v171
    v_add_u32 v11, s37, v9
    ds_write_b64 v11, v[12:13]
    ds_write_b64 v11, v[14:15] offset:16
    s_mov_b64 exec, s[44:45]
    ds_write_b64 v11, v[16:17] offset:32
    s_mov_b64 exec, -1
    s_add_u32 s37, s36, 6
    s_mul_i32 s38, s37, 3072
    s_add_u32 s38, s38, 20561920
    s_mul_i32 s39, s37, 80
    s_add_u32 s39, s39, 10076160
    buffer_load_dwordx4 v[64:67], v5, s[8:11], s38 offen offset:0
    buffer_load_dwordx4 v[68:71], v5, s[8:11], s38 offen offset:1024
    buffer_load_dwordx4 v[72:75], v5, s[8:11], s38 offen offset:2048
    buffer_load_dwordx4 v[76:79], v6, s[8:11], s39 offen offset:0
    buffer_load_dwordx4 v[80:83], v6, s[8:11], s39 offen offset:32
    buffer_load_dwordx4 v[84:87], v21, s[8:11], s39 offen offset:64
    buffer_load_dwordx4 v[88:91], v7, s[8:11], s39 offen offset:0
    buffer_load_dwordx4 v[92:95], v7, s[8:11], s39 offen offset:32
    buffer_load_dwordx4 v[96:99], v22, s[8:11], s39 offen offset:64
    s_waitcnt vmcnt(9)
    v_mov_b32 v144, 0
    v_mov_b32 v145, 0
    v_mov_b32 v146, 0
    v_mov_b32 v147, 0
    v_mov_b32 v148, 0
    v_mov_b32 v149, 0
    v_mov_b32 v150, 0
    v_mov_b32 v151, 0
    v_mov_b32 v152, 0
    v_mov_b32 v153, 0
    v_mov_b32 v154, 0
    v_mov_b32 v155, 0
    v_mov_b32 v156, 0
    v_mov_b32 v157, 0
    v_mov_b32 v158, 0
    v_mov_b32 v159, 0
    v_mov_b32 v160, 0
    v_mov_b32 v161, 0
    v_mov_b32 v162, 0
    v_mov_b32 v163, 0
    v_mov_b32 v164, 0
    v_mov_b32 v165, 0
    v_mov_b32 v166, 0
    v_mov_b32 v167, 0
    v_mov_b32 v168, 0
    v_mov_b32 v169, 0
    v_mov_b32 v170, 0
    v_mov_b32 v171, 0
    v_mov_b32 v172, 0
    v_mov_b32 v173, 0
    v_mov_b32 v174, 0
    v_mov_b32 v175, 0
    s_nop 1
    v_mfma_f32_32x32x16_bf16 v[144:159], v[100:103], v[112:115], v[144:159]
    v_mfma_f32_32x32x16_bf16 v[160:175], v[100:103], v[124:127], v[160:175]
    v_mfma_f32_32x32x16_bf16 v[144:159], v[104:107], v[116:119], v[144:159]
    v_mfma_f32_32x32x16_bf16 v[160:175], v[104:107], v[128:131], v[160:175]
    v_mfma_f32_32x32x16_bf16 v[144:159], v[108:111], v[120:123], v[144:159]
    v_mfma_f32_32x32x16_bf16 v[160:175], v[108:111], v[132:135], v[160:175]
    s_nop 15
    s_add_u32 s37, s36, 5
    s_mul_i32 s37, s37, 40
    v_cndmask_b32 v10, v156, v152, s[46:47]
    v_add_f32 v10, 0x358637bd, v10
    v_rcp_f32 v10, v10
    s_nop 0
    v_mul_f32 v144, v144, v10
    v_mul_f32 v145, v145, v10
    v_mul_f32 v146, v146, v10
    v_mul_f32 v147, v147, v10
    v_mul_f32 v148, v148, v10
    v_mul_f32 v149, v149, v10
    v_mul_f32 v150, v150, v10
    v_mul_f32 v151, v151, v10
    v_mul_f32 v152, v152, v10
    v_mul_f32 v153, v153, v10
    v_mul_f32 v154, v154, v10
    v_mul_f32 v155, v155, v10
    v_cvt_pk_bf16_f32 v12, v144, v145
    v_cvt_pk_bf16_f32 v13, v146, v147
    v_cvt_pk_bf16_f32 v14, v148, v149
    v_cvt_pk_bf16_f32 v15, v150, v151
    v_cvt_pk_bf16_f32 v16, v152, v153
    v_cvt_pk_bf16_f32 v17, v154, v155
    v_add_u32 v11, s37, v8
    ds_write_b64 v11, v[12:13]
    ds_write_b64 v11, v[14:15] offset:16
    s_mov_b64 exec, s[44:45]
    ds_write_b64 v11, v[16:17] offset:32
    s_mov_b64 exec, -1
    v_cndmask_b32 v10, v172, v168, s[46:47]
    v_add_f32 v10, 0x358637bd, v10
    v_rcp_f32 v10, v10
    s_nop 0
    v_mul_f32 v160, v160, v10
    v_mul_f32 v161, v161, v10
    v_mul_f32 v162, v162, v10
    v_mul_f32 v163, v163, v10
    v_mul_f32 v164, v164, v10
    v_mul_f32 v165, v165, v10
    v_mul_f32 v166, v166, v10
    v_mul_f32 v167, v167, v10
    v_mul_f32 v168, v168, v10
    v_mul_f32 v169, v169, v10
    v_mul_f32 v170, v170, v10
    v_mul_f32 v171, v171, v10
    v_cvt_pk_bf16_f32 v12, v160, v161
    v_cvt_pk_bf16_f32 v13, v162, v163
    v_cvt_pk_bf16_f32 v14, v164, v165
    v_cvt_pk_bf16_f32 v15, v166, v167
    v_cvt_pk_bf16_f32 v16, v168, v169
    v_cvt_pk_bf16_f32 v17, v170, v171
    v_add_u32 v11, s37, v9
    ds_write_b64 v11, v[12:13]
    ds_write_b64 v11, v[14:15] offset:16
    s_mov_b64 exec, s[44:45]
    ds_write_b64 v11, v[16:17] offset:32
    s_mov_b64 exec, -1
    s_add_u32 s37, s36, 7
    s_mul_i32 s38, s37, 3072
    s_add_u32 s38, s38, 20561920
    s_mul_i32 s39, s37, 80
    s_add_u32 s39, s39, 10076160
    buffer_load_dwordx4 v[100:103], v5, s[8:11], s38 offen offset:0
    buffer_load_dwordx4 v[104:107], v5, s[8:11], s38 offen offset:1024
    buffer_load_dwordx4 v[108:111], v5, s[8:11], s38 offen offset:2048
    buffer_load_dwordx4 v[112:115], v6, s[8:11], s39 offen offset:0
    buffer_load_dwordx4 v[116:119], v6, s[8:11], s39 offen offset:32
    buffer_load_dwordx4 v[120:123], v21, s[8:11], s39 offen offset:64
    buffer_load_dwordx4 v[124:127], v7, s[8:11], s39 offen offset:0
    buffer_load_dwordx4 v[128:131], v7, s[8:11], s39 offen offset:32
    buffer_load_dwordx4 v[132:135], v22, s[8:11], s39 offen offset:64
    s_waitcnt vmcnt(9)
    v_mov_b32 v144, 0
    v_mov_b32 v145, 0
    v_mov_b32 v146, 0
    v_mov_b32 v147, 0
    v_mov_b32 v148, 0
    v_mov_b32 v149, 0
    v_mov_b32 v150, 0
    v_mov_b32 v151, 0
    v_mov_b32 v152, 0
    v_mov_b32 v153, 0
    v_mov_b32 v154, 0
    v_mov_b32 v155, 0
    v_mov_b32 v156, 0
    v_mov_b32 v157, 0
    v_mov_b32 v158, 0
    v_mov_b32 v159, 0
    v_mov_b32 v160, 0
    v_mov_b32 v161, 0
    v_mov_b32 v162, 0
    v_mov_b32 v163, 0
    v_mov_b32 v164, 0
    v_mov_b32 v165, 0
    v_mov_b32 v166, 0
    v_mov_b32 v167, 0
    v_mov_b32 v168, 0
    v_mov_b32 v169, 0
    v_mov_b32 v170, 0
    v_mov_b32 v171, 0
    v_mov_b32 v172, 0
    v_mov_b32 v173, 0
    v_mov_b32 v174, 0
    v_mov_b32 v175, 0
    s_nop 1
    v_mfma_f32_32x32x16_bf16 v[144:159], v[64:67], v[76:79], v[144:159]
    v_mfma_f32_32x32x16_bf16 v[160:175], v[64:67], v[88:91], v[160:175]
    v_mfma_f32_32x32x16_bf16 v[144:159], v[68:71], v[80:83], v[144:159]
    v_mfma_f32_32x32x16_bf16 v[160:175], v[68:71], v[92:95], v[160:175]
    v_mfma_f32_32x32x16_bf16 v[144:159], v[72:75], v[84:87], v[144:159]
    v_mfma_f32_32x32x16_bf16 v[160:175], v[72:75], v[96:99], v[160:175]
    s_nop 15
    s_add_u32 s37, s36, 6
    s_mul_i32 s37, s37, 40
    v_cndmask_b32 v10, v156, v152, s[46:47]
    v_add_f32 v10, 0x358637bd, v10
    v_rcp_f32 v10, v10
    s_nop 0
    v_mul_f32 v144, v144, v10
    v_mul_f32 v145, v145, v10
    v_mul_f32 v146, v146, v10
    v_mul_f32 v147, v147, v10
    v_mul_f32 v148, v148, v10
    v_mul_f32 v149, v149, v10
    v_mul_f32 v150, v150, v10
    v_mul_f32 v151, v151, v10
    v_mul_f32 v152, v152, v10
    v_mul_f32 v153, v153, v10
    v_mul_f32 v154, v154, v10
    v_mul_f32 v155, v155, v10
    v_cvt_pk_bf16_f32 v12, v144, v145
    v_cvt_pk_bf16_f32 v13, v146, v147
    v_cvt_pk_bf16_f32 v14, v148, v149
    v_cvt_pk_bf16_f32 v15, v150, v151
    v_cvt_pk_bf16_f32 v16, v152, v153
    v_cvt_pk_bf16_f32 v17, v154, v155
    v_add_u32 v11, s37, v8
    ds_write_b64 v11, v[12:13]
    ds_write_b64 v11, v[14:15] offset:16
    s_mov_b64 exec, s[44:45]
    ds_write_b64 v11, v[16:17] offset:32
    s_mov_b64 exec, -1
    v_cndmask_b32 v10, v172, v168, s[46:47]
    v_add_f32 v10, 0x358637bd, v10
    v_rcp_f32 v10, v10
    s_nop 0
    v_mul_f32 v160, v160, v10
    v_mul_f32 v161, v161, v10
    v_mul_f32 v162, v162, v10
    v_mul_f32 v163, v163, v10
    v_mul_f32 v164, v164, v10
    v_mul_f32 v165, v165, v10
    v_mul_f32 v166, v166, v10
    v_mul_f32 v167, v167, v10
    v_mul_f32 v168, v168, v10
    v_mul_f32 v169, v169, v10
    v_mul_f32 v170, v170, v10
    v_mul_f32 v171, v171, v10
    v_cvt_pk_bf16_f32 v12, v160, v161
    v_cvt_pk_bf16_f32 v13, v162, v163
    v_cvt_pk_bf16_f32 v14, v164, v165
    v_cvt_pk_bf16_f32 v15, v166, v167
    v_cvt_pk_bf16_f32 v16, v168, v169
    v_cvt_pk_bf16_f32 v17, v170, v171
    v_add_u32 v11, s37, v9
    ds_write_b64 v11, v[12:13]
    ds_write_b64 v11, v[14:15] offset:16
    s_mov_b64 exec, s[44:45]
    ds_write_b64 v11, v[16:17] offset:32
    s_mov_b64 exec, -1
    s_waitcnt vmcnt(0)
    v_mov_b32 v144, 0
    v_mov_b32 v145, 0
    v_mov_b32 v146, 0
    v_mov_b32 v147, 0
    v_mov_b32 v148, 0
    v_mov_b32 v149, 0
    v_mov_b32 v150, 0
    v_mov_b32 v151, 0
    v_mov_b32 v152, 0
    v_mov_b32 v153, 0
    v_mov_b32 v154, 0
    v_mov_b32 v155, 0
    v_mov_b32 v156, 0
    v_mov_b32 v157, 0
    v_mov_b32 v158, 0
    v_mov_b32 v159, 0
    v_mov_b32 v160, 0
    v_mov_b32 v161, 0
    v_mov_b32 v162, 0
    v_mov_b32 v163, 0
    v_mov_b32 v164, 0
    v_mov_b32 v165, 0
    v_mov_b32 v166, 0
    v_mov_b32 v167, 0
    v_mov_b32 v168, 0
    v_mov_b32 v169, 0
    v_mov_b32 v170, 0
    v_mov_b32 v171, 0
    v_mov_b32 v172, 0
    v_mov_b32 v173, 0
    v_mov_b32 v174, 0
    v_mov_b32 v175, 0
    s_nop 1
    v_mfma_f32_32x32x16_bf16 v[144:159], v[100:103], v[112:115], v[144:159]
    v_mfma_f32_32x32x16_bf16 v[160:175], v[100:103], v[124:127], v[160:175]
    v_mfma_f32_32x32x16_bf16 v[144:159], v[104:107], v[116:119], v[144:159]
    v_mfma_f32_32x32x16_bf16 v[160:175], v[104:107], v[128:131], v[160:175]
    v_mfma_f32_32x32x16_bf16 v[144:159], v[108:111], v[120:123], v[144:159]
    v_mfma_f32_32x32x16_bf16 v[160:175], v[108:111], v[132:135], v[160:175]
    s_nop 15
    s_add_u32 s37, s36, 7
    s_mul_i32 s37, s37, 40
    v_cndmask_b32 v10, v156, v152, s[46:47]
    v_add_f32 v10, 0x358637bd, v10
    v_rcp_f32 v10, v10
    s_nop 0
    v_mul_f32 v144, v144, v10
    v_mul_f32 v145, v145, v10
    v_mul_f32 v146, v146, v10
    v_mul_f32 v147, v147, v10
    v_mul_f32 v148, v148, v10
    v_mul_f32 v149, v149, v10
    v_mul_f32 v150, v150, v10
    v_mul_f32 v151, v151, v10
    v_mul_f32 v152, v152, v10
    v_mul_f32 v153, v153, v10
    v_mul_f32 v154, v154, v10
    v_mul_f32 v155, v155, v10
    v_cvt_pk_bf16_f32 v12, v144, v145
    v_cvt_pk_bf16_f32 v13, v146, v147
    v_cvt_pk_bf16_f32 v14, v148, v149
    v_cvt_pk_bf16_f32 v15, v150, v151
    v_cvt_pk_bf16_f32 v16, v152, v153
    v_cvt_pk_bf16_f32 v17, v154, v155
    v_add_u32 v11, s37, v8
    ds_write_b64 v11, v[12:13]
    ds_write_b64 v11, v[14:15] offset:16
    s_mov_b64 exec, s[44:45]
    ds_write_b64 v11, v[16:17] offset:32
    s_mov_b64 exec, -1
    v_cndmask_b32 v10, v172, v168, s[46:47]
    v_add_f32 v10, 0x358637bd, v10
    v_rcp_f32 v10, v10
    s_nop 0
    v_mul_f32 v160, v160, v10
    v_mul_f32 v161, v161, v10
    v_mul_f32 v162, v162, v10
    v_mul_f32 v163, v163, v10
    v_mul_f32 v164, v164, v10
    v_mul_f32 v165, v165, v10
    v_mul_f32 v166, v166, v10
    v_mul_f32 v167, v167, v10
    v_mul_f32 v168, v168, v10
    v_mul_f32 v169, v169, v10
    v_mul_f32 v170, v170, v10
    v_mul_f32 v171, v171, v10
    v_cvt_pk_bf16_f32 v12, v160, v161
    v_cvt_pk_bf16_f32 v13, v162, v163
    v_cvt_pk_bf16_f32 v14, v164, v165
    v_cvt_pk_bf16_f32 v15, v166, v167
    v_cvt_pk_bf16_f32 v16, v168, v169
    v_cvt_pk_bf16_f32 v17, v170, v171
    v_add_u32 v11, s37, v9
    ds_write_b64 v11, v[12:13]
    ds_write_b64 v11, v[14:15] offset:16
    s_mov_b64 exec, s[44:45]
    ds_write_b64 v11, v[16:17] offset:32
    s_mov_b64 exec, -1
    s_waitcnt lgkmcnt(0)
    s_barrier
    s_lshl_b32 s37, s35, 2
    s_add_u32 s37, s37, s32
    s_mul_i32 s36, s37, 40960
    s_add_u32 s36, s36, 2621440
    v_mov_b32 v192, 0
    v_mov_b32 v193, 0
    v_mov_b32 v194, 0
    v_mov_b32 v195, 0
    v_mov_b32 v196, 0
    v_mov_b32 v197, 0
    v_mov_b32 v198, 0
    v_mov_b32 v199, 0
    v_mov_b32 v200, 0
    v_mov_b32 v201, 0
    v_mov_b32 v202, 0
    v_mov_b32 v203, 0
    v_mov_b32 v204, 0
    v_mov_b32 v205, 0
    v_mov_b32 v206, 0
    v_mov_b32 v207, 0
    v_mov_b32 v208, 0
    v_mov_b32 v209, 0
    v_mov_b32 v210, 0
    v_mov_b32 v211, 0
    v_mov_b32 v212, 0
    v_mov_b32 v213, 0
    v_mov_b32 v214, 0
    v_mov_b32 v215, 0
    v_mov_b32 v216, 0
    v_mov_b32 v217, 0
    v_mov_b32 v218, 0
    v_mov_b32 v219, 0
    v_mov_b32 v220, 0
    v_mov_b32 v221, 0
    v_mov_b32 v222, 0
    v_mov_b32 v223, 0
    v_add_u32 v44, 0, v5
    v_mul_u32_u24 v46, 1296, v2
    v_lshl_add_u32 v46, v3, 4, v46
    s_mov_b32 s40, s36
    s_add_u32 s41, s40, 4096
    s_add_u32 s42, s40, 8192
    s_add_u32 s43, s40, 12288
    s_add_u32 s44, s40, 16384
    buffer_load_dwordx4 v[64:67], v44, s[8:11], s40 offen offset:0
    buffer_load_dwordx4 v[68:71], v44, s[8:11], s40 offen offset:1024
    buffer_load_dwordx4 v[72:75], v44, s[8:11], s40 offen offset:2048
    buffer_load_dwordx4 v[76:79], v44, s[8:11], s40 offen offset:3072
    buffer_load_dwordx4 v[80:83], v44, s[8:11], s41 offen offset:0
    buffer_load_dwordx4 v[84:87], v44, s[8:11], s41 offen offset:1024
    buffer_load_dwordx4 v[88:91], v44, s[8:11], s41 offen offset:2048
    buffer_load_dwordx4 v[92:95], v44, s[8:11], s41 offen offset:3072
    buffer_load_dwordx4 v[96:99], v44, s[8:11], s42 offen offset:0
    buffer_load_dwordx4 v[100:103], v44, s[8:11], s42 offen offset:1024
    buffer_load_dwordx4 v[104:107], v44, s[8:11], s42 offen offset:2048
    buffer_load_dwordx4 v[108:111], v44, s[8:11], s42 offen offset:3072
    buffer_load_dwordx4 v[112:115], v44, s[8:11], s43 offen offset:0
    buffer_load_dwordx4 v[116:119], v44, s[8:11], s43 offen offset:1024
    buffer_load_dwordx4 v[120:123], v44, s[8:11], s43 offen offset:2048
    buffer_load_dwordx4 v[124:127], v44, s[8:11], s43 offen offset:3072
    buffer_load_dwordx4 v[128:131], v44, s[8:11], s44 offen offset:0
    buffer_load_dwordx4 v[132:135], v44, s[8:11], s44 offen offset:1024
    buffer_load_dwordx4 v[136:139], v44, s[8:11], s44 offen offset:2048
    buffer_load_dwordx4 v[140:143], v44, s[8:11], s44 offen offset:3072
    s_add_u32 s40, s40, 20480
    s_add_u32 s41, s41, 20480
    s_add_u32 s42, s42, 20480
    s_add_u32 s43, s43, 20480
    s_add_u32 s44, s44, 20480
    ds_read_b128 v[48:51], v46 offset:0
    ds_read_b128 v[52:55], v46 offset:41472
    s_mov_b32 s48, 2
gl_k2b_kernel:
    ds_read_b128 v[56:59], v46 offset:32
    ds_read_b128 v[60:63], v46 offset:41504
    s_waitcnt vmcnt(19) lgkmcnt(2)
    v_mfma_f32_32x32x16_bf16 v[192:207], v[64:67], v[48:51], v[192:207]
    v_mfma_f32_32x32x16_bf16 v[208:223], v[64:67], v[52:55], v[208:223]
    buffer_load_dwordx4 v[64:67], v44, s[8:11], s40 offen offset:0
    ds_read_b128 v[48:51], v46 offset:64
    ds_read_b128 v[52:55], v46 offset:41536
    s_waitcnt vmcnt(19) lgkmcnt(2)
    v_mfma_f32_32x32x16_bf16 v[192:207], v[68:71], v[56:59], v[192:207]
    v_mfma_f32_32x32x16_bf16 v[208:223], v[68:71], v[60:63], v[208:223]
    buffer_load_dwordx4 v[68:71], v44, s[8:11], s40 offen offset:1024
    ds_read_b128 v[56:59], v46 offset:96
    ds_read_b128 v[60:63], v46 offset:41568
    s_waitcnt vmcnt(19) lgkmcnt(2)
    v_mfma_f32_32x32x16_bf16 v[192:207], v[72:75], v[48:51], v[192:207]
    v_mfma_f32_32x32x16_bf16 v[208:223], v[72:75], v[52:55], v[208:223]
    buffer_load_dwordx4 v[72:75], v44, s[8:11], s40 offen offset:2048
    ds_read_b128 v[48:51], v46 offset:128
    ds_read_b128 v[52:55], v46 offset:41600
    s_waitcnt vmcnt(19) lgkmcnt(2)
    v_mfma_f32_32x32x16_bf16 v[192:207], v[76:79], v[56:59], v[192:207]
    v_mfma_f32_32x32x16_bf16 v[208:223], v[76:79], v[60:63], v[208:223]
    buffer_load_dwordx4 v[76:79], v44, s[8:11], s40 offen offset:3072
    ds_read_b128 v[56:59], v46 offset:160
    ds_read_b128 v[60:63], v46 offset:41632
    s_waitcnt vmcnt(19) lgkmcnt(2)
    v_mfma_f32_32x32x16_bf16 v[192:207], v[80:83], v[48:51], v[192:207]
    v_mfma_f32_32x32x16_bf16 v[208:223], v[80:83], v[52:55], v[208:223]
    buffer_load_dwordx4 v[80:83], v44, s[8:11], s41 offen offset:0
    ds_read_b128 v[48:51], v46 offset:192
    ds_read_b128 v[52:55], v46 offset:41664
    s_waitcnt vmcnt(19) lgkmcnt(2)
    v_mfma_f32_32x32x16_bf16 v[192:207], v[84:87], v[56:59], v[192:207]
    v_mfma_f32_32x32x16_bf16 v[208:223], v[84:87], v[60:63], v[208:223]
    buffer_load_dwordx4 v[84:87], v44, s[8:11], s41 offen offset:1024
    ds_read_b128 v[56:59], v46 offset:224
    ds_read_b128 v[60:63], v46 offset:41696
    s_waitcnt vmcnt(19) lgkmcnt(2)
    v_mfma_f32_32x32x16_bf16 v[192:207], v[88:91], v[48:51], v[192:207]
    v_mfma_f32_32x32x16_bf16 v[208:223], v[88:91], v[52:55], v[208:223]
    buffer_load_dwordx4 v[88:91], v44, s[8:11], s41 offen offset:2048
    ds_read_b128 v[48:51], v46 offset:256
    ds_read_b128 v[52:55], v46 offset:41728
    s_waitcnt vmcnt(19) lgkmcnt(2)
    v_mfma_f32_32x32x16_bf16 v[192:207], v[92:95], v[56:59], v[192:207]
    v_mfma_f32_32x32x16_bf16 v[208:223], v[92:95], v[60:63], v[208:223]
    buffer_load_dwordx4 v[92:95], v44, s[8:11], s41 offen offset:3072
    ds_read_b128 v[56:59], v46 offset:288
    ds_read_b128 v[60:63], v46 offset:41760
    s_waitcnt vmcnt(19) lgkmcnt(2)
    v_mfma_f32_32x32x16_bf16 v[192:207], v[96:99], v[48:51], v[192:207]
    v_mfma_f32_32x32x16_bf16 v[208:223], v[96:99], v[52:55], v[208:223]
    buffer_load_dwordx4 v[96:99], v44, s[8:11], s42 offen offset:0
    ds_read_b128 v[48:51], v46 offset:320
    ds_read_b128 v[52:55], v46 offset:41792
    s_waitcnt vmcnt(19) lgkmcnt(2)
    v_mfma_f32_32x32x16_bf16 v[192:207], v[100:103], v[56:59], v[192:207]
    v_mfma_f32_32x32x16_bf16 v[208:223], v[100:103], v[60:63], v[208:223]
    buffer_load_dwordx4 v[100:103], v44, s[8:11], s42 offen offset:1024
    ds_read_b128 v[56:59], v46 offset:352
    ds_read_b128 v[60:63], v46 offset:41824
    s_waitcnt vmcnt(19) lgkmcnt(2)
    v_mfma_f32_32x32x16_bf16 v[192:207], v[104:107], v[48:51], v[192:207]
    v_mfma_f32_32x32x16_bf16 v[208:223], v[104:107], v[52:55], v[208:223]
    buffer_load_dwordx4 v[104:107], v44, s[8:11], s42 offen offset:2048
    ds_read_b128 v[48:51], v46 offset:384
    ds_read_b128 v[52:55], v46 offset:41856
    s_waitcnt vmcnt(19) lgkmcnt(2)
    v_mfma_f32_32x32x16_bf16 v[192:207], v[108:111], v[56:59], v[192:207]
    v_mfma_f32_32x32x16_bf16 v[208:223], v[108:111], v[60:63], v[208:223]
    buffer_load_dwordx4 v[108:111], v44, s[8:11], s42 offen offset:3072
    ds_read_b128 v[56:59], v46 offset:416
    ds_read_b128 v[60:63], v46 offset:41888
    s_waitcnt vmcnt(19) lgkmcnt(2)
    v_mfma_f32_32x32x16_bf16 v[192:207], v[112:115], v[48:51], v[192:207]
    v_mfma_f32_32x32x16_bf16 v[208:223], v[112:115], v[52:55], v[208:223]
    buffer_load_dwordx4 v[112:115], v44, s[8:11], s43 offen offset:0
    ds_read_b128 v[48:51], v46 offset:448
    ds_read_b128 v[52:55], v46 offset:41920
    s_waitcnt vmcnt(19) lgkmcnt(2)
    v_mfma_f32_32x32x16_bf16 v[192:207], v[116:119], v[56:59], v[192:207]
    v_mfma_f32_32x32x16_bf16 v[208:223], v[116:119], v[60:63], v[208:223]
    buffer_load_dwordx4 v[116:119], v44, s[8:11], s43 offen offset:1024
    ds_read_b128 v[56:59], v46 offset:480
    ds_read_b128 v[60:63], v46 offset:41952
    s_waitcnt vmcnt(19) lgkmcnt(2)
    v_mfma_f32_32x32x16_bf16 v[192:207], v[120:123], v[48:51], v[192:207]
    v_mfma_f32_32x32x16_bf16 v[208:223], v[120:123], v[52:55], v[208:223]
    buffer_load_dwordx4 v[120:123], v44, s[8:11], s43 offen offset:2048
    ds_read_b128 v[48:51], v46 offset:512
    ds_read_b128 v[52:55], v46 offset:41984
    s_waitcnt vmcnt(19) lgkmcnt(2)
    v_mfma_f32_32x32x16_bf16 v[192:207], v[124:127], v[56:59], v[192:207]
    v_mfma_f32_32x32x16_bf16 v[208:223], v[124:127], v[60:63], v[208:223]
    buffer_load_dwordx4 v[124:127], v44, s[8:11], s43 offen offset:3072
    ds_read_b128 v[56:59], v46 offset:544
    ds_read_b128 v[60:63], v46 offset:42016
    s_waitcnt vmcnt(19) lgkmcnt(2)
    v_mfma_f32_32x32x16_bf16 v[192:207], v[128:131], v[48:51], v[192:207]
    v_mfma_f32_32x32x16_bf16 v[208:223], v[128:131], v[52:55], v[208:223]
    buffer_load_dwordx4 v[128:131], v44, s[8:11], s44 offen offset:0
    ds_read_b128 v[48:51], v46 offset:576
    ds_read_b128 v[52:55], v46 offset:42048
    s_waitcnt vmcnt(19) lgkmcnt(2)
    v_mfma_f32_32x32x16_bf16 v[192:207], v[132:135], v[56:59], v[192:207]
    v_mfma_f32_32x32x16_bf16 v[208:223], v[132:135], v[60:63], v[208:223]
    buffer_load_dwordx4 v[132:135], v44, s[8:11], s44 offen offset:1024
    ds_read_b128 v[56:59], v46 offset:608
    ds_read_b128 v[60:63], v46 offset:42080
    s_waitcnt vmcnt(19) lgkmcnt(2)
    v_mfma_f32_32x32x16_bf16 v[192:207], v[136:139], v[48:51], v[192:207]
    v_mfma_f32_32x32x16_bf16 v[208:223], v[136:139], v[52:55], v[208:223]
    buffer_load_dwordx4 v[136:139], v44, s[8:11], s44 offen offset:2048
    ds_read_b128 v[48:51], v46 offset:640
    ds_read_b128 v[52:55], v46 offset:42112
    s_waitcnt vmcnt(19) lgkmcnt(2)
    v_mfma_f32_32x32x16_bf16 v[192:207], v[140:143], v[56:59], v[192:207]
    v_mfma_f32_32x32x16_bf16 v[208:223], v[140:143], v[60:63], v[208:223]
    buffer_load_dwordx4 v[140:143], v44, s[8:11], s44 offen offset:3072
    s_add_u32 s40, s40, 20480
    s_add_u32 s41, s41, 20480
    s_add_u32 s42, s42, 20480
    s_add_u32 s43, s43, 20480
    s_add_u32 s44, s44, 20480
    v_add_u32 v46, 640, v46
    s_sub_u32 s48, s48, 1
    s_cmp_lg_u32 s48, 0
    s_cbranch_scc1 gl_k2b_kernel
    s_waitcnt vmcnt(0) lgkmcnt(0)
    s_nop 15
    s_lshl_b32 s37, s37, 5
    s_mov_b32 s30, 23281664
    s_mov_b32 s31, 25903104
    v_add_u32 v6, s34, v2
    v_add_u32 v6, 0, v6
    v_mul_u32_u24 v6, 1280, v6
    v_lshl_add_u32 v6, v3, 3, v6
    v_mov_b32 v7, s37
    v_lshl_add_u32 v6, v7, 1, v6
    buffer_load_dwordx2 v[8:9], v6, s[8:11], s30 offen offset:0
    buffer_load_dwordx2 v[10:11], v6, s[8:11], s30 offen offset:16
    buffer_load_dwordx2 v[12:13], v6, s[8:11], s30 offen offset:32
    buffer_load_dwordx2 v[14:15], v6, s[8:11], s30 offen offset:48
    s_waitcnt vmcnt(0)
    v_lshlrev_b32 v7, 16, v8
    v_add_f32 v192, v192, v7
    v_and_b32 v7, 0xffff0000, v8
    v_add_f32 v193, v193, v7
    v_cvt_pk_bf16_f32 v8, v192, v193
    v_lshlrev_b32 v7, 16, v9
    v_add_f32 v194, v194, v7
    v_and_b32 v7, 0xffff0000, v9
    v_add_f32 v195, v195, v7
    v_cvt_pk_bf16_f32 v9, v194, v195
    buffer_store_dwordx2 v[8:9], v6, s[8:11], s31 offen offset:0
    v_lshlrev_b32 v7, 16, v10
    v_add_f32 v196, v196, v7
    v_and_b32 v7, 0xffff0000, v10
    v_add_f32 v197, v197, v7
    v_cvt_pk_bf16_f32 v10, v196, v197
    v_lshlrev_b32 v7, 16, v11
    v_add_f32 v198, v198, v7
    v_and_b32 v7, 0xffff0000, v11
    v_add_f32 v199, v199, v7
    v_cvt_pk_bf16_f32 v11, v198, v199
    buffer_store_dwordx2 v[10:11], v6, s[8:11], s31 offen offset:16
    v_lshlrev_b32 v7, 16, v12
    v_add_f32 v200, v200, v7
    v_and_b32 v7, 0xffff0000, v12
    v_add_f32 v201, v201, v7
    v_cvt_pk_bf16_f32 v12, v200, v201
    v_lshlrev_b32 v7, 16, v13
    v_add_f32 v202, v202, v7
    v_and_b32 v7, 0xffff0000, v13
    v_add_f32 v203, v203, v7
    v_cvt_pk_bf16_f32 v13, v202, v203
    buffer_store_dwordx2 v[12:13], v6, s[8:11], s31 offen offset:32
    v_lshlrev_b32 v7, 16, v14
    v_add_f32 v204, v204, v7
    v_and_b32 v7, 0xffff0000, v14
    v_add_f32 v205, v205, v7
    v_cvt_pk_bf16_f32 v14, v204, v205
    v_lshlrev_b32 v7, 16, v15
    v_add_f32 v206, v206, v7
    v_and_b32 v7, 0xffff0000, v15
    v_add_f32 v207, v207, v7
    v_cvt_pk_bf16_f32 v15, v206, v207
    buffer_store_dwordx2 v[14:15], v6, s[8:11], s31 offen offset:48
    v_add_u32 v6, s34, v2
    v_add_u32 v6, 32, v6
    v_mul_u32_u24 v6, 1280, v6
    v_lshl_add_u32 v6, v3, 3, v6
    v_mov_b32 v7, s37
    v_lshl_add_u32 v6, v7, 1, v6
    buffer_load_dwordx2 v[8:9], v6, s[8:11], s30 offen offset:0
    buffer_load_dwordx2 v[10:11], v6, s[8:11], s30 offen offset:16
    buffer_load_dwordx2 v[12:13], v6, s[8:11], s30 offen offset:32
    buffer_load_dwordx2 v[14:15], v6, s[8:11], s30 offen offset:48
    s_waitcnt vmcnt(0)
    v_lshlrev_b32 v7, 16, v8
    v_add_f32 v208, v208, v7
    v_and_b32 v7, 0xffff0000, v8
    v_add_f32 v209, v209, v7
    v_cvt_pk_bf16_f32 v8, v208, v209
    v_lshlrev_b32 v7, 16, v9
    v_add_f32 v210, v210, v7
    v_and_b32 v7, 0xffff0000, v9
    v_add_f32 v211, v211, v7
    v_cvt_pk_bf16_f32 v9, v210, v211
    buffer_store_dwordx2 v[8:9], v6, s[8:11], s31 offen offset:0
    v_lshlrev_b32 v7, 16, v10
    v_add_f32 v212, v212, v7
    v_and_b32 v7, 0xffff0000, v10
    v_add_f32 v213, v213, v7
    v_cvt_pk_bf16_f32 v10, v212, v213
    v_lshlrev_b32 v7, 16, v11
    v_add_f32 v214, v214, v7
    v_and_b32 v7, 0xffff0000, v11
    v_add_f32 v215, v215, v7
    v_cvt_pk_bf16_f32 v11, v214, v215
    buffer_store_dwordx2 v[10:11], v6, s[8:11], s31 offen offset:16
    v_lshlrev_b32 v7, 16, v12
    v_add_f32 v216, v216, v7
    v_and_b32 v7, 0xffff0000, v12
    v_add_f32 v217, v217, v7
    v_cvt_pk_bf16_f32 v12, v216, v217
    v_lshlrev_b32 v7, 16, v13
    v_add_f32 v218, v218, v7
    v_and_b32 v7, 0xffff0000, v13
    v_add_f32 v219, v219, v7
    v_cvt_pk_bf16_f32 v13, v218, v219
    buffer_store_dwordx2 v[12:13], v6, s[8:11], s31 offen offset:32
    v_lshlrev_b32 v7, 16, v14
    v_add_f32 v220, v220, v7
    v_and_b32 v7, 0xffff0000, v14
    v_add_f32 v221, v221, v7
    v_cvt_pk_bf16_f32 v14, v220, v221
    v_lshlrev_b32 v7, 16, v15
    v_add_f32 v222, v222, v7
    v_and_b32 v7, 0xffff0000, v15
    v_add_f32 v223, v223, v7
    v_cvt_pk_bf16_f32 v15, v222, v223
    buffer_store_dwordx2 v[14:15], v6, s[8:11], s31 offen offset:48
k2b_kernel_end:
    s_endpgm
.p2align 8
.globl k3b_kernel
.type k3b_kernel,@function
k3b_kernel:
    s_cmp_ge_u32 s2, 448
    s_cbranch_scc1 k3b_kernel_end
    s_load_dwordx2 s[4:5], s[0:1], 80
    s_load_dwordx2 s[6:7], s[0:1], 64
    s_load_dwordx2 s[20:21], s[0:1], 0
    s_waitcnt lgkmcnt(0)
    s_mov_b32 s8, s4
    s_and_b32 s9, s5, 0xffff
    s_mov_b32 s10, 268435456
    s_mov_b32 s11, 0x20000
    s_mov_b32 s12, s6
    s_and_b32 s13, s7, 0xffff
    s_mov_b32 s14, 2621440
    s_mov_b32 s15, 0x20000
    s_mov_b32 s16, s20
    s_and_b32 s17, s21, 0xffff
    s_mov_b32 s18, 2621440
    s_mov_b32 s19, 0x20000
    v_lshrrev_b32 v1, 6, v0
    s_nop 0
    v_readfirstlane_b32 s32, v1
    v_and_b32 v2, 31, v0
    v_bfe_u32 v3, v0, 5, 1
    v_and_b32 v4, 63, v0
    v_lshlrev_b32 v5, 4, v4
    s_mul_hi_u32 s33, s2, 0x92492493
    s_lshr_b32 s33, s33, 3
    s_mul_i32 s35, s33, 14
    s_sub_u32 s35, s2, s35
    s_lshl_b32 s34, s33, 6
    v_lshrrev_b32 v6, 2, v0
    v_and_b32 v7, 3, v0
    v_add_u32 v8, s34, v6
    v_mul_u32_u24 v8, 1280, v8
    v_lshl_add_u32 v8, v7, 4, v8
    s_mov_b32 s30, 25903104
    buffer_load_dwordx4 v[16:19], v8, s[8:11], s30 offen offset:0
    buffer_load_dwordx4 v[20:23], v8, s[8:11], s30 offen offset:64
    buffer_load_dwordx4 v[24:27], v8, s[8:11], s30 offen offset:128
    buffer_load_dwordx4 v[28:31], v8, s[8:11], s30 offen offset:192
    buffer_load_dwordx4 v[32:35], v8, s[8:11], s30 offen offset:256
    buffer_load_dwordx4 v[36:39], v8, s[8:11], s30 offen offset:320
    buffer_load_dwordx4 v[40:43], v8, s[8:11], s30 offen offset:384
    buffer_load_dwordx4 v[44:47], v8, s[8:11], s30 offen offset:448
    buffer_load_dwordx4 v[48:51], v8, s[8:11], s30 offen offset:512
    buffer_load_dwordx4 v[52:55], v8, s[8:11], s30 offen offset:576
    buffer_load_dwordx4 v[56:59], v8, s[8:11], s30 offen offset:640
    buffer_load_dwordx4 v[60:63], v8, s[8:11], s30 offen offset:704
    buffer_load_dwordx4 v[64:67], v8, s[8:11], s30 offen offset:768
    buffer_load_dwordx4 v[68:71], v8, s[8:11], s30 offen offset:832
    buffer_load_dwordx4 v[72:75], v8, s[8:11], s30 offen offset:896
    buffer_load_dwordx4 v[76:79], v8, s[8:11], s30 offen offset:960
    buffer_load_dwordx4 v[80:83], v8, s[8:11], s30 offen offset:1024
    buffer_load_dwordx4 v[84:87], v8, s[8:11], s30 offen offset:1088
    buffer_load_dwordx4 v[88:91], v8, s[8:11], s30 offen offset:1152
    buffer_load_dwordx4 v[92:95], v8, s[8:11], s30 offen offset:1216
    v_mul_u32_u24 v9, 1296, v6
    v_lshl_add_u32 v9, v7, 4, v9
    v_mov_b32 v10, 0
    v_mov_b32 v11, 0
    v_mov_b32 v12, 0x3f803f80
    s_waitcnt vmcnt(0)
    v_dot2c_f32_bf16 v10, v16, v12
    v_dot2c_f32_bf16 v11, v16, v16
    v_dot2c_f32_bf16 v10, v17, v12
    v_dot2c_f32_bf16 v11, v17, v17
    v_dot2c_f32_bf16 v10, v18, v12
    v_dot2c_f32_bf16 v11, v18, v18
    v_dot2c_f32_bf16 v10, v19, v12
    v_dot2c_f32_bf16 v11, v19, v19
    v_dot2c_f32_bf16 v10, v20, v12
    v_dot2c_f32_bf16 v11, v20, v20
    v_dot2c_f32_bf16 v10, v21, v12
    v_dot2c_f32_bf16 v11, v21, v21
    v_dot2c_f32_bf16 v10, v22, v12
    v_dot2c_f32_bf16 v11, v22, v22
    v_dot2c_f32_bf16 v10, v23, v12
    v_dot2c_f32_bf16 v11, v23, v23
    v_dot2c_f32_bf16 v10, v24, v12
    v_dot2c_f32_bf16 v11, v24, v24
    v_dot2c_f32_bf16 v10, v25, v12
    v_dot2c_f32_bf16 v11, v25, v25
    v_dot2c_f32_bf16 v10, v26, v12
    v_dot2c_f32_bf16 v11, v26, v26
    v_dot2c_f32_bf16 v10, v27, v12
    v_dot2c_f32_bf16 v11, v27, v27
    v_dot2c_f32_bf16 v10, v28, v12
    v_dot2c_f32_bf16 v11, v28, v28
    v_dot2c_f32_bf16 v10, v29, v12
    v_dot2c_f32_bf16 v11, v29, v29
    v_dot2c_f32_bf16 v10, v30, v12
    v_dot2c_f32_bf16 v11, v30, v30
    v_dot2c_f32_bf16 v10, v31, v12
    v_dot2c_f32_bf16 v11, v31, v31
    v_dot2c_f32_bf16 v10, v32, v12
    v_dot2c_f32_bf16 v11, v32, v32
    v_dot2c_f32_bf16 v10, v33, v12
    v_dot2c_f32_bf16 v11, v33, v33
    v_dot2c_f32_bf16 v10, v34, v12
    v_dot2c_f32_bf16 v11, v34, v34
    v_dot2c_f32_bf16 v10, v35, v12
    v_dot2c_f32_bf16 v11, v35, v35
    v_dot2c_f32_bf16 v10, v36, v12
    v_dot2c_f32_bf16 v11, v36, v36
    v_dot2c_f32_bf16 v10, v37, v12
    v_dot2c_f32_bf16 v11, v37, v37
    v_dot2c_f32_bf16 v10, v38, v12
    v_dot2c_f32_bf16 v11, v38, v38
    v_dot2c_f32_bf16 v10, v39, v12
    v_dot2c_f32_bf16 v11, v39, v39
    v_dot2c_f32_bf16 v10, v40, v12
    v_dot2c_f32_bf16 v11, v40, v40
    v_dot2c_f32_bf16 v10, v41, v12
    v_dot2c_f32_bf16 v11, v41, v41
    v_dot2c_f32_bf16 v10, v42, v12
    v_dot2c_f32_bf16 v11, v42, v42
    v_dot2c_f32_bf16 v10, v43, v12
    v_dot2c_f32_bf16 v11, v43, v43
    v_dot2c_f32_bf16 v10, v44, v12
    v_dot2c_f32_bf16 v11, v44, v44
    v_dot2c_f32_bf16 v10, v45, v12
    v_dot2c_f32_bf16 v11, v45, v45
    v_dot2c_f32_bf16 v10, v46, v12
    v_dot2c_f32_bf16 v11, v46, v46
    v_dot2c_f32_bf16 v10, v47, v12
    v_dot2c_f32_bf16 v11, v47, v47
    v_dot2c_f32_bf16 v10, v48, v12
    v_dot2c_f32_bf16 v11, v48, v48
    v_dot2c_f32_bf16 v10, v49, v12
    v_dot2c_f32_bf16 v11, v49, v49
    v_dot2c_f32_bf16 v10, v50, v12
    v_dot2c_f32_bf16 v11, v50, v50
    v_dot2c_f32_bf16 v10, v51, v12
    v_dot2c_f32_bf16 v11, v51, v51
    v_dot2c_f32_bf16 v10, v52, v12
    v_dot2c_f32_bf16 v11, v52, v52
    v_dot2c_f32_bf16 v10, v53, v12
    v_dot2c_f32_bf16 v11, v53, v53
    v_dot2c_f32_bf16 v10, v54, v12
    v_dot2c_f32_bf16 v11, v54, v54
    v_dot2c_f32_bf16 v10, v55, v12
    v_dot2c_f32_bf16 v11, v55, v55
    v_dot2c_f32_bf16 v10, v56, v12
    v_dot2c_f32_bf16 v11, v56, v56
    v_dot2c_f32_bf16 v10, v57, v12
    v_dot2c_f32_bf16 v11, v57, v57
    v_dot2c_f32_bf16 v10, v58, v12
    v_dot2c_f32_bf16 v11, v58, v58
    v_dot2c_f32_bf16 v10, v59, v12
    v_dot2c_f32_bf16 v11, v59, v59
    v_dot2c_f32_bf16 v10, v60, v12
    v_dot2c_f32_bf16 v11, v60, v60
    v_dot2c_f32_bf16 v10, v61, v12
    v_dot2c_f32_bf16 v11, v61, v61
    v_dot2c_f32_bf16 v10, v62, v12
    v_dot2c_f32_bf16 v11, v62, v62
    v_dot2c_f32_bf16 v10, v63, v12
    v_dot2c_f32_bf16 v11, v63, v63
    v_dot2c_f32_bf16 v10, v64, v12
    v_dot2c_f32_bf16 v11, v64, v64
    v_dot2c_f32_bf16 v10, v65, v12
    v_dot2c_f32_bf16 v11, v65, v65
    v_dot2c_f32_bf16 v10, v66, v12
    v_dot2c_f32_bf16 v11, v66, v66
    v_dot2c_f32_bf16 v10, v67, v12
    v_dot2c_f32_bf16 v11, v67, v67
    v_dot2c_f32_bf16 v10, v68, v12
    v_dot2c_f32_bf16 v11, v68, v68
    v_dot2c_f32_bf16 v10, v69, v12
    v_dot2c_f32_bf16 v11, v69, v69
    v_dot2c_f32_bf16 v10, v70, v12
    v_dot2c_f32_bf16 v11, v70, v70
    v_dot2c_f32_bf16 v10, v71, v12
    v_dot2c_f32_bf16 v11, v71, v71
    v_dot2c_f32_bf16 v10, v72, v12
    v_dot2c_f32_bf16 v11, v72, v72
    v_dot2c_f32_bf16 v10, v73, v12
    v_dot2c_f32_bf16 v11, v73, v73
    v_dot2c_f32_bf16 v10, v74, v12
    v_dot2c_f32_bf16 v11, v74, v74
    v_dot2c_f32_bf16 v10, v75, v12
    v_dot2c_f32_bf16 v11, v75, v75
    v_dot2c_f32_bf16 v10, v76, v12
    v_dot2c_f32_bf16 v11, v76, v76
    v_dot2c_f32_bf16 v10, v77, v12
    v_dot2c_f32_bf16 v11, v77, v77
    v_dot2c_f32_bf16 v10, v78, v12
    v_dot2c_f32_bf16 v11, v78, v78
    v_dot2c_f32_bf16 v10, v79, v12
    v_dot2c_f32_bf16 v11, v79, v79
    v_dot2c_f32_bf16 v10, v80, v12
    v_dot2c_f32_bf16 v11, v80, v80
    v_dot2c_f32_bf16 v10, v81, v12
    v_dot2c_f32_bf16 v11, v81, v81
    v_dot2c_f32_bf16 v10, v82, v12
    v_dot2c_f32_bf16 v11, v82, v82
    v_dot2c_f32_bf16 v10, v83, v12
    v_dot2c_f32_bf16 v11, v83, v83
    v_dot2c_f32_bf16 v10, v84, v12
    v_dot2c_f32_bf16 v11, v84, v84
    v_dot2c_f32_bf16 v10, v85, v12
    v_dot2c_f32_bf16 v11, v85, v85
    v_dot2c_f32_bf16 v10, v86, v12
    v_dot2c_f32_bf16 v11, v86, v86
    v_dot2c_f32_bf16 v10, v87, v12
    v_dot2c_f32_bf16 v11, v87, v87
    v_dot2c_f32_bf16 v10, v88, v12
    v_dot2c_f32_bf16 v11, v88, v88
    v_dot2c_f32_bf16 v10, v89, v12
    v_dot2c_f32_bf16 v11, v89, v89
    v_dot2c_f32_bf16 v10, v90, v12
    v_dot2c_f32_bf16 v11, v90, v90
    v_dot2c_f32_bf16 v10, v91, v12
    v_dot2c_f32_bf16 v11, v91, v91
    v_dot2c_f32_bf16 v10, v92, v12
    v_dot2c_f32_bf16 v11, v92, v92
    v_dot2c_f32_bf16 v10, v93, v12
    v_dot2c_f32_bf16 v11, v93, v93
    v_dot2c_f32_bf16 v10, v94, v12
    v_dot2c_f32_bf16 v11, v94, v94
    v_dot2c_f32_bf16 v10, v95, v12
    v_dot2c_f32_bf16 v11, v95, v95
    s_nop 3
    v_add_f32_dpp v10, v10, v10 quad_perm:[1,0,3,2] row_mask:0xf bank_mask:0xf
    v_add_f32_dpp v11, v11, v11 quad_perm:[1,0,3,2] row_mask:0xf bank_mask:0xf
    s_nop 1
    v_add_f32_dpp v10, v10, v10 quad_perm:[2,3,0,1] row_mask:0xf bank_mask:0xf
    v_add_f32_dpp v11, v11, v11 quad_perm:[2,3,0,1] row_mask:0xf bank_mask:0xf
    s_nop 1
    v_mul_f32 v10, 0x3acccccd, v10
    v_mul_f32 v11, 0x3acccccd, v11
    v_fma_f32 v11, -v10, v10, v11
    v_max_f32 v11, 0, v11
    v_mov_b32 v14, 0x3727c5ac
    v_add_f32 v14, v14, v11
    v_rsq_f32 v14, v14
    s_nop 0
    v_mul_f32 v15, v10, v14
    v_lshlrev_b32 v12, 16, v16
    v_and_b32 v13, 0xffff0000, v16
    v_fma_f32 v12, v12, v14, -v15
    v_fma_f32 v13, v13, v14, -v15
    v_cvt_pk_bf16_f32 v16, v12, v13
    v_lshlrev_b32 v12, 16, v17
    v_and_b32 v13, 0xffff0000, v17
    v_fma_f32 v12, v12, v14, -v15
    v_fma_f32 v13, v13, v14, -v15
    v_cvt_pk_bf16_f32 v17, v12, v13
    v_lshlrev_b32 v12, 16, v18
    v_and_b32 v13, 0xffff0000, v18
    v_fma_f32 v12, v12, v14, -v15
    v_fma_f32 v13, v13, v14, -v15
    v_cvt_pk_bf16_f32 v18, v12, v13
    v_lshlrev_b32 v12, 16, v19
    v_and_b32 v13, 0xffff0000, v19
    v_fma_f32 v12, v12, v14, -v15
    v_fma_f32 v13, v13, v14, -v15
    v_cvt_pk_bf16_f32 v19, v12, v13
    v_lshlrev_b32 v12, 16, v20
    v_and_b32 v13, 0xffff0000, v20
    v_fma_f32 v12, v12, v14, -v15
    v_fma_f32 v13, v13, v14, -v15
    v_cvt_pk_bf16_f32 v20, v12, v13
    v_lshlrev_b32 v12, 16, v21
    v_and_b32 v13, 0xffff0000, v21
    v_fma_f32 v12, v12, v14, -v15
    v_fma_f32 v13, v13, v14, -v15
    v_cvt_pk_bf16_f32 v21, v12, v13
    v_lshlrev_b32 v12, 16, v22
    v_and_b32 v13, 0xffff0000, v22
    v_fma_f32 v12, v12, v14, -v15
    v_fma_f32 v13, v13, v14, -v15
    v_cvt_pk_bf16_f32 v22, v12, v13
    v_lshlrev_b32 v12, 16, v23
    v_and_b32 v13, 0xffff0000, v23
    v_fma_f32 v12, v12, v14, -v15
    v_fma_f32 v13, v13, v14, -v15
    v_cvt_pk_bf16_f32 v23, v12, v13
    v_lshlrev_b32 v12, 16, v24
    v_and_b32 v13, 0xffff0000, v24
    v_fma_f32 v12, v12, v14, -v15
    v_fma_f32 v13, v13, v14, -v15
    v_cvt_pk_bf16_f32 v24, v12, v13
    v_lshlrev_b32 v12, 16, v25
    v_and_b32 v13, 0xffff0000, v25
    v_fma_f32 v12, v12, v14, -v15
    v_fma_f32 v13, v13, v14, -v15
    v_cvt_pk_bf16_f32 v25, v12, v13
    v_lshlrev_b32 v12, 16, v26
    v_and_b32 v13, 0xffff0000, v26
    v_fma_f32 v12, v12, v14, -v15
    v_fma_f32 v13, v13, v14, -v15
    v_cvt_pk_bf16_f32 v26, v12, v13
    v_lshlrev_b32 v12, 16, v27
    v_and_b32 v13, 0xffff0000, v27
    v_fma_f32 v12, v12, v14, -v15
    v_fma_f32 v13, v13, v14, -v15
    v_cvt_pk_bf16_f32 v27, v12, v13
    v_lshlrev_b32 v12, 16, v28
    v_and_b32 v13, 0xffff0000, v28
    v_fma_f32 v12, v12, v14, -v15
    v_fma_f32 v13, v13, v14, -v15
    v_cvt_pk_bf16_f32 v28, v12, v13
    v_lshlrev_b32 v12, 16, v29
    v_and_b32 v13, 0xffff0000, v29
    v_fma_f32 v12, v12, v14, -v15
    v_fma_f32 v13, v13, v14, -v15
    v_cvt_pk_bf16_f32 v29, v12, v13
    v_lshlrev_b32 v12, 16, v30
    v_and_b32 v13, 0xffff0000, v30
    v_fma_f32 v12, v12, v14, -v15
    v_fma_f32 v13, v13, v14, -v15
    v_cvt_pk_bf16_f32 v30, v12, v13
    v_lshlrev_b32 v12, 16, v31
    v_and_b32 v13, 0xffff0000, v31
    v_fma_f32 v12, v12, v14, -v15
    v_fma_f32 v13, v13, v14, -v15
    v_cvt_pk_bf16_f32 v31, v12, v13
    v_lshlrev_b32 v12, 16, v32
    v_and_b32 v13, 0xffff0000, v32
    v_fma_f32 v12, v12, v14, -v15
    v_fma_f32 v13, v13, v14, -v15
    v_cvt_pk_bf16_f32 v32, v12, v13
    v_lshlrev_b32 v12, 16, v33
    v_and_b32 v13, 0xffff0000, v33
    v_fma_f32 v12, v12, v14, -v15
    v_fma_f32 v13, v13, v14, -v15
    v_cvt_pk_bf16_f32 v33, v12, v13
    v_lshlrev_b32 v12, 16, v34
    v_and_b32 v13, 0xffff0000, v34
    v_fma_f32 v12, v12, v14, -v15
    v_fma_f32 v13, v13, v14, -v15
    v_cvt_pk_bf16_f32 v34, v12, v13
    v_lshlrev_b32 v12, 16, v35
    v_and_b32 v13, 0xffff0000, v35
    v_fma_f32 v12, v12, v14, -v15
    v_fma_f32 v13, v13, v14, -v15
    v_cvt_pk_bf16_f32 v35, v12, v13
    v_lshlrev_b32 v12, 16, v36
    v_and_b32 v13, 0xffff0000, v36
    v_fma_f32 v12, v12, v14, -v15
    v_fma_f32 v13, v13, v14, -v15
    v_cvt_pk_bf16_f32 v36, v12, v13
    v_lshlrev_b32 v12, 16, v37
    v_and_b32 v13, 0xffff0000, v37
    v_fma_f32 v12, v12, v14, -v15
    v_fma_f32 v13, v13, v14, -v15
    v_cvt_pk_bf16_f32 v37, v12, v13
    v_lshlrev_b32 v12, 16, v38
    v_and_b32 v13, 0xffff0000, v38
    v_fma_f32 v12, v12, v14, -v15
    v_fma_f32 v13, v13, v14, -v15
    v_cvt_pk_bf16_f32 v38, v12, v13
    v_lshlrev_b32 v12, 16, v39
    v_and_b32 v13, 0xffff0000, v39
    v_fma_f32 v12, v12, v14, -v15
    v_fma_f32 v13, v13, v14, -v15
    v_cvt_pk_bf16_f32 v39, v12, v13
    v_lshlrev_b32 v12, 16, v40
    v_and_b32 v13, 0xffff0000, v40
    v_fma_f32 v12, v12, v14, -v15
    v_fma_f32 v13, v13, v14, -v15
    v_cvt_pk_bf16_f32 v40, v12, v13
    v_lshlrev_b32 v12, 16, v41
    v_and_b32 v13, 0xffff0000, v41
    v_fma_f32 v12, v12, v14, -v15
    v_fma_f32 v13, v13, v14, -v15
    v_cvt_pk_bf16_f32 v41, v12, v13
    v_lshlrev_b32 v12, 16, v42
    v_and_b32 v13, 0xffff0000, v42
    v_fma_f32 v12, v12, v14, -v15
    v_fma_f32 v13, v13, v14, -v15
    v_cvt_pk_bf16_f32 v42, v12, v13
    v_lshlrev_b32 v12, 16, v43
    v_and_b32 v13, 0xffff0000, v43
    v_fma_f32 v12, v12, v14, -v15
    v_fma_f32 v13, v13, v14, -v15
    v_cvt_pk_bf16_f32 v43, v12, v13
    v_lshlrev_b32 v12, 16, v44
    v_and_b32 v13, 0xffff0000, v44
    v_fma_f32 v12, v12, v14, -v15
    v_fma_f32 v13, v13, v14, -v15
    v_cvt_pk_bf16_f32 v44, v12, v13
    v_lshlrev_b32 v12, 16, v45
    v_and_b32 v13, 0xffff0000, v45
    v_fma_f32 v12, v12, v14, -v15
    v_fma_f32 v13, v13, v14, -v15
    v_cvt_pk_bf16_f32 v45, v12, v13
    v_lshlrev_b32 v12, 16, v46
    v_and_b32 v13, 0xffff0000, v46
    v_fma_f32 v12, v12, v14, -v15
    v_fma_f32 v13, v13, v14, -v15
    v_cvt_pk_bf16_f32 v46, v12, v13
    v_lshlrev_b32 v12, 16, v47
    v_and_b32 v13, 0xffff0000, v47
    v_fma_f32 v12, v12, v14, -v15
    v_fma_f32 v13, v13, v14, -v15
    v_cvt_pk_bf16_f32 v47, v12, v13
    v_lshlrev_b32 v12, 16, v48
    v_and_b32 v13, 0xffff0000, v48
    v_fma_f32 v12, v12, v14, -v15
    v_fma_f32 v13, v13, v14, -v15
    v_cvt_pk_bf16_f32 v48, v12, v13
    v_lshlrev_b32 v12, 16, v49
    v_and_b32 v13, 0xffff0000, v49
    v_fma_f32 v12, v12, v14, -v15
    v_fma_f32 v13, v13, v14, -v15
    v_cvt_pk_bf16_f32 v49, v12, v13
    v_lshlrev_b32 v12, 16, v50
    v_and_b32 v13, 0xffff0000, v50
    v_fma_f32 v12, v12, v14, -v15
    v_fma_f32 v13, v13, v14, -v15
    v_cvt_pk_bf16_f32 v50, v12, v13
    v_lshlrev_b32 v12, 16, v51
    v_and_b32 v13, 0xffff0000, v51
    v_fma_f32 v12, v12, v14, -v15
    v_fma_f32 v13, v13, v14, -v15
    v_cvt_pk_bf16_f32 v51, v12, v13
    v_lshlrev_b32 v12, 16, v52
    v_and_b32 v13, 0xffff0000, v52
    v_fma_f32 v12, v12, v14, -v15
    v_fma_f32 v13, v13, v14, -v15
    v_cvt_pk_bf16_f32 v52, v12, v13
    v_lshlrev_b32 v12, 16, v53
    v_and_b32 v13, 0xffff0000, v53
    v_fma_f32 v12, v12, v14, -v15
    v_fma_f32 v13, v13, v14, -v15
    v_cvt_pk_bf16_f32 v53, v12, v13
    v_lshlrev_b32 v12, 16, v54
    v_and_b32 v13, 0xffff0000, v54
    v_fma_f32 v12, v12, v14, -v15
    v_fma_f32 v13, v13, v14, -v15
    v_cvt_pk_bf16_f32 v54, v12, v13
    v_lshlrev_b32 v12, 16, v55
    v_and_b32 v13, 0xffff0000, v55
    v_fma_f32 v12, v12, v14, -v15
    v_fma_f32 v13, v13, v14, -v15
    v_cvt_pk_bf16_f32 v55, v12, v13
    v_lshlrev_b32 v12, 16, v56
    v_and_b32 v13, 0xffff0000, v56
    v_fma_f32 v12, v12, v14, -v15
    v_fma_f32 v13, v13, v14, -v15
    v_cvt_pk_bf16_f32 v56, v12, v13
    v_lshlrev_b32 v12, 16, v57
    v_and_b32 v13, 0xffff0000, v57
    v_fma_f32 v12, v12, v14, -v15
    v_fma_f32 v13, v13, v14, -v15
    v_cvt_pk_bf16_f32 v57, v12, v13
    v_lshlrev_b32 v12, 16, v58
    v_and_b32 v13, 0xffff0000, v58
    v_fma_f32 v12, v12, v14, -v15
    v_fma_f32 v13, v13, v14, -v15
    v_cvt_pk_bf16_f32 v58, v12, v13
    v_lshlrev_b32 v12, 16, v59
    v_and_b32 v13, 0xffff0000, v59
    v_fma_f32 v12, v12, v14, -v15
    v_fma_f32 v13, v13, v14, -v15
    v_cvt_pk_bf16_f32 v59, v12, v13
    v_lshlrev_b32 v12, 16, v60
    v_and_b32 v13, 0xffff0000, v60
    v_fma_f32 v12, v12, v14, -v15
    v_fma_f32 v13, v13, v14, -v15
    v_cvt_pk_bf16_f32 v60, v12, v13
    v_lshlrev_b32 v12, 16, v61
    v_and_b32 v13, 0xffff0000, v61
    v_fma_f32 v12, v12, v14, -v15
    v_fma_f32 v13, v13, v14, -v15
    v_cvt_pk_bf16_f32 v61, v12, v13
    v_lshlrev_b32 v12, 16, v62
    v_and_b32 v13, 0xffff0000, v62
    v_fma_f32 v12, v12, v14, -v15
    v_fma_f32 v13, v13, v14, -v15
    v_cvt_pk_bf16_f32 v62, v12, v13
    v_lshlrev_b32 v12, 16, v63
    v_and_b32 v13, 0xffff0000, v63
    v_fma_f32 v12, v12, v14, -v15
    v_fma_f32 v13, v13, v14, -v15
    v_cvt_pk_bf16_f32 v63, v12, v13
    v_lshlrev_b32 v12, 16, v64
    v_and_b32 v13, 0xffff0000, v64
    v_fma_f32 v12, v12, v14, -v15
    v_fma_f32 v13, v13, v14, -v15
    v_cvt_pk_bf16_f32 v64, v12, v13
    v_lshlrev_b32 v12, 16, v65
    v_and_b32 v13, 0xffff0000, v65
    v_fma_f32 v12, v12, v14, -v15
    v_fma_f32 v13, v13, v14, -v15
    v_cvt_pk_bf16_f32 v65, v12, v13
    v_lshlrev_b32 v12, 16, v66
    v_and_b32 v13, 0xffff0000, v66
    v_fma_f32 v12, v12, v14, -v15
    v_fma_f32 v13, v13, v14, -v15
    v_cvt_pk_bf16_f32 v66, v12, v13
    v_lshlrev_b32 v12, 16, v67
    v_and_b32 v13, 0xffff0000, v67
    v_fma_f32 v12, v12, v14, -v15
    v_fma_f32 v13, v13, v14, -v15
    v_cvt_pk_bf16_f32 v67, v12, v13
    v_lshlrev_b32 v12, 16, v68
    v_and_b32 v13, 0xffff0000, v68
    v_fma_f32 v12, v12, v14, -v15
    v_fma_f32 v13, v13, v14, -v15
    v_cvt_pk_bf16_f32 v68, v12, v13
    v_lshlrev_b32 v12, 16, v69
    v_and_b32 v13, 0xffff0000, v69
    v_fma_f32 v12, v12, v14, -v15
    v_fma_f32 v13, v13, v14, -v15
    v_cvt_pk_bf16_f32 v69, v12, v13
    v_lshlrev_b32 v12, 16, v70
    v_and_b32 v13, 0xffff0000, v70
    v_fma_f32 v12, v12, v14, -v15
    v_fma_f32 v13, v13, v14, -v15
    v_cvt_pk_bf16_f32 v70, v12, v13
    v_lshlrev_b32 v12, 16, v71
    v_and_b32 v13, 0xffff0000, v71
    v_fma_f32 v12, v12, v14, -v15
    v_fma_f32 v13, v13, v14, -v15
    v_cvt_pk_bf16_f32 v71, v12, v13
    v_lshlrev_b32 v12, 16, v72
    v_and_b32 v13, 0xffff0000, v72
    v_fma_f32 v12, v12, v14, -v15
    v_fma_f32 v13, v13, v14, -v15
    v_cvt_pk_bf16_f32 v72, v12, v13
    v_lshlrev_b32 v12, 16, v73
    v_and_b32 v13, 0xffff0000, v73
    v_fma_f32 v12, v12, v14, -v15
    v_fma_f32 v13, v13, v14, -v15
    v_cvt_pk_bf16_f32 v73, v12, v13
    v_lshlrev_b32 v12, 16, v74
    v_and_b32 v13, 0xffff0000, v74
    v_fma_f32 v12, v12, v14, -v15
    v_fma_f32 v13, v13, v14, -v15
    v_cvt_pk_bf16_f32 v74, v12, v13
    v_lshlrev_b32 v12, 16, v75
    v_and_b32 v13, 0xffff0000, v75
    v_fma_f32 v12, v12, v14, -v15
    v_fma_f32 v13, v13, v14, -v15
    v_cvt_pk_bf16_f32 v75, v12, v13
    v_lshlrev_b32 v12, 16, v76
    v_and_b32 v13, 0xffff0000, v76
    v_fma_f32 v12, v12, v14, -v15
    v_fma_f32 v13, v13, v14, -v15
    v_cvt_pk_bf16_f32 v76, v12, v13
    v_lshlrev_b32 v12, 16, v77
    v_and_b32 v13, 0xffff0000, v77
    v_fma_f32 v12, v12, v14, -v15
    v_fma_f32 v13, v13, v14, -v15
    v_cvt_pk_bf16_f32 v77, v12, v13
    v_lshlrev_b32 v12, 16, v78
    v_and_b32 v13, 0xffff0000, v78
    v_fma_f32 v12, v12, v14, -v15
    v_fma_f32 v13, v13, v14, -v15
    v_cvt_pk_bf16_f32 v78, v12, v13
    v_lshlrev_b32 v12, 16, v79
    v_and_b32 v13, 0xffff0000, v79
    v_fma_f32 v12, v12, v14, -v15
    v_fma_f32 v13, v13, v14, -v15
    v_cvt_pk_bf16_f32 v79, v12, v13
    v_lshlrev_b32 v12, 16, v80
    v_and_b32 v13, 0xffff0000, v80
    v_fma_f32 v12, v12, v14, -v15
    v_fma_f32 v13, v13, v14, -v15
    v_cvt_pk_bf16_f32 v80, v12, v13
    v_lshlrev_b32 v12, 16, v81
    v_and_b32 v13, 0xffff0000, v81
    v_fma_f32 v12, v12, v14, -v15
    v_fma_f32 v13, v13, v14, -v15
    v_cvt_pk_bf16_f32 v81, v12, v13
    v_lshlrev_b32 v12, 16, v82
    v_and_b32 v13, 0xffff0000, v82
    v_fma_f32 v12, v12, v14, -v15
    v_fma_f32 v13, v13, v14, -v15
    v_cvt_pk_bf16_f32 v82, v12, v13
    v_lshlrev_b32 v12, 16, v83
    v_and_b32 v13, 0xffff0000, v83
    v_fma_f32 v12, v12, v14, -v15
    v_fma_f32 v13, v13, v14, -v15
    v_cvt_pk_bf16_f32 v83, v12, v13
    v_lshlrev_b32 v12, 16, v84
    v_and_b32 v13, 0xffff0000, v84
    v_fma_f32 v12, v12, v14, -v15
    v_fma_f32 v13, v13, v14, -v15
    v_cvt_pk_bf16_f32 v84, v12, v13
    v_lshlrev_b32 v12, 16, v85
    v_and_b32 v13, 0xffff0000, v85
    v_fma_f32 v12, v12, v14, -v15
    v_fma_f32 v13, v13, v14, -v15
    v_cvt_pk_bf16_f32 v85, v12, v13
    v_lshlrev_b32 v12, 16, v86
    v_and_b32 v13, 0xffff0000, v86
    v_fma_f32 v12, v12, v14, -v15
    v_fma_f32 v13, v13, v14, -v15
    v_cvt_pk_bf16_f32 v86, v12, v13
    v_lshlrev_b32 v12, 16, v87
    v_and_b32 v13, 0xffff0000, v87
    v_fma_f32 v12, v12, v14, -v15
    v_fma_f32 v13, v13, v14, -v15
    v_cvt_pk_bf16_f32 v87, v12, v13
    v_lshlrev_b32 v12, 16, v88
    v_and_b32 v13, 0xffff0000, v88
    v_fma_f32 v12, v12, v14, -v15
    v_fma_f32 v13, v13, v14, -v15
    v_cvt_pk_bf16_f32 v88, v12, v13
    v_lshlrev_b32 v12, 16, v89
    v_and_b32 v13, 0xffff0000, v89
    v_fma_f32 v12, v12, v14, -v15
    v_fma_f32 v13, v13, v14, -v15
    v_cvt_pk_bf16_f32 v89, v12, v13
    v_lshlrev_b32 v12, 16, v90
    v_and_b32 v13, 0xffff0000, v90
    v_fma_f32 v12, v12, v14, -v15
    v_fma_f32 v13, v13, v14, -v15
    v_cvt_pk_bf16_f32 v90, v12, v13
    v_lshlrev_b32 v12, 16, v91
    v_and_b32 v13, 0xffff0000, v91
    v_fma_f32 v12, v12, v14, -v15
    v_fma_f32 v13, v13, v14, -v15
    v_cvt_pk_bf16_f32 v91, v12, v13
    v_lshlrev_b32 v12, 16, v92
    v_and_b32 v13, 0xffff0000, v92
    v_fma_f32 v12, v12, v14, -v15
    v_fma_f32 v13, v13, v14, -v15
    v_cvt_pk_bf16_f32 v92, v12, v13
    v_lshlrev_b32 v12, 16, v93
    v_and_b32 v13, 0xffff0000, v93
    v_fma_f32 v12, v12, v14, -v15
    v_fma_f32 v13, v13, v14, -v15
    v_cvt_pk_bf16_f32 v93, v12, v13
    v_lshlrev_b32 v12, 16, v94
    v_and_b32 v13, 0xffff0000, v94
    v_fma_f32 v12, v12, v14, -v15
    v_fma_f32 v13, v13, v14, -v15
    v_cvt_pk_bf16_f32 v94, v12, v13
    v_lshlrev_b32 v12, 16, v95
    v_and_b32 v13, 0xffff0000, v95
    v_fma_f32 v12, v12, v14, -v15
    v_fma_f32 v13, v13, v14, -v15
    v_cvt_pk_bf16_f32 v95, v12, v13
    ds_write_b128 v9, v[16:19] offset:0
    ds_write_b128 v9, v[20:23] offset:64
    ds_write_b128 v9, v[24:27] offset:128
    ds_write_b128 v9, v[28:31] offset:192
    ds_write_b128 v9, v[32:35] offset:256
    ds_write_b128 v9, v[36:39] offset:320
    ds_write_b128 v9, v[40:43] offset:384
    ds_write_b128 v9, v[44:47] offset:448
    ds_write_b128 v9, v[48:51] offset:512
    ds_write_b128 v9, v[52:55] offset:576
    ds_write_b128 v9, v[56:59] offset:640
    ds_write_b128 v9, v[60:63] offset:704
    ds_write_b128 v9, v[64:67] offset:768
    ds_write_b128 v9, v[68:71] offset:832
    ds_write_b128 v9, v[72:75] offset:896
    ds_write_b128 v9, v[76:79] offset:960
    ds_write_b128 v9, v[80:83] offset:1024
    ds_write_b128 v9, v[84:87] offset:1088
    ds_write_b128 v9, v[88:91] offset:1152
    ds_write_b128 v9, v[92:95] offset:1216
    s_waitcnt lgkmcnt(0)
    s_barrier
    s_lshl_b32 s37, s35, 2
    s_add_u32 s37, s37, s32
    s_cmp_ge_u32 s37, 54
    s_cbranch_scc1 k3b_kernel_end
    s_mul_i32 s36, s37, 81920
    s_add_u32 s36, s36, 3440640
    v_mov_b32 v192, 0
    v_mov_b32 v193, 0
    v_mov_b32 v194, 0
    v_mov_b32 v195, 0
    v_mov_b32 v196, 0
    v_mov_b32 v197, 0
    v_mov_b32 v198, 0
    v_mov_b32 v199, 0
    v_mov_b32 v200, 0
    v_mov_b32 v201, 0
    v_mov_b32 v202, 0
    v_mov_b32 v203, 0
    v_mov_b32 v204, 0
    v_mov_b32 v205, 0
    v_mov_b32 v206, 0
    v_mov_b32 v207, 0
    v_mov_b32 v208, 0
    v_mov_b32 v209, 0
    v_mov_b32 v210, 0
    v_mov_b32 v211, 0
    v_mov_b32 v212, 0
    v_mov_b32 v213, 0
    v_mov_b32 v214, 0
    v_mov_b32 v215, 0
    v_mov_b32 v216, 0
    v_mov_b32 v217, 0
    v_mov_b32 v218, 0
    v_mov_b32 v219, 0
    v_mov_b32 v220, 0
    v_mov_b32 v221, 0
    v_mov_b32 v222, 0
    v_mov_b32 v223, 0
    v_mov_b32 v224, 0
    v_mov_b32 v225, 0
    v_mov_b32 v226, 0
    v_mov_b32 v227, 0
    v_mov_b32 v228, 0
    v_mov_b32 v229, 0
    v_mov_b32 v230, 0
    v_mov_b32 v231, 0
    v_mov_b32 v232, 0
    v_mov_b32 v233, 0
    v_mov_b32 v234, 0
    v_mov_b32 v235, 0
    v_mov_b32 v236, 0
    v_mov_b32 v237, 0
    v_mov_b32 v238, 0
    v_mov_b32 v239, 0
    v_mov_b32 v240, 0
    v_mov_b32 v241, 0
    v_mov_b32 v242, 0
    v_mov_b32 v243, 0
    v_mov_b32 v244, 0
    v_mov_b32 v245, 0
    v_mov_b32 v246, 0
    v_mov_b32 v247, 0
    v_mov_b32 v248, 0
    v_mov_b32 v249, 0
    v_mov_b32 v250, 0
    v_mov_b32 v251, 0
    v_mov_b32 v252, 0
    v_mov_b32 v253, 0
    v_mov_b32 v254, 0
    v_mov_b32 v255, 0
    v_add_u32 v44, 0, v5
    v_add_u32 v45, 40960, v5
    v_mul_u32_u24 v46, 1296, v2
    v_lshl_add_u32 v46, v3, 4, v46
    s_mov_b32 s40, s36
    s_add_u32 s41, s40, 4096
    s_add_u32 s42, s40, 8192
    buffer_load_dwordx4 v[64:67], v44, s[8:11], s40 offen offset:0
    buffer_load_dwordx4 v[68:71], v45, s[8:11], s40 offen offset:0
    buffer_load_dwordx4 v[72:75], v44, s[8:11], s40 offen offset:1024
    buffer_load_dwordx4 v[76:79], v45, s[8:11], s40 offen offset:1024
    buffer_load_dwordx4 v[80:83], v44, s[8:11], s40 offen offset:2048
    buffer_load_dwordx4 v[84:87], v45, s[8:11], s40 offen offset:2048
    buffer_load_dwordx4 v[88:91], v44, s[8:11], s40 offen offset:3072
    buffer_load_dwordx4 v[92:95], v45, s[8:11], s40 offen offset:3072
    buffer_load_dwordx4 v[96:99], v44, s[8:11], s41 offen offset:0
    buffer_load_dwordx4 v[100:103], v45, s[8:11], s41 offen offset:0
    buffer_load_dwordx4 v[104:107], v44, s[8:11], s41 offen offset:1024
    buffer_load_dwordx4 v[108:111], v45, s[8:11], s41 offen offset:1024
    buffer_load_dwordx4 v[112:115], v44, s[8:11], s41 offen offset:2048
    buffer_load_dwordx4 v[116:119], v45, s[8:11], s41 offen offset:2048
    buffer_load_dwordx4 v[120:123], v44, s[8:11], s41 offen offset:3072
    buffer_load_dwordx4 v[124:127], v45, s[8:11], s41 offen offset:3072
    buffer_load_dwordx4 v[128:131], v44, s[8:11], s42 offen offset:0
    buffer_load_dwordx4 v[132:135], v45, s[8:11], s42 offen offset:0
    buffer_load_dwordx4 v[136:139], v44, s[8:11], s42 offen offset:1024
    buffer_load_dwordx4 v[140:143], v45, s[8:11], s42 offen offset:1024
    s_add_u32 s40, s40, 10240
    s_add_u32 s41, s41, 10240
    s_add_u32 s42, s42, 10240
    ds_read_b128 v[48:51], v46 offset:0
    ds_read_b128 v[52:55], v46 offset:41472
    s_mov_b32 s48, 4
gl_k3b_kernel:
    ds_read_b128 v[56:59], v46 offset:32
    ds_read_b128 v[60:63], v46 offset:41504
    s_waitcnt vmcnt(18) lgkmcnt(2)
    v_mfma_f32_32x32x16_bf16 v[192:207], v[64:67], v[48:51], v[192:207]
    v_mfma_f32_32x32x16_bf16 v[208:223], v[68:71], v[48:51], v[208:223]
    v_mfma_f32_32x32x16_bf16 v[224:239], v[64:67], v[52:55], v[224:239]
    v_mfma_f32_32x32x16_bf16 v[240:255], v[68:71], v[52:55], v[240:255]
    buffer_load_dwordx4 v[64:67], v44, s[8:11], s40 offen offset:0
    buffer_load_dwordx4 v[68:71], v45, s[8:11], s40 offen offset:0
    ds_read_b128 v[48:51], v46 offset:64
    ds_read_b128 v[52:55], v46 offset:41536
    s_waitcnt vmcnt(18) lgkmcnt(2)
    v_mfma_f32_32x32x16_bf16 v[192:207], v[72:75], v[56:59], v[192:207]
    v_mfma_f32_32x32x16_bf16 v[208:223], v[76:79], v[56:59], v[208:223]
    v_mfma_f32_32x32x16_bf16 v[224:239], v[72:75], v[60:63], v[224:239]
    v_mfma_f32_32x32x16_bf16 v[240:255], v[76:79], v[60:63], v[240:255]
    buffer_load_dwordx4 v[72:75], v44, s[8:11], s40 offen offset:1024
    buffer_load_dwordx4 v[76:79], v45, s[8:11], s40 offen offset:1024
    ds_read_b128 v[56:59], v46 offset:96
    ds_read_b128 v[60:63], v46 offset:41568
    s_waitcnt vmcnt(18) lgkmcnt(2)
    v_mfma_f32_32x32x16_bf16 v[192:207], v[80:83], v[48:51], v[192:207]
    v_mfma_f32_32x32x16_bf16 v[208:223], v[84:87], v[48:51], v[208:223]
    v_mfma_f32_32x32x16_bf16 v[224:239], v[80:83], v[52:55], v[224:239]
    v_mfma_f32_32x32x16_bf16 v[240:255], v[84:87], v[52:55], v[240:255]
    buffer_load_dwordx4 v[80:83], v44, s[8:11], s40 offen offset:2048
    buffer_load_dwordx4 v[84:87], v45, s[8:11], s40 offen offset:2048
    ds_read_b128 v[48:51], v46 offset:128
    ds_read_b128 v[52:55], v46 offset:41600
    s_waitcnt vmcnt(18) lgkmcnt(2)
    v_mfma_f32_32x32x16_bf16 v[192:207], v[88:91], v[56:59], v[192:207]
    v_mfma_f32_32x32x16_bf16 v[208:223], v[92:95], v[56:59], v[208:223]
    v_mfma_f32_32x32x16_bf16 v[224:239], v[88:91], v[60:63], v[224:239]
    v_mfma_f32_32x32x16_bf16 v[240:255], v[92:95], v[60:63], v[240:255]
    buffer_load_dwordx4 v[88:91], v44, s[8:11], s40 offen offset:3072
    buffer_load_dwordx4 v[92:95], v45, s[8:11], s40 offen offset:3072
    ds_read_b128 v[56:59], v46 offset:160
    ds_read_b128 v[60:63], v46 offset:41632
    s_waitcnt vmcnt(18) lgkmcnt(2)
    v_mfma_f32_32x32x16_bf16 v[192:207], v[96:99], v[48:51], v[192:207]
    v_mfma_f32_32x32x16_bf16 v[208:223], v[100:103], v[48:51], v[208:223]
    v_mfma_f32_32x32x16_bf16 v[224:239], v[96:99], v[52:55], v[224:239]
    v_mfma_f32_32x32x16_bf16 v[240:255], v[100:103], v[52:55], v[240:255]
    buffer_load_dwordx4 v[96:99], v44, s[8:11], s41 offen offset:0
    buffer_load_dwordx4 v[100:103], v45, s[8:11], s41 offen offset:0
    ds_read_b128 v[48:51], v46 offset:192
    ds_read_b128 v[52:55], v46 offset:41664
    s_waitcnt vmcnt(18) lgkmcnt(2)
    v_mfma_f32_32x32x16_bf16 v[192:207], v[104:107], v[56:59], v[192:207]
    v_mfma_f32_32x32x16_bf16 v[208:223], v[108:111], v[56:59], v[208:223]
    v_mfma_f32_32x32x16_bf16 v[224:239], v[104:107], v[60:63], v[224:239]
    v_mfma_f32_32x32x16_bf16 v[240:255], v[108:111], v[60:63], v[240:255]
    buffer_load_dwordx4 v[104:107], v44, s[8:11], s41 offen offset:1024
    buffer_load_dwordx4 v[108:111], v45, s[8:11], s41 offen offset:1024
    ds_read_b128 v[56:59], v46 offset:224
    ds_read_b128 v[60:63], v46 offset:41696
    s_waitcnt vmcnt(18) lgkmcnt(2)
    v_mfma_f32_32x32x16_bf16 v[192:207], v[112:115], v[48:51], v[192:207]
    v_mfma_f32_32x32x16_bf16 v[208:223], v[116:119], v[48:51], v[208:223]
    v_mfma_f32_32x32x16_bf16 v[224:239], v[112:115], v[52:55], v[224:239]
    v_mfma_f32_32x32x16_bf16 v[240:255], v[116:119], v[52:55], v[240:255]
    buffer_load_dwordx4 v[112:115], v44, s[8:11], s41 offen offset:2048
    buffer_load_dwordx4 v[116:119], v45, s[8:11], s41 offen offset:2048
    ds_read_b128 v[48:51], v46 offset:256
    ds_read_b128 v[52:55], v46 offset:41728
    s_waitcnt vmcnt(18) lgkmcnt(2)
    v_mfma_f32_32x32x16_bf16 v[192:207], v[120:123], v[56:59], v[192:207]
    v_mfma_f32_32x32x16_bf16 v[208:223], v[124:127], v[56:59], v[208:223]
    v_mfma_f32_32x32x16_bf16 v[224:239], v[120:123], v[60:63], v[224:239]
    v_mfma_f32_32x32x16_bf16 v[240:255], v[124:127], v[60:63], v[240:255]
    buffer_load_dwordx4 v[120:123], v44, s[8:11], s41 offen offset:3072
    buffer_load_dwordx4 v[124:127], v45, s[8:11], s41 offen offset:3072
    ds_read_b128 v[56:59], v46 offset:288
    ds_read_b128 v[60:63], v46 offset:41760
    s_waitcnt vmcnt(18) lgkmcnt(2)
    v_mfma_f32_32x32x16_bf16 v[192:207], v[128:131], v[48:51], v[192:207]
    v_mfma_f32_32x32x16_bf16 v[208:223], v[132:135], v[48:51], v[208:223]
    v_mfma_f32_32x32x16_bf16 v[224:239], v[128:131], v[52:55], v[224:239]
    v_mfma_f32_32x32x16_bf16 v[240:255], v[132:135], v[52:55], v[240:255]
    buffer_load_dwordx4 v[128:131], v44, s[8:11], s42 offen offset:0
    buffer_load_dwordx4 v[132:135], v45, s[8:11], s42 offen offset:0
    ds_read_b128 v[48:51], v46 offset:320
    ds_read_b128 v[52:55], v46 offset:41792
    s_waitcnt vmcnt(18) lgkmcnt(2)
    v_mfma_f32_32x32x16_bf16 v[192:207], v[136:139], v[56:59], v[192:207]
    v_mfma_f32_32x32x16_bf16 v[208:223], v[140:143], v[56:59], v[208:223]
    v_mfma_f32_32x32x16_bf16 v[224:239], v[136:139], v[60:63], v[224:239]
    v_mfma_f32_32x32x16_bf16 v[240:255], v[140:143], v[60:63], v[240:255]
    buffer_load_dwordx4 v[136:139], v44, s[8:11], s42 offen offset:1024
    buffer_load_dwordx4 v[140:143], v45, s[8:11], s42 offen offset:1024
    s_add_u32 s40, s40, 10240
    s_add_u32 s41, s41, 10240
    s_add_u32 s42, s42, 10240
    v_add_u32 v46, 320, v46
    s_sub_u32 s48, s48, 1
    s_cmp_lg_u32 s48, 0
    s_cbranch_scc1 gl_k3b_kernel
    s_waitcnt vmcnt(0) lgkmcnt(0)
    s_nop 15
    s_mov_b32 s38, 0x4013547a
    s_mov_b32 s39, 0x3dd2d2ae
    s_mov_b32 s40, 28524544
    s_lshl_b32 s37, s37, 6
    v_add_u32 v6, s34, v2
    v_add_u32 v6, 0, v6
    v_mul_u32_u24 v6, 3456, v6
    v_lshl_add_u32 v6, v3, 3, v6
    v_add_u32 v6, s37, v6
    v_mul_f32 v7, v192, v192
    v_mul_f32 v7, s39, v7
    v_add_f32 v7, s38, v7
    v_mul_f32 v7, v7, v192
    v_exp_f32 v7, -v7
    s_nop 0
    v_add_f32 v7, 1.0, v7
    v_rcp_f32 v7, v7
    s_nop 0
    v_mul_f32 v7, v7, v192
    v_mul_f32 v192, v7, v208
    v_mul_f32 v7, v193, v193
    v_mul_f32 v7, s39, v7
    v_add_f32 v7, s38, v7
    v_mul_f32 v7, v7, v193
    v_exp_f32 v7, -v7
    s_nop 0
    v_add_f32 v7, 1.0, v7
    v_rcp_f32 v7, v7
    s_nop 0
    v_mul_f32 v7, v7, v193
    v_mul_f32 v193, v7, v209
    v_mul_f32 v7, v194, v194
    v_mul_f32 v7, s39, v7
    v_add_f32 v7, s38, v7
    v_mul_f32 v7, v7, v194
    v_exp_f32 v7, -v7
    s_nop 0
    v_add_f32 v7, 1.0, v7
    v_rcp_f32 v7, v7
    s_nop 0
    v_mul_f32 v7, v7, v194
    v_mul_f32 v194, v7, v210
    v_mul_f32 v7, v195, v195
    v_mul_f32 v7, s39, v7
    v_add_f32 v7, s38, v7
    v_mul_f32 v7, v7, v195
    v_exp_f32 v7, -v7
    s_nop 0
    v_add_f32 v7, 1.0, v7
    v_rcp_f32 v7, v7
    s_nop 0
    v_mul_f32 v7, v7, v195
    v_mul_f32 v195, v7, v211
    v_mul_f32 v7, v196, v196
    v_mul_f32 v7, s39, v7
    v_add_f32 v7, s38, v7
    v_mul_f32 v7, v7, v196
    v_exp_f32 v7, -v7
    s_nop 0
    v_add_f32 v7, 1.0, v7
    v_rcp_f32 v7, v7
    s_nop 0
    v_mul_f32 v7, v7, v196
    v_mul_f32 v196, v7, v212
    v_mul_f32 v7, v197, v197
    v_mul_f32 v7, s39, v7
    v_add_f32 v7, s38, v7
    v_mul_f32 v7, v7, v197
    v_exp_f32 v7, -v7
    s_nop 0
    v_add_f32 v7, 1.0, v7
    v_rcp_f32 v7, v7
    s_nop 0
    v_mul_f32 v7, v7, v197
    v_mul_f32 v197, v7, v213
    v_mul_f32 v7, v198, v198
    v_mul_f32 v7, s39, v7
    v_add_f32 v7, s38, v7
    v_mul_f32 v7, v7, v198
    v_exp_f32 v7, -v7
    s_nop 0
    v_add_f32 v7, 1.0, v7
    v_rcp_f32 v7, v7
    s_nop 0
    v_mul_f32 v7, v7, v198
    v_mul_f32 v198, v7, v214
    v_mul_f32 v7, v199, v199
    v_mul_f32 v7, s39, v7
    v_add_f32 v7, s38, v7
    v_mul_f32 v7, v7, v199
    v_exp_f32 v7, -v7
    s_nop 0
    v_add_f32 v7, 1.0, v7
    v_rcp_f32 v7, v7
    s_nop 0
    v_mul_f32 v7, v7, v199
    v_mul_f32 v199, v7, v215
    v_mul_f32 v7, v200, v200
    v_mul_f32 v7, s39, v7
    v_add_f32 v7, s38, v7
    v_mul_f32 v7, v7, v200
    v_exp_f32 v7, -v7
    s_nop 0
    v_add_f32 v7, 1.0, v7
    v_rcp_f32 v7, v7
    s_nop 0
    v_mul_f32 v7, v7, v200
    v_mul_f32 v200, v7, v216
    v_mul_f32 v7, v201, v201
    v_mul_f32 v7, s39, v7
    v_add_f32 v7, s38, v7
    v_mul_f32 v7, v7, v201
    v_exp_f32 v7, -v7
    s_nop 0
    v_add_f32 v7, 1.0, v7
    v_rcp_f32 v7, v7
    s_nop 0
    v_mul_f32 v7, v7, v201
    v_mul_f32 v201, v7, v217
    v_mul_f32 v7, v202, v202
    v_mul_f32 v7, s39, v7
    v_add_f32 v7, s38, v7
    v_mul_f32 v7, v7, v202
    v_exp_f32 v7, -v7
    s_nop 0
    v_add_f32 v7, 1.0, v7
    v_rcp_f32 v7, v7
    s_nop 0
    v_mul_f32 v7, v7, v202
    v_mul_f32 v202, v7, v218
    v_mul_f32 v7, v203, v203
    v_mul_f32 v7, s39, v7
    v_add_f32 v7, s38, v7
    v_mul_f32 v7, v7, v203
    v_exp_f32 v7, -v7
    s_nop 0
    v_add_f32 v7, 1.0, v7
    v_rcp_f32 v7, v7
    s_nop 0
    v_mul_f32 v7, v7, v203
    v_mul_f32 v203, v7, v219
    v_mul_f32 v7, v204, v204
    v_mul_f32 v7, s39, v7
    v_add_f32 v7, s38, v7
    v_mul_f32 v7, v7, v204
    v_exp_f32 v7, -v7
    s_nop 0
    v_add_f32 v7, 1.0, v7
    v_rcp_f32 v7, v7
    s_nop 0
    v_mul_f32 v7, v7, v204
    v_mul_f32 v204, v7, v220
    v_mul_f32 v7, v205, v205
    v_mul_f32 v7, s39, v7
    v_add_f32 v7, s38, v7
    v_mul_f32 v7, v7, v205
    v_exp_f32 v7, -v7
    s_nop 0
    v_add_f32 v7, 1.0, v7
    v_rcp_f32 v7, v7
    s_nop 0
    v_mul_f32 v7, v7, v205
    v_mul_f32 v205, v7, v221
    v_mul_f32 v7, v206, v206
    v_mul_f32 v7, s39, v7
    v_add_f32 v7, s38, v7
    v_mul_f32 v7, v7, v206
    v_exp_f32 v7, -v7
    s_nop 0
    v_add_f32 v7, 1.0, v7
    v_rcp_f32 v7, v7
    s_nop 0
    v_mul_f32 v7, v7, v206
    v_mul_f32 v206, v7, v222
    v_mul_f32 v7, v207, v207
    v_mul_f32 v7, s39, v7
    v_add_f32 v7, s38, v7
    v_mul_f32 v7, v7, v207
    v_exp_f32 v7, -v7
    s_nop 0
    v_add_f32 v7, 1.0, v7
    v_rcp_f32 v7, v7
    s_nop 0
    v_mul_f32 v7, v7, v207
    v_mul_f32 v207, v7, v223
    v_cvt_pk_bf16_f32 v8, v192, v193
    v_cvt_pk_bf16_f32 v9, v194, v195
    buffer_store_dwordx2 v[8:9], v6, s[8:11], s40 offen offset:0
    s_nop 1
    v_cvt_pk_bf16_f32 v8, v196, v197
    v_cvt_pk_bf16_f32 v9, v198, v199
    buffer_store_dwordx2 v[8:9], v6, s[8:11], s40 offen offset:16
    s_nop 1
    v_cvt_pk_bf16_f32 v8, v200, v201
    v_cvt_pk_bf16_f32 v9, v202, v203
    buffer_store_dwordx2 v[8:9], v6, s[8:11], s40 offen offset:32
    s_nop 1
    v_cvt_pk_bf16_f32 v8, v204, v205
    v_cvt_pk_bf16_f32 v9, v206, v207
    buffer_store_dwordx2 v[8:9], v6, s[8:11], s40 offen offset:48
    s_nop 1
    v_add_u32 v6, s34, v2
    v_add_u32 v6, 32, v6
    v_mul_u32_u24 v6, 3456, v6
    v_lshl_add_u32 v6, v3, 3, v6
    v_add_u32 v6, s37, v6
    v_mul_f32 v7, v224, v224
    v_mul_f32 v7, s39, v7
    v_add_f32 v7, s38, v7
    v_mul_f32 v7, v7, v224
    v_exp_f32 v7, -v7
    s_nop 0
    v_add_f32 v7, 1.0, v7
    v_rcp_f32 v7, v7
    s_nop 0
    v_mul_f32 v7, v7, v224
    v_mul_f32 v224, v7, v240
    v_mul_f32 v7, v225, v225
    v_mul_f32 v7, s39, v7
    v_add_f32 v7, s38, v7
    v_mul_f32 v7, v7, v225
    v_exp_f32 v7, -v7
    s_nop 0
    v_add_f32 v7, 1.0, v7
    v_rcp_f32 v7, v7
    s_nop 0
    v_mul_f32 v7, v7, v225
    v_mul_f32 v225, v7, v241
    v_mul_f32 v7, v226, v226
    v_mul_f32 v7, s39, v7
    v_add_f32 v7, s38, v7
    v_mul_f32 v7, v7, v226
    v_exp_f32 v7, -v7
    s_nop 0
    v_add_f32 v7, 1.0, v7
    v_rcp_f32 v7, v7
    s_nop 0
    v_mul_f32 v7, v7, v226
    v_mul_f32 v226, v7, v242
    v_mul_f32 v7, v227, v227
    v_mul_f32 v7, s39, v7
    v_add_f32 v7, s38, v7
    v_mul_f32 v7, v7, v227
    v_exp_f32 v7, -v7
    s_nop 0
    v_add_f32 v7, 1.0, v7
    v_rcp_f32 v7, v7
    s_nop 0
    v_mul_f32 v7, v7, v227
    v_mul_f32 v227, v7, v243
    v_mul_f32 v7, v228, v228
    v_mul_f32 v7, s39, v7
    v_add_f32 v7, s38, v7
    v_mul_f32 v7, v7, v228
    v_exp_f32 v7, -v7
    s_nop 0
    v_add_f32 v7, 1.0, v7
    v_rcp_f32 v7, v7
    s_nop 0
    v_mul_f32 v7, v7, v228
    v_mul_f32 v228, v7, v244
    v_mul_f32 v7, v229, v229
    v_mul_f32 v7, s39, v7
    v_add_f32 v7, s38, v7
    v_mul_f32 v7, v7, v229
    v_exp_f32 v7, -v7
    s_nop 0
    v_add_f32 v7, 1.0, v7
    v_rcp_f32 v7, v7
    s_nop 0
    v_mul_f32 v7, v7, v229
    v_mul_f32 v229, v7, v245
    v_mul_f32 v7, v230, v230
    v_mul_f32 v7, s39, v7
    v_add_f32 v7, s38, v7
    v_mul_f32 v7, v7, v230
    v_exp_f32 v7, -v7
    s_nop 0
    v_add_f32 v7, 1.0, v7
    v_rcp_f32 v7, v7
    s_nop 0
    v_mul_f32 v7, v7, v230
    v_mul_f32 v230, v7, v246
    v_mul_f32 v7, v231, v231
    v_mul_f32 v7, s39, v7
    v_add_f32 v7, s38, v7
    v_mul_f32 v7, v7, v231
    v_exp_f32 v7, -v7
    s_nop 0
    v_add_f32 v7, 1.0, v7
    v_rcp_f32 v7, v7
    s_nop 0
    v_mul_f32 v7, v7, v231
    v_mul_f32 v231, v7, v247
    v_mul_f32 v7, v232, v232
    v_mul_f32 v7, s39, v7
    v_add_f32 v7, s38, v7
    v_mul_f32 v7, v7, v232
    v_exp_f32 v7, -v7
    s_nop 0
    v_add_f32 v7, 1.0, v7
    v_rcp_f32 v7, v7
    s_nop 0
    v_mul_f32 v7, v7, v232
    v_mul_f32 v232, v7, v248
    v_mul_f32 v7, v233, v233
    v_mul_f32 v7, s39, v7
    v_add_f32 v7, s38, v7
    v_mul_f32 v7, v7, v233
    v_exp_f32 v7, -v7
    s_nop 0
    v_add_f32 v7, 1.0, v7
    v_rcp_f32 v7, v7
    s_nop 0
    v_mul_f32 v7, v7, v233
    v_mul_f32 v233, v7, v249
    v_mul_f32 v7, v234, v234
    v_mul_f32 v7, s39, v7
    v_add_f32 v7, s38, v7
    v_mul_f32 v7, v7, v234
    v_exp_f32 v7, -v7
    s_nop 0
    v_add_f32 v7, 1.0, v7
    v_rcp_f32 v7, v7
    s_nop 0
    v_mul_f32 v7, v7, v234
    v_mul_f32 v234, v7, v250
    v_mul_f32 v7, v235, v235
    v_mul_f32 v7, s39, v7
    v_add_f32 v7, s38, v7
    v_mul_f32 v7, v7, v235
    v_exp_f32 v7, -v7
    s_nop 0
    v_add_f32 v7, 1.0, v7
    v_rcp_f32 v7, v7
    s_nop 0
    v_mul_f32 v7, v7, v235
    v_mul_f32 v235, v7, v251
    v_mul_f32 v7, v236, v236
    v_mul_f32 v7, s39, v7
    v_add_f32 v7, s38, v7
    v_mul_f32 v7, v7, v236
    v_exp_f32 v7, -v7
    s_nop 0
    v_add_f32 v7, 1.0, v7
    v_rcp_f32 v7, v7
    s_nop 0
    v_mul_f32 v7, v7, v236
    v_mul_f32 v236, v7, v252
    v_mul_f32 v7, v237, v237
    v_mul_f32 v7, s39, v7
    v_add_f32 v7, s38, v7
    v_mul_f32 v7, v7, v237
    v_exp_f32 v7, -v7
    s_nop 0
    v_add_f32 v7, 1.0, v7
    v_rcp_f32 v7, v7
    s_nop 0
    v_mul_f32 v7, v7, v237
    v_mul_f32 v237, v7, v253
    v_mul_f32 v7, v238, v238
    v_mul_f32 v7, s39, v7
    v_add_f32 v7, s38, v7
    v_mul_f32 v7, v7, v238
    v_exp_f32 v7, -v7
    s_nop 0
    v_add_f32 v7, 1.0, v7
    v_rcp_f32 v7, v7
    s_nop 0
    v_mul_f32 v7, v7, v238
    v_mul_f32 v238, v7, v254
    v_mul_f32 v7, v239, v239
    v_mul_f32 v7, s39, v7
    v_add_f32 v7, s38, v7
    v_mul_f32 v7, v7, v239
    v_exp_f32 v7, -v7
    s_nop 0
    v_add_f32 v7, 1.0, v7
    v_rcp_f32 v7, v7
    s_nop 0
    v_mul_f32 v7, v7, v239
    v_mul_f32 v239, v7, v255
    v_cvt_pk_bf16_f32 v8, v224, v225
    v_cvt_pk_bf16_f32 v9, v226, v227
    buffer_store_dwordx2 v[8:9], v6, s[8:11], s40 offen offset:0
    s_nop 1
    v_cvt_pk_bf16_f32 v8, v228, v229
    v_cvt_pk_bf16_f32 v9, v230, v231
    buffer_store_dwordx2 v[8:9], v6, s[8:11], s40 offen offset:16
    s_nop 1
    v_cvt_pk_bf16_f32 v8, v232, v233
    v_cvt_pk_bf16_f32 v9, v234, v235
    buffer_store_dwordx2 v[8:9], v6, s[8:11], s40 offen offset:32
    s_nop 1
    v_cvt_pk_bf16_f32 v8, v236, v237
    v_cvt_pk_bf16_f32 v9, v238, v239
    buffer_store_dwordx2 v[8:9], v6, s[8:11], s40 offen offset:48
    s_nop 1
k3b_kernel_end:
    s_endpgm
.p2align 8
.globl k4b_kernel
.type k4b_kernel,@function
k4b_kernel:
    s_cmp_ge_u32 s2, 160
    s_cbranch_scc1 k4b_kernel_end
    s_load_dwordx2 s[4:5], s[0:1], 80
    s_load_dwordx2 s[6:7], s[0:1], 64
    s_load_dwordx2 s[20:21], s[0:1], 0
    s_waitcnt lgkmcnt(0)
    s_mov_b32 s8, s4
    s_and_b32 s9, s5, 0xffff
    s_mov_b32 s10, 268435456
    s_mov_b32 s11, 0x20000
    s_mov_b32 s12, s6
    s_and_b32 s13, s7, 0xffff
    s_mov_b32 s14, 2621440
    s_mov_b32 s15, 0x20000
    s_mov_b32 s16, s20
    s_and_b32 s17, s21, 0xffff
    s_mov_b32 s18, 2621440
    s_mov_b32 s19, 0x20000
    v_lshrrev_b32 v1, 6, v0
    s_nop 0
    v_readfirstlane_b32 s32, v1
    v_and_b32 v2, 31, v0
    v_bfe_u32 v3, v0, 5, 1
    v_and_b32 v4, 63, v0
    v_lshlrev_b32 v5, 4, v4
    s_mul_hi_u32 s33, s2, 0xcccccccd
    s_lshr_b32 s33, s33, 2
    s_mul_i32 s35, s33, 5
    s_sub_u32 s35, s2, s35
    s_lshl_b32 s34, s33, 6
    s_lshl_b32 s37, s35, 2
    s_add_u32 s37, s37, s32
    s_mul_i32 s36, s37, 110592
    s_add_u32 s36, s36, 7864320
    v_lshrrev_b32 v6, 2, v0
    v_and_b32 v7, 3, v0
    v_add_u32 v8, s34, v6
    v_mul_u32_u24 v8, 3456, v8
    v_lshl_add_u32 v8, v7, 4, v8
    v_mul_u32_u24 v9, 1744, v6
    v_lshl_add_u32 v9, v7, 4, v9
    s_mov_b32 s30, 28524544
    buffer_load_dwordx4 v[144:147], v8, s[8:11], s30 offen offset:0
    buffer_load_dwordx4 v[148:151], v8, s[8:11], s30 offen offset:64
    buffer_load_dwordx4 v[152:155], v8, s[8:11], s30 offen offset:128
    buffer_load_dwordx4 v[156:159], v8, s[8:11], s30 offen offset:192
    buffer_load_dwordx4 v[160:163], v8, s[8:11], s30 offen offset:256
    buffer_load_dwordx4 v[164:167], v8, s[8:11], s30 offen offset:320
    buffer_load_dwordx4 v[168:171], v8, s[8:11], s30 offen offset:384
    buffer_load_dwordx4 v[172:175], v8, s[8:11], s30 offen offset:448
    buffer_load_dwordx4 v[176:179], v8, s[8:11], s30 offen offset:512
    buffer_load_dwordx4 v[180:183], v8, s[8:11], s30 offen offset:576
    buffer_load_dwordx4 v[184:187], v8, s[8:11], s30 offen offset:640
    buffer_load_dwordx4 v[188:191], v8, s[8:11], s30 offen offset:704
    buffer_load_dwordx4 v[192:195], v8, s[8:11], s30 offen offset:768
    buffer_load_dwordx4 v[196:199], v8, s[8:11], s30 offen offset:832
    buffer_load_dwordx4 v[200:203], v8, s[8:11], s30 offen offset:896
    buffer_load_dwordx4 v[204:207], v8, s[8:11], s30 offen offset:960
    buffer_load_dwordx4 v[208:211], v8, s[8:11], s30 offen offset:1024
    buffer_load_dwordx4 v[212:215], v8, s[8:11], s30 offen offset:1088
    buffer_load_dwordx4 v[216:219], v8, s[8:11], s30 offen offset:1152
    buffer_load_dwordx4 v[220:223], v8, s[8:11], s30 offen offset:1216
    buffer_load_dwordx4 v[224:227], v8, s[8:11], s30 offen offset:1280
    buffer_load_dwordx4 v[228:231], v8, s[8:11], s30 offen offset:1344
    buffer_load_dwordx4 v[232:235], v8, s[8:11], s30 offen offset:1408
    buffer_load_dwordx4 v[236:239], v8, s[8:11], s30 offen offset:1472
    buffer_load_dwordx4 v[240:243], v8, s[8:11], s30 offen offset:1536
    buffer_load_dwordx4 v[244:247], v8, s[8:11], s30 offen offset:1600
    buffer_load_dwordx4 v[248:251], v8, s[8:11], s30 offen offset:1664
    s_waitcnt vmcnt(0)
    ds_write_b128 v9, v[144:147] offset:0
    ds_write_b128 v9, v[148:151] offset:64
    ds_write_b128 v9, v[152:155] offset:128
    ds_write_b128 v9, v[156:159] offset:192
    ds_write_b128 v9, v[160:163] offset:256
    ds_write_b128 v9, v[164:167] offset:320
    ds_write_b128 v9, v[168:171] offset:384
    ds_write_b128 v9, v[172:175] offset:448
    ds_write_b128 v9, v[176:179] offset:512
    ds_write_b128 v9, v[180:183] offset:576
    ds_write_b128 v9, v[184:187] offset:640
    ds_write_b128 v9, v[188:191] offset:704
    ds_write_b128 v9, v[192:195] offset:768
    ds_write_b128 v9, v[196:199] offset:832
    ds_write_b128 v9, v[200:203] offset:896
    ds_write_b128 v9, v[204:207] offset:960
    ds_write_b128 v9, v[208:211] offset:1024
    ds_write_b128 v9, v[212:215] offset:1088
    ds_write_b128 v9, v[216:219] offset:1152
    ds_write_b128 v9, v[220:223] offset:1216
    ds_write_b128 v9, v[224:227] offset:1280
    ds_write_b128 v9, v[228:231] offset:1344
    ds_write_b128 v9, v[232:235] offset:1408
    ds_write_b128 v9, v[236:239] offset:1472
    ds_write_b128 v9, v[240:243] offset:1536
    ds_write_b128 v9, v[244:247] offset:1600
    ds_write_b128 v9, v[248:251] offset:1664
    s_waitcnt lgkmcnt(0)
    s_mov_b32 s30, 28526272
    buffer_load_dwordx4 v[144:147], v8, s[8:11], s30 offen offset:0
    buffer_load_dwordx4 v[148:151], v8, s[8:11], s30 offen offset:64
    buffer_load_dwordx4 v[152:155], v8, s[8:11], s30 offen offset:128
    buffer_load_dwordx4 v[156:159], v8, s[8:11], s30 offen offset:192
    buffer_load_dwordx4 v[160:163], v8, s[8:11], s30 offen offset:256
    buffer_load_dwordx4 v[164:167], v8, s[8:11], s30 offen offset:320
    buffer_load_dwordx4 v[168:171], v8, s[8:11], s30 offen offset:384
    buffer_load_dwordx4 v[172:175], v8, s[8:11], s30 offen offset:448
    buffer_load_dwordx4 v[176:179], v8, s[8:11], s30 offen offset:512
    buffer_load_dwordx4 v[180:183], v8, s[8:11], s30 offen offset:576
    buffer_load_dwordx4 v[184:187], v8, s[8:11], s30 offen offset:640
    buffer_load_dwordx4 v[188:191], v8, s[8:11], s30 offen offset:704
    buffer_load_dwordx4 v[192:195], v8, s[8:11], s30 offen offset:768
    buffer_load_dwordx4 v[196:199], v8, s[8:11], s30 offen offset:832
    buffer_load_dwordx4 v[200:203], v8, s[8:11], s30 offen offset:896
    buffer_load_dwordx4 v[204:207], v8, s[8:11], s30 offen offset:960
    buffer_load_dwordx4 v[208:211], v8, s[8:11], s30 offen offset:1024
    buffer_load_dwordx4 v[212:215], v8, s[8:11], s30 offen offset:1088
    buffer_load_dwordx4 v[216:219], v8, s[8:11], s30 offen offset:1152
    buffer_load_dwordx4 v[220:223], v8, s[8:11], s30 offen offset:1216
    buffer_load_dwordx4 v[224:227], v8, s[8:11], s30 offen offset:1280
    buffer_load_dwordx4 v[228:231], v8, s[8:11], s30 offen offset:1344
    buffer_load_dwordx4 v[232:235], v8, s[8:11], s30 offen offset:1408
    buffer_load_dwordx4 v[236:239], v8, s[8:11], s30 offen offset:1472
    buffer_load_dwordx4 v[240:243], v8, s[8:11], s30 offen offset:1536
    buffer_load_dwordx4 v[244:247], v8, s[8:11], s30 offen offset:1600
    buffer_load_dwordx4 v[248:251], v8, s[8:11], s30 offen offset:1664
    s_barrier
    v_mov_b32 v100, 0
    v_mov_b32 v101, 0
    v_mov_b32 v102, 0
    v_mov_b32 v103, 0
    v_mov_b32 v104, 0
    v_mov_b32 v105, 0
    v_mov_b32 v106, 0
    v_mov_b32 v107, 0
    v_mov_b32 v108, 0
    v_mov_b32 v109, 0
    v_mov_b32 v110, 0
    v_mov_b32 v111, 0
    v_mov_b32 v112, 0
    v_mov_b32 v113, 0
    v_mov_b32 v114, 0
    v_mov_b32 v115, 0
    v_mov_b32 v116, 0
    v_mov_b32 v117, 0
    v_mov_b32 v118, 0
    v_mov_b32 v119, 0
    v_mov_b32 v120, 0
    v_mov_b32 v121, 0
    v_mov_b32 v122, 0
    v_mov_b32 v123, 0
    v_mov_b32 v124, 0
    v_mov_b32 v125, 0
    v_mov_b32 v126, 0
    v_mov_b32 v127, 0
    v_mov_b32 v128, 0
    v_mov_b32 v129, 0
    v_mov_b32 v130, 0
    v_mov_b32 v131, 0
    v_add_u32 v44, 0, v5
    v_mul_u32_u24 v46, 1744, v2
    v_lshl_add_u32 v46, v3, 4, v46
    s_mov_b32 s40, s36
    s_add_u32 s41, s40, 4096
    buffer_load_dwordx4 v[64:67], v44, s[8:11], s40 offen offset:0
    buffer_load_dwordx4 v[68:71], v44, s[8:11], s40 offen offset:1024
    buffer_load_dwordx4 v[72:75], v44, s[8:11], s40 offen offset:2048
    buffer_load_dwordx4 v[76:79], v44, s[8:11], s40 offen offset:3072
    buffer_load_dwordx4 v[80:83], v44, s[8:11], s41 offen offset:0
    buffer_load_dwordx4 v[84:87], v44, s[8:11], s41 offen offset:1024
    s_add_u32 s40, s40, 6144
    s_add_u32 s41, s41, 6144
    ds_read_b128 v[48:51], v46 offset:0
    ds_read_b128 v[52:55], v46 offset:55808
    s_mov_b32 s48, 9
gl_k4b_kernel_0:
    ds_read_b128 v[56:59], v46 offset:32
    ds_read_b128 v[60:63], v46 offset:55840
    s_waitcnt vmcnt(5) lgkmcnt(2)
    v_mfma_f32_32x32x16_bf16 v[100:115], v[64:67], v[48:51], v[100:115]
    v_mfma_f32_32x32x16_bf16 v[116:131], v[64:67], v[52:55], v[116:131]
    buffer_load_dwordx4 v[64:67], v44, s[8:11], s40 offen offset:0
    ds_read_b128 v[48:51], v46 offset:64
    ds_read_b128 v[52:55], v46 offset:55872
    s_waitcnt vmcnt(5) lgkmcnt(2)
    v_mfma_f32_32x32x16_bf16 v[100:115], v[68:71], v[56:59], v[100:115]
    v_mfma_f32_32x32x16_bf16 v[116:131], v[68:71], v[60:63], v[116:131]
    buffer_load_dwordx4 v[68:71], v44, s[8:11], s40 offen offset:1024
    ds_read_b128 v[56:59], v46 offset:96
    ds_read_b128 v[60:63], v46 offset:55904
    s_waitcnt vmcnt(5) lgkmcnt(2)
    v_mfma_f32_32x32x16_bf16 v[100:115], v[72:75], v[48:51], v[100:115]
    v_mfma_f32_32x32x16_bf16 v[116:131], v[72:75], v[52:55], v[116:131]
    buffer_load_dwordx4 v[72:75], v44, s[8:11], s40 offen offset:2048
    ds_read_b128 v[48:51], v46 offset:128
    ds_read_b128 v[52:55], v46 offset:55936
    s_waitcnt vmcnt(5) lgkmcnt(2)
    v_mfma_f32_32x32x16_bf16 v[100:115], v[76:79], v[56:59], v[100:115]
    v_mfma_f32_32x32x16_bf16 v[116:131], v[76:79], v[60:63], v[116:131]
    buffer_load_dwordx4 v[76:79], v44, s[8:11], s40 offen offset:3072
    ds_read_b128 v[56:59], v46 offset:160
    ds_read_b128 v[60:63], v46 offset:55968
    s_waitcnt vmcnt(5) lgkmcnt(2)
    v_mfma_f32_32x32x16_bf16 v[100:115], v[80:83], v[48:51], v[100:115]
    v_mfma_f32_32x32x16_bf16 v[116:131], v[80:83], v[52:55], v[116:131]
    buffer_load_dwordx4 v[80:83], v44, s[8:11], s41 offen offset:0
    ds_read_b128 v[48:51], v46 offset:192
    ds_read_b128 v[52:55], v46 offset:56000
    s_waitcnt vmcnt(5) lgkmcnt(2)
    v_mfma_f32_32x32x16_bf16 v[100:115], v[84:87], v[56:59], v[100:115]
    v_mfma_f32_32x32x16_bf16 v[116:131], v[84:87], v[60:63], v[116:131]
    buffer_load_dwordx4 v[84:87], v44, s[8:11], s41 offen offset:1024
    s_add_u32 s40, s40, 6144
    s_add_u32 s41, s41, 6144
    v_add_u32 v46, 192, v46
    s_sub_u32 s48, s48, 1
    s_cmp_lg_u32 s48, 0
    s_cbranch_scc1 gl_k4b_kernel_0
    s_waitcnt vmcnt(0) lgkmcnt(0)
    s_nop 15
    s_add_u32 s36, s36, 55296
    s_barrier
    s_waitcnt vmcnt(0)
    ds_write_b128 v9, v[144:147] offset:0
    ds_write_b128 v9, v[148:151] offset:64
    ds_write_b128 v9, v[152:155] offset:128
    ds_write_b128 v9, v[156:159] offset:192
    ds_write_b128 v9, v[160:163] offset:256
    ds_write_b128 v9, v[164:167] offset:320
    ds_write_b128 v9, v[168:171] offset:384
    ds_write_b128 v9, v[172:175] offset:448
    ds_write_b128 v9, v[176:179] offset:512
    ds_write_b128 v9, v[180:183] offset:576
    ds_write_b128 v9, v[184:187] offset:640
    ds_write_b128 v9, v[188:191] offset:704
    ds_write_b128 v9, v[192:195] offset:768
    ds_write_b128 v9, v[196:199] offset:832
    ds_write_b128 v9, v[200:203] offset:896
    ds_write_b128 v9, v[204:207] offset:960
    ds_write_b128 v9, v[208:211] offset:1024
    ds_write_b128 v9, v[212:215] offset:1088
    ds_write_b128 v9, v[216:219] offset:1152
    ds_write_b128 v9, v[220:223] offset:1216
    ds_write_b128 v9, v[224:227] offset:1280
    ds_write_b128 v9, v[228:231] offset:1344
    ds_write_b128 v9, v[232:235] offset:1408
    ds_write_b128 v9, v[236:239] offset:1472
    ds_write_b128 v9, v[240:243] offset:1536
    ds_write_b128 v9, v[244:247] offset:1600
    ds_write_b128 v9, v[248:251] offset:1664
    s_waitcnt lgkmcnt(0)
    s_barrier
    v_add_u32 v44, 0, v5
    v_mul_u32_u24 v46, 1744, v2
    v_lshl_add_u32 v46, v3, 4, v46
    s_mov_b32 s40, s36
    s_add_u32 s41, s40, 4096
    buffer_load_dwordx4 v[64:67], v44, s[8:11], s40 offen offset:0
    buffer_load_dwordx4 v[68:71], v44, s[8:11], s40 offen offset:1024
    buffer_load_dwordx4 v[72:75], v44, s[8:11], s40 offen offset:2048
    buffer_load_dwordx4 v[76:79], v44, s[8:11], s40 offen offset:3072
    buffer_load_dwordx4 v[80:83], v44, s[8:11], s41 offen offset:0
    buffer_load_dwordx4 v[84:87], v44, s[8:11], s41 offen offset:1024
    s_add_u32 s40, s40, 6144
    s_add_u32 s41, s41, 6144
    ds_read_b128 v[48:51], v46 offset:0
    ds_read_b128 v[52:55], v46 offset:55808
    s_mov_b32 s48, 9
gl_k4b_kernel_1:
    ds_read_b128 v[56:59], v46 offset:32
    ds_read_b128 v[60:63], v46 offset:55840
    s_waitcnt vmcnt(5) lgkmcnt(2)
    v_mfma_f32_32x32x16_bf16 v[100:115], v[64:67], v[48:51], v[100:115]
    v_mfma_f32_32x32x16_bf16 v[116:131], v[64:67], v[52:55], v[116:131]
    buffer_load_dwordx4 v[64:67], v44, s[8:11], s40 offen offset:0
    ds_read_b128 v[48:51], v46 offset:64
    ds_read_b128 v[52:55], v46 offset:55872
    s_waitcnt vmcnt(5) lgkmcnt(2)
    v_mfma_f32_32x32x16_bf16 v[100:115], v[68:71], v[56:59], v[100:115]
    v_mfma_f32_32x32x16_bf16 v[116:131], v[68:71], v[60:63], v[116:131]
    buffer_load_dwordx4 v[68:71], v44, s[8:11], s40 offen offset:1024
    ds_read_b128 v[56:59], v46 offset:96
    ds_read_b128 v[60:63], v46 offset:55904
    s_waitcnt vmcnt(5) lgkmcnt(2)
    v_mfma_f32_32x32x16_bf16 v[100:115], v[72:75], v[48:51], v[100:115]
    v_mfma_f32_32x32x16_bf16 v[116:131], v[72:75], v[52:55], v[116:131]
    buffer_load_dwordx4 v[72:75], v44, s[8:11], s40 offen offset:2048
    ds_read_b128 v[48:51], v46 offset:128
    ds_read_b128 v[52:55], v46 offset:55936
    s_waitcnt vmcnt(5) lgkmcnt(2)
    v_mfma_f32_32x32x16_bf16 v[100:115], v[76:79], v[56:59], v[100:115]
    v_mfma_f32_32x32x16_bf16 v[116:131], v[76:79], v[60:63], v[116:131]
    buffer_load_dwordx4 v[76:79], v44, s[8:11], s40 offen offset:3072
    ds_read_b128 v[56:59], v46 offset:160
    ds_read_b128 v[60:63], v46 offset:55968
    s_waitcnt vmcnt(5) lgkmcnt(2)
    v_mfma_f32_32x32x16_bf16 v[100:115], v[80:83], v[48:51], v[100:115]
    v_mfma_f32_32x32x16_bf16 v[116:131], v[80:83], v[52:55], v[116:131]
    buffer_load_dwordx4 v[80:83], v44, s[8:11], s41 offen offset:0
    ds_read_b128 v[48:51], v46 offset:192
    ds_read_b128 v[52:55], v46 offset:56000
    s_waitcnt vmcnt(5) lgkmcnt(2)
    v_mfma_f32_32x32x16_bf16 v[100:115], v[84:87], v[56:59], v[100:115]
    v_mfma_f32_32x32x16_bf16 v[116:131], v[84:87], v[60:63], v[116:131]
    buffer_load_dwordx4 v[84:87], v44, s[8:11], s41 offen offset:1024
    s_add_u32 s40, s40, 6144
    s_add_u32 s41, s41, 6144
    v_add_u32 v46, 192, v46
    s_sub_u32 s48, s48, 1
    s_cmp_lg_u32 s48, 0
    s_cbranch_scc1 gl_k4b_kernel_1
    s_waitcnt vmcnt(0) lgkmcnt(0)
    s_nop 15
    s_add_u32 s36, s36, 55296
    s_lshl_b32 s37, s37, 5
    s_mov_b32 s30, 25903104
    s_mov_b32 s31, 0
    v_add_u32 v6, s34, v2
    v_add_u32 v6, 0, v6
    v_mul_u32_u24 v6, 1280, v6
    v_lshl_add_u32 v6, v3, 3, v6
    v_mov_b32 v7, s37
    v_lshl_add_u32 v6, v7, 1, v6
    buffer_load_dwordx2 v[8:9], v6, s[8:11], s30 offen offset:0
    buffer_load_dwordx2 v[10:11], v6, s[8:11], s30 offen offset:16
    buffer_load_dwordx2 v[12:13], v6, s[8:11], s30 offen offset:32
    buffer_load_dwordx2 v[14:15], v6, s[8:11], s30 offen offset:48
    s_waitcnt vmcnt(0)
    v_lshlrev_b32 v7, 16, v8
    v_add_f32 v100, v100, v7
    v_and_b32 v7, 0xffff0000, v8
    v_add_f32 v101, v101, v7
    v_cvt_pk_bf16_f32 v8, v100, v101
    v_lshlrev_b32 v7, 16, v9
    v_add_f32 v102, v102, v7
    v_and_b32 v7, 0xffff0000, v9
    v_add_f32 v103, v103, v7
    v_cvt_pk_bf16_f32 v9, v102, v103
    buffer_store_dwordx2 v[8:9], v6, s[12:15], s31 offen offset:0
    v_lshlrev_b32 v7, 16, v10
    v_add_f32 v104, v104, v7
    v_and_b32 v7, 0xffff0000, v10
    v_add_f32 v105, v105, v7
    v_cvt_pk_bf16_f32 v10, v104, v105
    v_lshlrev_b32 v7, 16, v11
    v_add_f32 v106, v106, v7
    v_and_b32 v7, 0xffff0000, v11
    v_add_f32 v107, v107, v7
    v_cvt_pk_bf16_f32 v11, v106, v107
    buffer_store_dwordx2 v[10:11], v6, s[12:15], s31 offen offset:16
    v_lshlrev_b32 v7, 16, v12
    v_add_f32 v108, v108, v7
    v_and_b32 v7, 0xffff0000, v12
    v_add_f32 v109, v109, v7
    v_cvt_pk_bf16_f32 v12, v108, v109
    v_lshlrev_b32 v7, 16, v13
    v_add_f32 v110, v110, v7
    v_and_b32 v7, 0xffff0000, v13
    v_add_f32 v111, v111, v7
    v_cvt_pk_bf16_f32 v13, v110, v111
    buffer_store_dwordx2 v[12:13], v6, s[12:15], s31 offen offset:32
    v_lshlrev_b32 v7, 16, v14
    v_add_f32 v112, v112, v7
    v_and_b32 v7, 0xffff0000, v14
    v_add_f32 v113, v113, v7
    v_cvt_pk_bf16_f32 v14, v112, v113
    v_lshlrev_b32 v7, 16, v15
    v_add_f32 v114, v114, v7
    v_and_b32 v7, 0xffff0000, v15
    v_add_f32 v115, v115, v7
    v_cvt_pk_bf16_f32 v15, v114, v115
    buffer_store_dwordx2 v[14:15], v6, s[12:15], s31 offen offset:48
    v_add_u32 v6, s34, v2
    v_add_u32 v6, 32, v6
    v_mul_u32_u24 v6, 1280, v6
    v_lshl_add_u32 v6, v3, 3, v6
    v_mov_b32 v7, s37
    v_lshl_add_u32 v6, v7, 1, v6
    buffer_load_dwordx2 v[8:9], v6, s[8:11], s30 offen offset:0
    buffer_load_dwordx2 v[10:11], v6, s[8:11], s30 offen offset:16
    buffer_load_dwordx2 v[12:13], v6, s[8:11], s30 offen offset:32
    buffer_load_dwordx2 v[14:15], v6, s[8:11], s30 offen offset:48
    s_waitcnt vmcnt(0)
    v_lshlrev_b32 v7, 16, v8
    v_add_f32 v116, v116, v7
    v_and_b32 v7, 0xffff0000, v8
    v_add_f32 v117, v117, v7
    v_cvt_pk_bf16_f32 v8, v116, v117
    v_lshlrev_b32 v7, 16, v9
    v_add_f32 v118, v118, v7
    v_and_b32 v7, 0xffff0000, v9
    v_add_f32 v119, v119, v7
    v_cvt_pk_bf16_f32 v9, v118, v119
    buffer_store_dwordx2 v[8:9], v6, s[12:15], s31 offen offset:0
    v_lshlrev_b32 v7, 16, v10
    v_add_f32 v120, v120, v7
    v_and_b32 v7, 0xffff0000, v10
    v_add_f32 v121, v121, v7
    v_cvt_pk_bf16_f32 v10, v120, v121
    v_lshlrev_b32 v7, 16, v11
    v_add_f32 v122, v122, v7
    v_and_b32 v7, 0xffff0000, v11
    v_add_f32 v123, v123, v7
    v_cvt_pk_bf16_f32 v11, v122, v123
    buffer_store_dwordx2 v[10:11], v6, s[12:15], s31 offen offset:16
    v_lshlrev_b32 v7, 16, v12
    v_add_f32 v124, v124, v7
    v_and_b32 v7, 0xffff0000, v12
    v_add_f32 v125, v125, v7
    v_cvt_pk_bf16_f32 v12, v124, v125
    v_lshlrev_b32 v7, 16, v13
    v_add_f32 v126, v126, v7
    v_and_b32 v7, 0xffff0000, v13
    v_add_f32 v127, v127, v7
    v_cvt_pk_bf16_f32 v13, v126, v127
    buffer_store_dwordx2 v[12:13], v6, s[12:15], s31 offen offset:32
    v_lshlrev_b32 v7, 16, v14
    v_add_f32 v128, v128, v7
    v_and_b32 v7, 0xffff0000, v14
    v_add_f32 v129, v129, v7
    v_cvt_pk_bf16_f32 v14, v128, v129
    v_lshlrev_b32 v7, 16, v15
    v_add_f32 v130, v130, v7
    v_and_b32 v7, 0xffff0000, v15
    v_add_f32 v131, v131, v7
    v_cvt_pk_bf16_f32 v15, v130, v131
    buffer_store_dwordx2 v[14:15], v6, s[12:15], s31 offen offset:48
k4b_kernel_end:
    s_endpgm
.section .rodata,"a"
.p2align 6
.amdhsa_kernel interleave_layers__linear_kernel_hedgehog__glu_gated_geglu__prompt_kernel
  .amdhsa_next_free_vgpr 256
  .amdhsa_next_free_sgpr 102
  .amdhsa_accum_offset 256
  .amdhsa_group_segment_fixed_size 0
  .amdhsa_kernarg_size 88
  .amdhsa_user_sgpr_count 2
  .amdhsa_user_sgpr_kernarg_segment_ptr 1
  .amdhsa_system_sgpr_workgroup_id_x 1
.end_amdhsa_kernel
.p2align 6
.amdhsa_kernel k1a_kernel
  .amdhsa_next_free_vgpr 256
  .amdhsa_next_free_sgpr 102
  .amdhsa_accum_offset 256
  .amdhsa_group_segment_fixed_size 0
  .amdhsa_kernarg_size 88
  .amdhsa_user_sgpr_count 2
  .amdhsa_user_sgpr_kernarg_segment_ptr 1
  .amdhsa_system_sgpr_workgroup_id_x 1
.end_amdhsa_kernel
.p2align 6
.amdhsa_kernel kra_kernel
  .amdhsa_next_free_vgpr 256
  .amdhsa_next_free_sgpr 102
  .amdhsa_accum_offset 256
  .amdhsa_group_segment_fixed_size 0
  .amdhsa_kernarg_size 88
  .amdhsa_user_sgpr_count 2
  .amdhsa_user_sgpr_kernarg_segment_ptr 1
  .amdhsa_system_sgpr_workgroup_id_x 1
.end_amdhsa_kernel
.p2align 6
.amdhsa_kernel k2a_kernel
  .amdhsa_next_free_vgpr 256
  .amdhsa_next_free_sgpr 102
  .amdhsa_accum_offset 256
  .amdhsa_group_segment_fixed_size 0
  .amdhsa_kernarg_size 88
  .amdhsa_user_sgpr_count 2
  .amdhsa_user_sgpr_kernarg_segment_ptr 1
  .amdhsa_system_sgpr_workgroup_id_x 1
.end_amdhsa_kernel
.p2align 6
.amdhsa_kernel k3a_kernel
  .amdhsa_next_free_vgpr 256
  .amdhsa_next_free_sgpr 102
  .amdhsa_accum_offset 256
  .amdhsa_group_segment_fixed_size 0
  .amdhsa_kernarg_size 88
  .amdhsa_user_sgpr_count 2
  .amdhsa_user_sgpr_kernarg_segment_ptr 1
  .amdhsa_system_sgpr_workgroup_id_x 1
.end_amdhsa_kernel
.p2align 6
.amdhsa_kernel k4a_kernel
  .amdhsa_next_free_vgpr 256
  .amdhsa_next_free_sgpr 102
  .amdhsa_accum_offset 256
  .amdhsa_group_segment_fixed_size 0
  .amdhsa_kernarg_size 88
  .amdhsa_user_sgpr_count 2
  .amdhsa_user_sgpr_kernarg_segment_ptr 1
  .amdhsa_system_sgpr_workgroup_id_x 1
.end_amdhsa_kernel
.p2align 6
.amdhsa_kernel k1b_kernel
  .amdhsa_next_free_vgpr 256
  .amdhsa_next_free_sgpr 102
  .amdhsa_accum_offset 256
  .amdhsa_group_segment_fixed_size 0
  .amdhsa_kernarg_size 88
  .amdhsa_user_sgpr_count 2
  .amdhsa_user_sgpr_kernarg_segment_ptr 1
  .amdhsa_system_sgpr_workgroup_id_x 1
.end_amdhsa_kernel
.p2align 6
.amdhsa_kernel krb_kernel
  .amdhsa_next_free_vgpr 256
  .amdhsa_next_free_sgpr 102
  .amdhsa_accum_offset 256
  .amdhsa_group_segment_fixed_size 0
  .amdhsa_kernarg_size 88
  .amdhsa_user_sgpr_count 2
  .amdhsa_user_sgpr_kernarg_segment_ptr 1
  .amdhsa_system_sgpr_workgroup_id_x 1
.end_amdhsa_kernel
.p2align 6
.amdhsa_kernel k2b_kernel
  .amdhsa_next_free_vgpr 256
  .amdhsa_next_free_sgpr 102
  .amdhsa_accum_offset 256
  .amdhsa_group_segment_fixed_size 0
  .amdhsa_kernarg_size 88
  .amdhsa_user_sgpr_count 2
  .amdhsa_user_sgpr_kernarg_segment_ptr 1
  .amdhsa_system_sgpr_workgroup_id_x 1
.end_amdhsa_kernel
.p2align 6
.amdhsa_kernel k3b_kernel
  .amdhsa_next_free_vgpr 256
  .amdhsa_next_free_sgpr 102
  .amdhsa_accum_offset 256
  .amdhsa_group_segment_fixed_size 0
  .amdhsa_kernarg_size 88
  .amdhsa_user_sgpr_count 2
  .amdhsa_user_sgpr_kernarg_segment_ptr 1
  .amdhsa_system_sgpr_workgroup_id_x 1
.end_amdhsa_kernel
.p2align 6
.amdhsa_kernel k4b_kernel
  .amdhsa_next_free_vgpr 256
  .amdhsa_next_free_sgpr 102
  .amdhsa_accum_offset 256
  .amdhsa_group_segment_fixed_size 0
  .amdhsa_kernarg_size 88
  .amdhsa_user_sgpr_count 2
  .amdhsa_user_sgpr_kernarg_segment_ptr 1
  .amdhsa_system_sgpr_workgroup_id_x 1
.end_amdhsa_kernel
```
